```python
import torch

def _softmax(x, axis=-1):
    return torch.softmax(x, dim=axis)
def _gelu(x):
    return torch.nn.functional.gelu(x, approximate="tanh")
def _silu(x):
    return torch.nn.functional.silu(x)
def _sigmoid(x):
    return torch.sigmoid(x)
def _layernorm(x, axis=-1, eps=1e-5):
    m = x.mean(dim=axis, keepdim=True)
    v = x.var(dim=axis, keepdim=True, unbiased=False)
    return (x - m) / torch.sqrt(v + eps)
def _scatter_add(tgt, idx, src, axis=0):
    return tgt.clone().index_add_(axis, idx, src)
def _segment_sum(src, seg, n):
    out = torch.zeros((n,) + src.shape[1:], dtype=src.dtype)
    return out.index_add_(0, seg, src)
def _pad(x, pw):
    flat = tuple(v for pair in reversed(pw) for v in pair)
    return torch.nn.functional.pad(x, flat)

kernel_name = 'sequential_preLN__sliding_block__mixer_channel_mlp__prompt'

def setup_inputs():

    _w = (lambda a: (lambda t: t.to(torch.bfloat16) if t.is_floating_point() else t)(torch.as_tensor(a)))
    def _A_setup():
        B, S, D = 1, 2048, 512
        return {
            "x": _w((lambda *s: torch.randn(*s, dtype=torch.bfloat16) * 0.05)(B, S, D)),
            "wqkv": _w((lambda *s: torch.randn(*s, dtype=torch.bfloat16) * 0.05)(D, 3 * D)),
            "wo": _w((lambda *s: torch.randn(*s, dtype=torch.bfloat16) * 0.05)(D, D)),
        }
    _A_in = _A_setup()

    def _B_setup():
        B, S, D, F = 1, 2048, 512, 1792
        return {
            "x": _w((lambda *s: torch.randn(*s, dtype=torch.bfloat16) * 0.05)(B, S, D)),
            "w1": _w((lambda *s: torch.randn(*s, dtype=torch.bfloat16) * 3.2)(D, F) * (D ** -0.5)),
            "b1": _w((lambda *s: torch.randn(*s, dtype=torch.bfloat16) * 1.6)(F)),
            "w2": _w((lambda *s: torch.randn(*s, dtype=torch.bfloat16) * 0.2)(F, D) * (F ** -0.5)),
            "b2": _w((lambda *s: torch.randn(*s, dtype=torch.bfloat16) * 0.2)(D)),
        }
    _B_in = _B_setup()

    return {
        "A_x": _A_in["x"],
        "A_wqkv": _A_in["wqkv"],
        "A_wo": _A_in["wo"],
        "B_x": _B_in["x"],
        "B_w1": _B_in["w1"],
        "B_b1": _B_in["b1"],
        "B_w2": _B_in["w2"],
        "B_b2": _B_in["b2"],
    }

def reference(A_x, A_wqkv, A_wo, B_x, B_w1, B_b1, B_w2, B_b2):
    def _A_ref(x, wqkv, wo):
        B, S, D = x.shape
        H = 32; Dh = D // H; W = 256
        qkv = (lambda x, *d: x.permute(*d))((x @ wqkv).reshape(B, S, 3, H, Dh), 2, 0, 3, 1, 4)
        q, k, v = qkv[0], qkv[1], qkv[2]
        scores = torch.einsum("bhqd,bhkd->bhqk", q, k) * (Dh ** -0.5)
        idx = torch.arange(S)
        mask = (idx[:, None] - idx[None, :] >= 0) & (idx[:, None] - idx[None, :] < W)
        scores = torch.where(mask[None, None], scores, -1e9)
        p = _softmax(scores, axis=-1)
        o = torch.einsum("bhqk,bhkd->bhqd", p, v)
        return (lambda x, *d: x.permute(*d))(o, 0, 2, 1, 3).reshape(B, S, D) @ wo

    def _B_ref(x, w1, b1, w2, b2):
        y = _layernorm(x, axis=-1)
        h = _gelu(torch.einsum("bsd,df->bsf", y, w1) + b1)
        return torch.einsum("bsf,fd->bsd", h, w2) + b2

    x = A_x
    h = x + _A_ref(_layernorm(x, axis=-1), A_wqkv, A_wo)
    h2 = h + _B_ref(_layernorm(h, axis=-1), B_w1, B_b1, B_w2, B_b2)
    return h2
```

```asm
; @launch grid=(256,1,1) block=(256,1,1) lds=163840
.amdgcn_target "amdgcn-amd-amdhsa--gfx950"
.text
.globl sequential_preLN__sliding_block__mixer_channel_mlp__prompt_kernel
.p2align 8
.type sequential_preLN__sliding_block__mixer_channel_mlp__prompt_kernel,@function
sequential_preLN__sliding_block__mixer_channel_mlp__prompt_kernel:
    s_cmp_ge_u32 s2, 256
    s_cbranch_scc1 L_end
    s_load_dwordx16 s[40:55], s[0:1], 0
    s_load_dwordx4 s[56:59], s[0:1], 64
    s_load_dwordx2 s[60:61], s[0:1], 80
    v_lshrrev_b32 v2, 6, v0
    v_and_b32 v0, 63, v0
    v_readfirstlane_b32 s62, v2
    v_lshlrev_b32 v1, 4, v0
    v_mov_b32 v6, 0
    s_and_b32 s72, s2, 7
    s_lshr_b32 s73, s2, 3
    s_lshr_b32 s74, s72, 1
    s_lshl_b32 s75, s74, 3
    s_and_b32 s76, s73, 7
    s_add_u32 s63, s75, s76
    s_and_b32 s75, s72, 1
    s_lshl_b32 s76, s75, 2
    s_lshr_b32 s77, s73, 3
    s_add_u32 s64, s76, s77
    s_and_b32 s76, s73, 3
    s_lshl_b32 s77, s72, 2
    s_add_u32 s65, s77, s76
    s_lshr_b32 s66, s73, 2
    s_lshl_b32 s77, s74, 2
    s_add_u32 s67, s77, s76
    s_mul_i32 s77, s75, 7
    s_add_u32 s68, s77, s66
    s_cmp_lt_u32 s66, 7
    s_cselect_b32 s69, 1, 0
    s_min_u32 s68, s68, 13
    s_cmp_eq_u32 s75, 0
    s_cselect_b32 s76, 3, 0
    s_xor_b32 s64, s64, s76
    s_and_b32 s76, s66, 3
    s_cmp_eq_u32 s76, 3
    s_cselect_b32 s76, 4, 0
    s_xor_b32 s66, s66, s76
    s_add_u32 s76, s64, 1
    s_and_b32 s76, s76, 3
    s_andn2_b32 s77, s64, 3
    s_or_b32 s85, s77, s76
    s_add_u32 s76, s64, 2
    s_and_b32 s76, s76, 3
    s_andn2_b32 s77, s64, 3
    s_or_b32 s86, s77, s76
    s_lshl_b32 s74, s63, 16
    s_lshl_b32 s75, s62, 14
    s_add_u32 s87, s74, s75
    s_and_b32 s75, s2, 64
    s_lshl_b32 s75, s75, 7
    s_xor_b32 s76, s75, 8192
    s_add_u32 s89, s87, s76
    s_add_u32 s87, s87, s75
    s_add_u32 s88, s87, 4096
    s_add_u32 s90, s89, 4096
    v_lshrrev_b32 v2, 3, v0
    v_and_b32 v3, 7, v0
    v_bfe_u32 v4, v0, 4, 1
    v_lshlrev_b32 v4, 2, v4
    v_xor_b32 v3, v3, v4
    v_lshlrev_b32 v3, 4, v3
    v_mul_u32_u24 v53, 3072, v2
    v_add_u32 v53, v53, v3
    v_lshl_add_u32 v11, v2, 10, v3
    v_add_u32 v54, 23552, v53
    v_add_u32 v12, 7168, v11
    v_add_u32 v55, 47104, v53
    v_add_u32 v13, 14336, v11
    v_add_u32 v56, 70656, v53
    v_add_u32 v14, 21504, v11
    v_lshlrev_b32 v57, 7, v0
    s_waitcnt lgkmcnt(0)
    s_mov_b32 s4, s40
    s_and_b32 s5, s41, 0xffff
    s_mov_b32 s6, 2097152
    s_mov_b32 s7, 0x20000
    buffer_load_dwordx4 v[64:67], v1, s[4:7], s87 offen offset:0
    buffer_load_dwordx4 v[68:71], v1, s[4:7], s87 offen offset:1024
    buffer_load_dwordx4 v[72:75], v1, s[4:7], s87 offen offset:2048
    buffer_load_dwordx4 v[76:79], v1, s[4:7], s87 offen offset:3072
    buffer_load_dwordx4 v[80:83], v1, s[4:7], s88 offen offset:0
    buffer_load_dwordx4 v[84:87], v1, s[4:7], s88 offen offset:1024
    buffer_load_dwordx4 v[88:91], v1, s[4:7], s88 offen offset:2048
    buffer_load_dwordx4 v[92:95], v1, s[4:7], s88 offen offset:3072
    s_mov_b32 s8, s42
    s_and_b32 s9, s43, 0xffff
    s_mov_b32 s10, 1572864
    s_mov_b32 s11, 0x20000
    s_mov_b32 s28, s60
    s_and_b32 s29, s61, 0xffff
    s_mov_b32 s30, 18874368
    s_mov_b32 s31, 0x20000
    s_lshl_b32 s80, s2, 2
    s_add_u32 s80, s80, s62
    s_mul_i32 s80, s80, 1536
    s_mov_b64 exec, 0xfff
    buffer_load_dword v58, v57, s[8:11], s80 offen
    s_mov_b64 exec, -1
    s_mov_b32 s12, s44
    s_and_b32 s13, s45, 0xffff
    s_mov_b32 s14, 524288
    s_mov_b32 s15, 0x20000
    s_mov_b32 s20, s52
    s_and_b32 s21, s53, 0xffff
    s_mov_b32 s22, 1835008
    s_mov_b32 s23, 0x20000
    s_mov_b32 s24, s56
    s_and_b32 s25, s57, 0xffff
    s_mov_b32 s26, 2097152
    s_mov_b32 s27, 0x20000
    s_mov_b32 s32, s50
    s_and_b32 s33, s51, 0xffff
    s_mov_b32 s34, 3584
    s_mov_b32 s35, 0x20000
    s_mov_b32 s36, s54
    s_and_b32 s37, s55, 0xffff
    s_mov_b32 s38, 1024
    s_mov_b32 s39, 0x20000
    s_mov_b32 s16, s48
    s_and_b32 s17, s49, 0xffff
    s_mov_b32 s18, 1835008
    s_mov_b32 s19, 0x20000
    s_mov_b32 s92, s58
    s_and_b32 s93, s59, 0xffff
    s_mov_b32 s94, 256
    s_mov_b32 s95, 0x20000
    s_lshl_b32 s74, s2, 2
    s_add_u32 s74, s74, s62
    s_cmp_eq_u32 s74, 0
    s_cbranch_scc0 L_epoch_done
    s_load_dword s70, s[60:61], 0
    s_waitcnt lgkmcnt(0)
    s_add_u32 s70, s70, 0x9e3779b8
    s_or_b32 s70, s70, 1
    v_mov_b32 v7, s70
    s_mov_b64 exec, 1
    buffer_store_dword v7, v6, s[92:95], 0 offen sc1
    buffer_store_dword v7, v6, s[28:31], 0 offen sc1
    s_mov_b64 exec, -1
L_epoch_done:
    s_and_b32 s74, s62, 1
    s_mul_i32 s74, s74, 98304
    s_lshr_b32 s75, s62, 1
    s_lshl_b32 s75, s75, 10
    s_cmp_lt_u32 s62, 2
    s_cselect_b32 s76, s85, s86
    s_lshl_b32 s76, s76, 7
    s_add_u32 s40, s74, s75
    s_add_u32 s40, s40, s76
    s_add_u32 s40, s40, 1024
    s_lshl_b32 s76, s64, 7
    s_lshl_b32 s41, s62, 12
    s_add_u32 s41, s41, 65536
    s_mul_i32 s74, s62, 49152
    s_add_u32 s42, s74, s76
    s_lshl_b32 s43, s62, 11
    s_add_u32 s43, s43, 98304
    v_mov_b32 v24, 0x3f803f80
    v_mov_b32 v25, 0x00003f80
    v_mov_b32 v48, 0x3f800000
    v_bfe_u32 v27, v0, 2, 2
    v_and_b32 v2, 3, v0
    v_lshlrev_b32 v2, 3, v2
    v_bfe_u32 v3, v0, 4, 1
    v_lshl_add_u32 v26, v3, 5, v2
    v_lshrrev_b32 v2, 5, v0
    v_lshl_add_u32 v2, v2, 3, v27
    v_lshl_add_u32 v2, v2, 7, v26
    v_lshrrev_b32 v3, 1, v27
    s_lshr_b32 s74, s62, 1
    v_xor_b32 v3, s74, v3
    v_lshl_add_u32 v2, v3, 6, v2
    v_add_u32 v61, 65536, v2
    v_add_u32 v62, 131072, v2
    v_add_u32 v164, 98304, v2
    v_add_u32 v165, 131072, v2
    v_lshrrev_b32 v2, 5, v0
    v_and_b32 v3, 31, v0
    v_xor_b32 v3, v3, v2
    v_lshlrev_b32 v3, 4, v3
    v_lshl_add_u32 v3, v2, 9, v3
    s_and_b32 s74, s62, 1
    s_lshl_b32 s74, s74, 15
    v_add_u32 v3, s74, v3
    v_xor_b32 v160, 0, v3
    v_xor_b32 v161, 32, v3
    v_xor_b32 v162, 64, v3
    v_xor_b32 v163, 96, v3
    v_lshrrev_b32 v2, 3, v0
    v_and_b32 v3, 7, v0
    v_lshlrev_b32 v3, 4, v3
    v_lshl_add_u32 v17, v2, 10, v3
    s_lshl_b32 s74, s65, 16
    s_lshl_b32 s75, s62, 13
    s_add_u32 s74, s74, s75
    s_lshl_b32 s75, s66, 7
    s_add_u32 s44, s74, s75
    s_add_u32 s76, s44, 32768
    v_mov_b32 v166, v3
    s_mov_b32 s45, s76
    s_mov_b32 s46, s75
    v_and_b32 v167, 31, v0
    v_lshlrev_b32 v167, 1, v167
    s_lshl_b32 s74, s68, 8
    s_lshl_b32 s75, s62, 6
    s_add_u32 s47, s74, s75
    s_getpc_b64 s[48:49]
L_pcref:
    s_lshl_b32 s74, s73, 2
    s_add_u32 s74, s74, s62
    s_lshl_b32 s74, s74, 9
    v_lshl_add_u32 v51, v0, 7, s74
    v_min_u32 v51, L_codeend-L_pcref-4, v51
    s_and_b32 s74, s62, 1
    s_lshl_b32 s75, s63, 1
    s_add_u32 s74, s74, s75
    s_lshl_b32 s74, s74, 5
    s_and_b32 s76, s62, 2
    s_add_u32 s74, s74, s76
    s_lshl_b32 s75, s85, 2
    s_add_u32 s75, s74, s75
    s_lshl_b32 s75, s75, 10
    s_add_u32 s50, s75, 1048576
    s_lshl_b32 s75, s86, 2
    s_add_u32 s75, s74, s75
    s_lshl_b32 s75, s75, 10
    s_add_u32 s51, s75, 3145728
    v_and_b32 v2, 15, v0
    v_lshlrev_b32 v2, 4, v2
    v_lshrrev_b32 v3, 5, v0
    v_lshl_add_u32 v2, v3, 8, v2
    v_bfe_u32 v3, v0, 4, 1
    v_lshl_add_u32 v204, v3, 10, v2
    s_lshl_b32 s74, s64, 5
    s_add_u32 s74, s74, s63
    s_lshl_b32 s74, s74, 2
    s_add_u32 s74, s74, s62
    s_lshl_b32 s74, s74, 2
    s_add_u32 s52, s74, 4096
    s_lshl_b32 s74, s62, 17
    s_lshl_b32 s75, s66, 7
    s_add_u32 s53, s74, s75
    s_lshl_b32 s54, s62, 13
    s_mul_i32 s74, s62, 114688
    s_lshl_b32 s75, s68, 8
    s_add_u32 s55, s74, s75
    v_lshrrev_b32 v2, 4, v0
    v_lshlrev_b32 v3, 2, v2
    v_and_b32 v4, 15, v0
    v_xor_b32 v3, v3, v4
    v_lshlrev_b32 v3, 4, v3
    v_mul_u32_u24 v208, 3584, v2
    v_add_u32 v208, v208, v3
    v_add_u32 v209, 13312, v208
    v_mul_u32_u24 v208, s69, v208
    v_mul_u32_u24 v209, s69, v209
    s_sub_u32 s75, s64, 1
    s_and_b32 s75, s75, 3
    s_andn2_b32 s77, s64, 3
    s_or_b32 s75, s77, s75
    s_lshl_b32 s75, s75, 9
    s_sub_u32 s76, s64, 2
    s_and_b32 s76, s76, 3
    s_andn2_b32 s77, s64, 3
    s_or_b32 s76, s77, s76
    s_lshl_b32 s76, s76, 9
    v_min_u32 v2, 39, v0
    v_subrev_u32 v3, 20, v2
    v_cmp_gt_u32 vcc, 20, v2
    s_lshl_b32 s74, s63, 2
    s_sub_u32 s74, s74, 16
    v_cndmask_b32 v2, v3, v2, vcc
    v_mov_b32 v3, s76
    v_mov_b32 v4, s75
    v_add_u32 v2, s74, v2
    v_max_i32 v2, 0, v2
    v_cndmask_b32 v3, v3, v4, vcc
    v_lshl_add_u32 v9, v2, 2, v3
    s_mov_b32 s60, 4096
    v_and_b32 v2, 15, v0
    v_lshlrev_b32 v2, 4, v2
    v_lshrrev_b32 v3, 5, v0
    v_lshl_add_u32 v206, v3, 8, v2
    v_add_u32 v206, 3145728, v206
    v_add_u32 v207, 1048576, v1
    s_and_b32 s74, s62, 2
    s_lshl_b32 s74, s74, 11
    s_and_b32 s75, s62, 1
    s_lshl_b32 s75, s75, 10
    s_add_u32 s74, s74, s75
    v_add_u32 v200, s74, v1
    s_lshl_b32 s74, s62, 11
    v_add_u32 v201, s74, v1
    v_add_u32 v200, 98304, v200
    v_add_u32 v201, 98304, v201
    v_mov_b32 v4, 0x3f803f80
    v_accvgpr_write_b32 a40, v4
    v_accvgpr_write_b32 a41, v4
    buffer_load_dwordx4 v[96:99], v1, s[4:7], s89 offen offset:0
    buffer_load_dwordx4 v[100:103], v1, s[4:7], s89 offen offset:1024
    buffer_load_dwordx4 v[104:107], v1, s[4:7], s89 offen offset:2048
    buffer_load_dwordx4 v[108:111], v1, s[4:7], s89 offen offset:3072
    buffer_load_dwordx4 v[112:115], v1, s[4:7], s90 offen offset:0
    buffer_load_dwordx4 v[116:119], v1, s[4:7], s90 offen offset:1024
    buffer_load_dwordx4 v[120:123], v1, s[4:7], s90 offen offset:2048
    buffer_load_dwordx4 v[124:127], v1, s[4:7], s90 offen offset:3072
    buffer_load_dwordx4 v[36:39], v166, s[36:39], s46 offen
    buffer_load_ushort v42, v167, s[32:35], s47 offen
    v_accvgpr_write_b32 a42, v4
    v_accvgpr_write_b32 a43, v4
    v_accvgpr_write_b32 a44, v4
    v_accvgpr_write_b32 a45, v4
    v_accvgpr_write_b32 a46, v4
    v_accvgpr_write_b32 a47, v4
    v_accvgpr_write_b32 a48, v4
    v_accvgpr_write_b32 a49, v4
    v_accvgpr_write_b32 a50, v4
    v_accvgpr_write_b32 a51, v4
    v_accvgpr_write_b32 a52, v4
    v_accvgpr_write_b32 a53, v4
    v_accvgpr_write_b32 a54, v4
    v_accvgpr_write_b32 a55, v4
    v_accvgpr_write_b32 a56, v4
    v_accvgpr_write_b32 a57, v4
    v_accvgpr_write_b32 a58, v4
    v_accvgpr_write_b32 a59, v4
    v_accvgpr_write_b32 a60, v4
    v_accvgpr_write_b32 a61, v4
    v_accvgpr_write_b32 a62, v4
    v_accvgpr_write_b32 a63, v4
    v_accvgpr_write_b32 a64, v4
    v_accvgpr_write_b32 a65, v4
    v_accvgpr_write_b32 a66, v4
    v_accvgpr_write_b32 a67, v4
    v_accvgpr_write_b32 a68, v4
    v_accvgpr_write_b32 a69, v4
    v_accvgpr_write_b32 a70, v4
    v_accvgpr_write_b32 a71, v4
    v_accvgpr_write_b32 a72, v4
    v_accvgpr_write_b32 a73, v4
    v_accvgpr_write_b32 a74, v4
    v_accvgpr_write_b32 a75, v4
    v_accvgpr_write_b32 a76, v4
    v_accvgpr_write_b32 a77, v4
    v_accvgpr_write_b32 a78, v4
    v_accvgpr_write_b32 a79, v4
    v_accvgpr_write_b32 a80, v4
    v_accvgpr_write_b32 a81, v4
    v_accvgpr_write_b32 a82, v4
    v_accvgpr_write_b32 a83, v4
    v_accvgpr_write_b32 a84, v4
    v_accvgpr_write_b32 a85, v4
    v_accvgpr_write_b32 a86, v4
    v_accvgpr_write_b32 a87, v4
    v_accvgpr_write_b32 a88, v4
    v_accvgpr_write_b32 a89, v4
    v_accvgpr_write_b32 a90, v4
    v_accvgpr_write_b32 a91, v4
    v_accvgpr_write_b32 a92, v4
    v_accvgpr_write_b32 a93, v4
    v_accvgpr_write_b32 a94, v4
    v_accvgpr_write_b32 a95, v4
    v_accvgpr_write_b32 a96, v4
    v_accvgpr_write_b32 a97, v4
    v_accvgpr_write_b32 a98, v4
    v_accvgpr_write_b32 a99, v4
    v_accvgpr_write_b32 a100, v4
    v_accvgpr_write_b32 a101, v4
    v_accvgpr_write_b32 a102, v4
    v_accvgpr_write_b32 a103, v4
    v_accvgpr_write_b32 a104, v4
    v_accvgpr_write_b32 a105, v4
    v_accvgpr_write_b32 a106, v4
    v_accvgpr_write_b32 a107, v4
    v_accvgpr_write_b32 a108, v4
    v_accvgpr_write_b32 a109, v4
    v_accvgpr_write_b32 a110, v4
    v_accvgpr_write_b32 a111, v4
    v_accvgpr_write_b32 a112, v4
    v_accvgpr_write_b32 a113, v4
    v_accvgpr_write_b32 a114, v4
    v_accvgpr_write_b32 a115, v4
    v_accvgpr_write_b32 a116, v4
    v_accvgpr_write_b32 a117, v4
    v_accvgpr_write_b32 a118, v4
    v_accvgpr_write_b32 a119, v4
    v_and_b32 v2, 31, v0
    v_lshrrev_b32 v3, 5, v0
    v_lshlrev_b32 v3, 2, v3
    v_sub_u32 v2, v2, v3
    v_mov_b32 v8, 0xff800000
    v_cmp_le_i32 s[72:73], 0, v2
    v_cmp_le_i32 s[74:75], 1, v2
    v_cmp_le_i32 s[76:77], 2, v2
    v_cmp_le_i32 s[78:79], 3, v2
    v_cndmask_b32 v224, v8, v6, s[72:73]
    v_cndmask_b32 v240, v6, v8, s[72:73]
    v_cndmask_b32 v225, v8, v6, s[74:75]
    v_cndmask_b32 v241, v6, v8, s[74:75]
    v_cndmask_b32 v226, v8, v6, s[76:77]
    v_cndmask_b32 v242, v6, v8, s[76:77]
    v_cndmask_b32 v227, v8, v6, s[78:79]
    v_cndmask_b32 v243, v6, v8, s[78:79]
    v_cmp_le_i32 s[72:73], 8, v2
    v_cmp_le_i32 s[74:75], 9, v2
    v_cmp_le_i32 s[76:77], 10, v2
    v_cmp_le_i32 s[78:79], 11, v2
    v_cndmask_b32 v228, v8, v6, s[72:73]
    v_cndmask_b32 v244, v6, v8, s[72:73]
    v_cndmask_b32 v229, v8, v6, s[74:75]
    v_cndmask_b32 v245, v6, v8, s[74:75]
    v_cndmask_b32 v230, v8, v6, s[76:77]
    v_cndmask_b32 v246, v6, v8, s[76:77]
    v_cndmask_b32 v231, v8, v6, s[78:79]
    v_cndmask_b32 v247, v6, v8, s[78:79]
    v_cmp_le_i32 s[72:73], 16, v2
    v_cmp_le_i32 s[74:75], 17, v2
    v_cmp_le_i32 s[76:77], 18, v2
    v_cmp_le_i32 s[78:79], 19, v2
    v_cndmask_b32 v232, v8, v6, s[72:73]
    v_cndmask_b32 v248, v6, v8, s[72:73]
    v_cndmask_b32 v233, v8, v6, s[74:75]
    v_cndmask_b32 v249, v6, v8, s[74:75]
    v_cndmask_b32 v234, v8, v6, s[76:77]
    v_cndmask_b32 v250, v6, v8, s[76:77]
    v_cndmask_b32 v235, v8, v6, s[78:79]
    v_cndmask_b32 v251, v6, v8, s[78:79]
    v_cmp_le_i32 s[72:73], 24, v2
    v_cmp_le_i32 s[74:75], 25, v2
    v_cmp_le_i32 s[76:77], 26, v2
    v_cmp_le_i32 s[78:79], 27, v2
    v_cndmask_b32 v236, v8, v6, s[72:73]
    v_cndmask_b32 v252, v6, v8, s[72:73]
    v_cndmask_b32 v237, v8, v6, s[74:75]
    v_cndmask_b32 v253, v6, v8, s[74:75]
    v_cndmask_b32 v238, v8, v6, s[76:77]
    v_cndmask_b32 v254, v6, v8, s[76:77]
    v_cndmask_b32 v239, v8, v6, s[78:79]
    v_cndmask_b32 v255, v6, v8, s[78:79]
    v_cmp_gt_u32 s[72:73], 32, v0
    v_mov_b32 v4, 0x3f80
    v_mov_b32 v213, 0
    v_mov_b32 v214, 0
    v_mov_b32 v215, 0
    v_mov_b32 v217, 0
    v_mov_b32 v218, 0
    v_mov_b32 v219, 0
    v_mov_b32 v221, 0
    v_mov_b32 v222, 0
    v_mov_b32 v223, 0
    v_cndmask_b32 v212, v6, v4, s[72:73]
    v_lshrrev_b32 v2, 5, v0
    v_lshl_add_u32 v2, v2, 2, v27
    v_lshl_add_u32 v2, v2, 7, v26
    v_lshrrev_b32 v3, 1, v27
    v_lshl_add_u32 v2, v3, 6, v2
    v_add_u32 v15, s54, v2
    v_xor_b32 v16, 64, v15
    v_add_u32 v44, 65536, v15
    v_add_u32 v45, 65536, v16
    s_mul_i32 s74, s62, 458752
    s_lshl_b32 s75, s66, 7
    s_add_u32 s56, s74, s75
    s_lshl_b32 s74, s63, 6
    s_lshl_b32 s75, s64, 2
    s_add_u32 s75, s75, s62
    s_add_u32 s74, s74, s75
    s_lshl_b32 s74, s74, 10
    s_add_u32 s57, s74, 5242880
    s_lshl_b32 s74, s63, 5
    s_add_u32 s74, s74, s75
    s_lshl_b32 s74, s74, 2
    s_add_u32 s58, s74, 8192
    s_lshl_b32 s74, s65, 7
    s_lshl_b32 s75, s62, 5
    s_add_u32 s74, s74, s75
    s_add_u32 s59, s74, 8192
    v_and_b32 v2, 7, v0
    v_lshlrev_b32 v2, 9, v2
    v_lshrrev_b32 v3, 3, v0
    v_lshl_add_u32 v52, v3, 4, v2
    v_lshlrev_b32 v10, 4, v3
    v_and_b32 v2, 31, v0
    v_lshrrev_b32 v3, 5, v0
    v_and_b32 v4, 7, v0
    v_xor_b32 v3, v3, v4
    v_lshlrev_b32 v3, 4, v3
    v_lshl_add_u32 v2, v2, 8, v3
    v_add_u32 v20, s54, v2
    v_lshrrev_b32 v2, 3, v0
    v_lshlrev_b32 v4, 1, v4
    v_xor_b32 v4, v4, v2
    v_lshlrev_b32 v4, 4, v4
    v_lshl_add_u32 v2, v2, 8, v4
    s_lshl_b32 s75, s62, 11
    v_add_u32 v18, s75, v2
    v_xor_b32 v19, 16, v18
    v_xor_b32 v21, 32, v20
    v_xor_b32 v22, 64, v20
    v_xor_b32 v23, 96, v20
    v_lshrrev_b32 v2, 5, v0
    v_lshl_add_u32 v2, v2, 3, v27
    v_lshl_add_u32 v2, v2, 8, v26
    v_xor_b32 v3, s62, v27
    v_lshl_add_u32 v2, v3, 6, v2
    v_add_u32 v49, 32768, v2
    v_add_u32 v50, 98304, v2
    v_add_u32 v46, 131072, v15
    v_add_u32 v47, 131072, v16
    s_waitcnt vmcnt(18)
    v_dot2_f32_bf16 v128, v64, v24, 0
    v_dot2_f32_bf16 v144, v64, v64, 0
    s_waitcnt vmcnt(17)
    v_dot2_f32_bf16 v129, v68, v24, 0
    v_dot2_f32_bf16 v145, v68, v68, 0
    v_dot2_f32_bf16 v128, v65, v24, v128
    v_dot2_f32_bf16 v144, v65, v65, v144
    v_dot2_f32_bf16 v129, v69, v24, v129
    v_dot2_f32_bf16 v145, v69, v69, v145
    s_add_u32 m0, s41, 0
    s_add_u32 s78, s40, 0
    buffer_load_dwordx4 v53, s[8:11], s78 offen offset:0 lds
    v_dot2_f32_bf16 v128, v66, v24, v128
    v_dot2_f32_bf16 v144, v66, v66, v144
    v_dot2_f32_bf16 v129, v70, v24, v129
    v_dot2_f32_bf16 v145, v70, v70, v145
    v_dot2_f32_bf16 v128, v67, v24, v128
    v_dot2_f32_bf16 v144, v67, v67, v144
    v_dot2_f32_bf16 v129, v71, v24, v129
    v_dot2_f32_bf16 v145, v71, v71, v145
    buffer_load_dwordx4 v54, s[8:11], s78 offen offset:1024 lds
    s_waitcnt vmcnt(18)
    v_dot2_f32_bf16 v130, v72, v24, 0
    v_dot2_f32_bf16 v146, v72, v72, 0
    s_waitcnt vmcnt(17)
    v_dot2_f32_bf16 v131, v76, v24, 0
    v_dot2_f32_bf16 v147, v76, v76, 0
    v_dot2_f32_bf16 v130, v73, v24, v130
    v_dot2_f32_bf16 v146, v73, v73, v146
    v_dot2_f32_bf16 v131, v77, v24, v131
    v_dot2_f32_bf16 v147, v77, v77, v147
    buffer_load_dwordx4 v55, s[8:11], s78 offen offset:2048 lds
    v_dot2_f32_bf16 v130, v74, v24, v130
    v_dot2_f32_bf16 v146, v74, v74, v146
    v_dot2_f32_bf16 v131, v78, v24, v131
    v_dot2_f32_bf16 v147, v78, v78, v147
    v_dot2_f32_bf16 v130, v75, v24, v130
    v_dot2_f32_bf16 v146, v75, v75, v146
    v_dot2_f32_bf16 v131, v79, v24, v131
    v_dot2_f32_bf16 v147, v79, v79, v147
    buffer_load_dwordx4 v56, s[8:11], s78 offen offset:3072 lds
    s_waitcnt vmcnt(18)
    v_dot2_f32_bf16 v132, v80, v24, 0
    v_dot2_f32_bf16 v148, v80, v80, 0
    s_waitcnt vmcnt(17)
    v_dot2_f32_bf16 v133, v84, v24, 0
    v_dot2_f32_bf16 v149, v84, v84, 0
    v_dot2_f32_bf16 v132, v81, v24, v132
    v_dot2_f32_bf16 v148, v81, v81, v148
    v_dot2_f32_bf16 v133, v85, v24, v133
    v_dot2_f32_bf16 v149, v85, v85, v149
    s_add_u32 m0, s41, 16384
    s_add_u32 s78, s40, 196608
    buffer_load_dwordx4 v53, s[8:11], s78 offen offset:0 lds
    v_dot2_f32_bf16 v132, v82, v24, v132
    v_dot2_f32_bf16 v148, v82, v82, v148
    v_dot2_f32_bf16 v133, v86, v24, v133
    v_dot2_f32_bf16 v149, v86, v86, v149
    v_dot2_f32_bf16 v132, v83, v24, v132
    v_dot2_f32_bf16 v148, v83, v83, v148
    v_dot2_f32_bf16 v133, v87, v24, v133
    v_dot2_f32_bf16 v149, v87, v87, v149
    buffer_load_dwordx4 v54, s[8:11], s78 offen offset:1024 lds
    s_waitcnt vmcnt(18)
    v_dot2_f32_bf16 v134, v88, v24, 0
    v_dot2_f32_bf16 v150, v88, v88, 0
    s_waitcnt vmcnt(17)
    v_dot2_f32_bf16 v135, v92, v24, 0
    v_dot2_f32_bf16 v151, v92, v92, 0
    v_dot2_f32_bf16 v134, v89, v24, v134
    v_dot2_f32_bf16 v150, v89, v89, v150
    v_dot2_f32_bf16 v135, v93, v24, v135
    v_dot2_f32_bf16 v151, v93, v93, v151
    buffer_load_dwordx4 v55, s[8:11], s78 offen offset:2048 lds
    v_dot2_f32_bf16 v134, v90, v24, v134
    v_dot2_f32_bf16 v150, v90, v90, v150
    v_dot2_f32_bf16 v135, v94, v24, v135
    v_dot2_f32_bf16 v151, v94, v94, v151
    v_dot2_f32_bf16 v134, v91, v24, v134
    v_dot2_f32_bf16 v150, v91, v91, v150
    v_dot2_f32_bf16 v135, v95, v24, v135
    v_dot2_f32_bf16 v151, v95, v95, v151
    buffer_load_dwordx4 v56, s[8:11], s78 offen offset:3072 lds
    s_waitcnt vmcnt(17)
    v_dot2_f32_bf16 v136, v96, v24, 0
    v_dot2_f32_bf16 v152, v96, v96, 0
    s_waitcnt vmcnt(16)
    v_dot2_f32_bf16 v137, v100, v24, 0
    v_dot2_f32_bf16 v153, v100, v100, 0
    v_dot2_f32_bf16 v136, v97, v24, v136
    v_dot2_f32_bf16 v152, v97, v97, v152
    v_dot2_f32_bf16 v137, v101, v24, v137
    v_dot2_f32_bf16 v153, v101, v101, v153
    s_mov_b64 exec, 15
    global_load_dword v58, v51, s[48:49]
    s_mov_b64 exec, -1
    v_dot2_f32_bf16 v136, v98, v24, v136
    v_dot2_f32_bf16 v152, v98, v98, v152
    v_dot2_f32_bf16 v137, v102, v24, v137
    v_dot2_f32_bf16 v153, v102, v102, v153
    v_dot2_f32_bf16 v136, v99, v24, v136
    v_dot2_f32_bf16 v152, v99, v99, v152
    v_dot2_f32_bf16 v137, v103, v24, v137
    v_dot2_f32_bf16 v153, v103, v103, v153
    s_add_u32 m0, s41, 32768
    s_add_u32 s78, s40, 393216
    buffer_load_dwordx4 v53, s[8:11], s78 offen offset:0 lds
    s_waitcnt vmcnt(17)
    v_dot2_f32_bf16 v138, v104, v24, 0
    v_dot2_f32_bf16 v154, v104, v104, 0
    s_waitcnt vmcnt(16)
    v_dot2_f32_bf16 v139, v108, v24, 0
    v_dot2_f32_bf16 v155, v108, v108, 0
    v_dot2_f32_bf16 v138, v105, v24, v138
    v_dot2_f32_bf16 v154, v105, v105, v154
    v_dot2_f32_bf16 v139, v109, v24, v139
    v_dot2_f32_bf16 v155, v109, v109, v155
    buffer_load_dwordx4 v54, s[8:11], s78 offen offset:1024 lds
    v_dot2_f32_bf16 v138, v106, v24, v138
    v_dot2_f32_bf16 v154, v106, v106, v154
    v_dot2_f32_bf16 v139, v110, v24, v139
    v_dot2_f32_bf16 v155, v110, v110, v155
    v_dot2_f32_bf16 v138, v107, v24, v138
    v_dot2_f32_bf16 v154, v107, v107, v154
    v_dot2_f32_bf16 v139, v111, v24, v139
    v_dot2_f32_bf16 v155, v111, v111, v155
    buffer_load_dwordx4 v55, s[8:11], s78 offen offset:2048 lds
    s_waitcnt vmcnt(17)
    v_dot2_f32_bf16 v140, v112, v24, 0
    v_dot2_f32_bf16 v156, v112, v112, 0
    s_waitcnt vmcnt(16)
    v_dot2_f32_bf16 v141, v116, v24, 0
    v_dot2_f32_bf16 v157, v116, v116, 0
    v_dot2_f32_bf16 v140, v113, v24, v140
    v_dot2_f32_bf16 v156, v113, v113, v156
    v_dot2_f32_bf16 v141, v117, v24, v141
    v_dot2_f32_bf16 v157, v117, v117, v157
    buffer_load_dwordx4 v56, s[8:11], s78 offen offset:3072 lds
    v_dot2_f32_bf16 v140, v114, v24, v140
    v_dot2_f32_bf16 v156, v114, v114, v156
    v_dot2_f32_bf16 v141, v118, v24, v141
    v_dot2_f32_bf16 v157, v118, v118, v157
    v_dot2_f32_bf16 v140, v115, v24, v140
    v_dot2_f32_bf16 v156, v115, v115, v156
    v_dot2_f32_bf16 v141, v119, v24, v141
    v_dot2_f32_bf16 v157, v119, v119, v157
    s_add_u32 m0, s41, 49152
    s_add_u32 s78, s40, 589824
    buffer_load_dwordx4 v53, s[8:11], s78 offen offset:0 lds
    s_waitcnt vmcnt(17)
    v_dot2_f32_bf16 v142, v120, v24, 0
    v_dot2_f32_bf16 v158, v120, v120, 0
    s_waitcnt vmcnt(16)
    v_dot2_f32_bf16 v143, v124, v24, 0
    v_dot2_f32_bf16 v159, v124, v124, 0
    v_dot2_f32_bf16 v142, v121, v24, v142
    v_dot2_f32_bf16 v158, v121, v121, v158
    v_dot2_f32_bf16 v143, v125, v24, v143
    v_dot2_f32_bf16 v159, v125, v125, v159
    buffer_load_dwordx4 v54, s[8:11], s78 offen offset:1024 lds
    v_dot2_f32_bf16 v142, v122, v24, v142
    v_dot2_f32_bf16 v158, v122, v122, v158
    v_dot2_f32_bf16 v143, v126, v24, v143
    v_dot2_f32_bf16 v159, v126, v126, v159
    v_dot2_f32_bf16 v142, v123, v24, v142
    v_dot2_f32_bf16 v158, v123, v123, v158
    v_dot2_f32_bf16 v143, v127, v24, v143
    v_dot2_f32_bf16 v159, v127, v127, v159
    buffer_load_dwordx4 v55, s[8:11], s78 offen offset:2048 lds
    v_permlane32_swap_b32 v128, v136
    v_permlane32_swap_b32 v129, v137
    v_permlane32_swap_b32 v130, v138
    v_permlane32_swap_b32 v131, v139
    v_permlane32_swap_b32 v132, v140
    v_permlane32_swap_b32 v133, v141
    v_permlane32_swap_b32 v134, v142
    v_permlane32_swap_b32 v135, v143
    v_permlane32_swap_b32 v144, v152
    v_permlane32_swap_b32 v145, v153
    v_permlane32_swap_b32 v146, v154
    v_permlane32_swap_b32 v147, v155
    v_permlane32_swap_b32 v148, v156
    v_permlane32_swap_b32 v149, v157
    v_permlane32_swap_b32 v150, v158
    v_permlane32_swap_b32 v151, v159
    buffer_load_dwordx4 v56, s[8:11], s78 offen offset:3072 lds
    s_lshl_b32 s80, s2, 2
    s_add_u32 s80, s80, s62
    s_mul_i32 s80, s80, 1792
    s_mov_b64 exec, 0x3fff
    buffer_load_dword v58, v57, s[16:19], s80 offen
    s_mov_b64 exec, -1
    v_add_f32 v128, v128, v136
    v_add_f32 v129, v129, v137
    v_add_f32 v130, v130, v138
    v_add_f32 v131, v131, v139
    v_add_f32 v132, v132, v140
    v_add_f32 v133, v133, v141
    v_add_f32 v134, v134, v142
    v_add_f32 v135, v135, v143
    v_add_f32 v144, v144, v152
    v_add_f32 v145, v145, v153
    v_add_f32 v146, v146, v154
    v_add_f32 v147, v147, v155
    v_add_f32 v148, v148, v156
    v_add_f32 v149, v149, v157
    v_add_f32 v150, v150, v158
    v_add_f32 v151, v151, v159
    s_add_u32 m0, s41, 65536
    s_add_u32 s78, s40, 786432
    buffer_load_dwordx4 v53, s[8:11], s78 offen offset:0 lds
    v_permlane16_swap_b32 v128, v132
    v_permlane16_swap_b32 v129, v133
    v_permlane16_swap_b32 v130, v134
    v_permlane16_swap_b32 v131, v135
    v_permlane16_swap_b32 v144, v148
    v_permlane16_swap_b32 v145, v149
    v_permlane16_swap_b32 v146, v150
    v_permlane16_swap_b32 v147, v151
    v_add_f32 v128, v128, v132
    v_add_f32 v129, v129, v133
    v_add_f32 v130, v130, v134
    v_add_f32 v131, v131, v135
    v_add_f32 v144, v144, v148
    v_add_f32 v145, v145, v149
    v_add_f32 v146, v146, v150
    v_add_f32 v147, v147, v151
    buffer_load_dwordx4 v54, s[8:11], s78 offen offset:1024 lds
    v_add_f32_dpp v136, v128, v128 row_ror:8 row_mask:0xf bank_mask:0x3
    v_add_f32_dpp v137, v129, v129 row_ror:8 row_mask:0xf bank_mask:0x3
    v_add_f32_dpp v152, v144, v144 row_ror:8 row_mask:0xf bank_mask:0x3
    v_add_f32_dpp v153, v145, v145 row_ror:8 row_mask:0xf bank_mask:0x3
    v_add_f32_dpp v136, v130, v130 row_ror:8 row_mask:0xf bank_mask:0xc
    v_add_f32_dpp v137, v131, v131 row_ror:8 row_mask:0xf bank_mask:0xc
    v_add_f32_dpp v152, v146, v146 row_ror:8 row_mask:0xf bank_mask:0xc
    v_add_f32_dpp v153, v147, v147 row_ror:8 row_mask:0xf bank_mask:0xc
    v_add_f32_dpp v138, v136, v136 row_half_mirror row_mask:0xf bank_mask:0x5
    v_add_f32_dpp v154, v152, v152 row_half_mirror row_mask:0xf bank_mask:0x5
    s_nop 0
    v_add_f32_dpp v138, v137, v137 row_half_mirror row_mask:0xf bank_mask:0xa
    v_add_f32_dpp v154, v153, v153 row_half_mirror row_mask:0xf bank_mask:0xa
    s_nop 0
    v_add_f32_dpp v139, v138, v138 quad_perm:[1,0,3,2] row_mask:0xf bank_mask:0xf
    v_add_f32_dpp v155, v154, v154 quad_perm:[1,0,3,2] row_mask:0xf bank_mask:0xf
    s_nop 0
    v_add_f32_dpp v140, v139, v139 quad_perm:[2,3,0,1] row_mask:0xf bank_mask:0xf
    v_add_f32_dpp v156, v155, v155 quad_perm:[2,3,0,1] row_mask:0xf bank_mask:0xf
    v_mul_f32 v128, 0x3b000000, v140
    v_mul_f32 v144, 0x3b000000, v156
    v_fma_f32 v129, -v128, v128, v144
    v_max_f32 v129, 0, v129
    v_cvt_pk_bf16_f32 v131, v128, v129
    v_lshlrev_b32 v128, 16, v131
    v_and_b32 v129, 0xffff0000, v131
    v_add_f32 v129, 0x3727c5ac, v129
    v_cvt_pk_bf16_f32 v131, v129, v129
    v_lshlrev_b32 v129, 16, v131
    v_sqrt_f32 v129, v129
    s_nop 0
    v_cvt_pk_bf16_f32 v131, v129, v129
    v_lshlrev_b32 v129, 16, v131
    v_rcp_f32 v130, v129
    v_sub_f32 v128, 0, v128
    v_and_b32 v2, 7, v0
    v_lshlrev_b32 v2, 4, v2
    v_lshl_add_u32 v2, v0, 9, v2
    s_lshr_b32 s74, s62, 1
    s_lshl_b32 s74, s74, 15
    s_and_b32 s75, s62, 1
    s_lshl_b32 s75, s75, 8
    s_add_u32 s74, s74, s75
    s_and_b32 s75, s2, 64
    s_lshl_b32 s75, s75, 1
    s_add_u32 s74, s74, s75
    v_add_u32 v2, s74, v2
    v_readlane_b32 s96, v128, 0
    v_readlane_b32 s98, v130, 0
    v_readlane_b32 s97, v128, 4
    v_readlane_b32 s100, v130, 4
    v_xor_b32 v168, 0, v2
    v_dot2_f32_bf16 v170, v64, v25, s96
    v_dot2_f32_bf16 v171, v64, v48, s96
    v_dot2_f32_bf16 v172, v65, v25, s96
    v_dot2_f32_bf16 v173, v65, v48, s96
    v_dot2_f32_bf16 v174, v66, v25, s96
    v_dot2_f32_bf16 v175, v66, v48, s96
    v_dot2_f32_bf16 v176, v67, v25, s96
    v_dot2_f32_bf16 v177, v67, v48, s96
    v_pk_mul_f32 v[170:171], v[170:171], s[98:99] op_sel_hi:[1,0]
    v_pk_mul_f32 v[172:173], v[172:173], s[98:99] op_sel_hi:[1,0]
    v_pk_mul_f32 v[174:175], v[174:175], s[98:99] op_sel_hi:[1,0]
    v_pk_mul_f32 v[176:177], v[176:177], s[98:99] op_sel_hi:[1,0]
    v_cvt_pk_bf16_f32 v64, v170, v171
    v_cvt_pk_bf16_f32 v65, v172, v173
    v_cvt_pk_bf16_f32 v66, v174, v175
    v_cvt_pk_bf16_f32 v67, v176, v177
    ds_write_b128 v168, v[64:67] offset:0
    buffer_load_dwordx4 v55, s[8:11], s78 offen offset:2048 lds
    v_readlane_b32 s96, v128, 8
    v_readlane_b32 s98, v130, 8
    v_xor_b32 v169, 16, v2
    v_dot2_f32_bf16 v170, v68, v25, s97
    v_dot2_f32_bf16 v171, v68, v48, s97
    v_dot2_f32_bf16 v172, v69, v25, s97
    v_dot2_f32_bf16 v173, v69, v48, s97
    v_dot2_f32_bf16 v174, v70, v25, s97
    v_dot2_f32_bf16 v175, v70, v48, s97
    v_dot2_f32_bf16 v176, v71, v25, s97
    v_dot2_f32_bf16 v177, v71, v48, s97
    v_pk_mul_f32 v[170:171], v[170:171], s[100:101] op_sel_hi:[1,0]
    v_pk_mul_f32 v[172:173], v[172:173], s[100:101] op_sel_hi:[1,0]
    v_pk_mul_f32 v[174:175], v[174:175], s[100:101] op_sel_hi:[1,0]
    v_pk_mul_f32 v[176:177], v[176:177], s[100:101] op_sel_hi:[1,0]
    v_cvt_pk_bf16_f32 v68, v170, v171
    v_cvt_pk_bf16_f32 v69, v172, v173
    v_cvt_pk_bf16_f32 v70, v174, v175
    v_cvt_pk_bf16_f32 v71, v176, v177
    ds_write_b128 v169, v[68:71] offset:0
    buffer_load_dwordx4 v56, s[8:11], s78 offen offset:3072 lds
    v_readlane_b32 s97, v128, 12
    v_readlane_b32 s100, v130, 12
    v_xor_b32 v168, 32, v2
    v_dot2_f32_bf16 v170, v72, v25, s96
    v_dot2_f32_bf16 v171, v72, v48, s96
    v_dot2_f32_bf16 v172, v73, v25, s96
    v_dot2_f32_bf16 v173, v73, v48, s96
    v_dot2_f32_bf16 v174, v74, v25, s96
    v_dot2_f32_bf16 v175, v74, v48, s96
    v_dot2_f32_bf16 v176, v75, v25, s96
    v_dot2_f32_bf16 v177, v75, v48, s96
    v_pk_mul_f32 v[170:171], v[170:171], s[98:99] op_sel_hi:[1,0]
    v_pk_mul_f32 v[172:173], v[172:173], s[98:99] op_sel_hi:[1,0]
    v_pk_mul_f32 v[174:175], v[174:175], s[98:99] op_sel_hi:[1,0]
    v_pk_mul_f32 v[176:177], v[176:177], s[98:99] op_sel_hi:[1,0]
    v_cvt_pk_bf16_f32 v72, v170, v171
    v_cvt_pk_bf16_f32 v73, v172, v173
    v_cvt_pk_bf16_f32 v74, v174, v175
    v_cvt_pk_bf16_f32 v75, v176, v177
    ds_write_b128 v168, v[72:75] offset:0
    s_add_u32 m0, s41, 81920
    s_add_u32 s78, s40, 983040
    buffer_load_dwordx4 v53, s[8:11], s78 offen offset:0 lds
    v_readlane_b32 s96, v128, 16
    v_readlane_b32 s98, v130, 16
    v_xor_b32 v169, 48, v2
    v_dot2_f32_bf16 v170, v76, v25, s97
    v_dot2_f32_bf16 v171, v76, v48, s97
    v_dot2_f32_bf16 v172, v77, v25, s97
    v_dot2_f32_bf16 v173, v77, v48, s97
    v_dot2_f32_bf16 v174, v78, v25, s97
    v_dot2_f32_bf16 v175, v78, v48, s97
    v_dot2_f32_bf16 v176, v79, v25, s97
    v_dot2_f32_bf16 v177, v79, v48, s97
    v_pk_mul_f32 v[170:171], v[170:171], s[100:101] op_sel_hi:[1,0]
    v_pk_mul_f32 v[172:173], v[172:173], s[100:101] op_sel_hi:[1,0]
    v_pk_mul_f32 v[174:175], v[174:175], s[100:101] op_sel_hi:[1,0]
    v_pk_mul_f32 v[176:177], v[176:177], s[100:101] op_sel_hi:[1,0]
    v_cvt_pk_bf16_f32 v76, v170, v171
    v_cvt_pk_bf16_f32 v77, v172, v173
    v_cvt_pk_bf16_f32 v78, v174, v175
    v_cvt_pk_bf16_f32 v79, v176, v177
    ds_write_b128 v169, v[76:79] offset:0
    buffer_load_dwordx4 v54, s[8:11], s78 offen offset:1024 lds
    v_readlane_b32 s97, v128, 20
    v_readlane_b32 s100, v130, 20
    v_xor_b32 v168, 64, v2
    v_dot2_f32_bf16 v170, v80, v25, s96
    v_dot2_f32_bf16 v171, v80, v48, s96
    v_dot2_f32_bf16 v172, v81, v25, s96
    v_dot2_f32_bf16 v173, v81, v48, s96
    v_dot2_f32_bf16 v174, v82, v25, s96
    v_dot2_f32_bf16 v175, v82, v48, s96
    v_dot2_f32_bf16 v176, v83, v25, s96
    v_dot2_f32_bf16 v177, v83, v48, s96
    v_pk_mul_f32 v[170:171], v[170:171], s[98:99] op_sel_hi:[1,0]
    v_pk_mul_f32 v[172:173], v[172:173], s[98:99] op_sel_hi:[1,0]
    v_pk_mul_f32 v[174:175], v[174:175], s[98:99] op_sel_hi:[1,0]
    v_pk_mul_f32 v[176:177], v[176:177], s[98:99] op_sel_hi:[1,0]
    v_cvt_pk_bf16_f32 v80, v170, v171
    v_cvt_pk_bf16_f32 v81, v172, v173
    v_cvt_pk_bf16_f32 v82, v174, v175
    v_cvt_pk_bf16_f32 v83, v176, v177
    ds_write_b128 v168, v[80:83] offset:0
    buffer_load_dwordx4 v55, s[8:11], s78 offen offset:2048 lds
    v_readlane_b32 s96, v128, 24
    v_readlane_b32 s98, v130, 24
    v_xor_b32 v169, 80, v2
    v_dot2_f32_bf16 v170, v84, v25, s97
    v_dot2_f32_bf16 v171, v84, v48, s97
    v_dot2_f32_bf16 v172, v85, v25, s97
    v_dot2_f32_bf16 v173, v85, v48, s97
    v_dot2_f32_bf16 v174, v86, v25, s97
    v_dot2_f32_bf16 v175, v86, v48, s97
    v_dot2_f32_bf16 v176, v87, v25, s97
    v_dot2_f32_bf16 v177, v87, v48, s97
    v_pk_mul_f32 v[170:171], v[170:171], s[100:101] op_sel_hi:[1,0]
    v_pk_mul_f32 v[172:173], v[172:173], s[100:101] op_sel_hi:[1,0]
    v_pk_mul_f32 v[174:175], v[174:175], s[100:101] op_sel_hi:[1,0]
    v_pk_mul_f32 v[176:177], v[176:177], s[100:101] op_sel_hi:[1,0]
    v_cvt_pk_bf16_f32 v84, v170, v171
    v_cvt_pk_bf16_f32 v85, v172, v173
    v_cvt_pk_bf16_f32 v86, v174, v175
    v_cvt_pk_bf16_f32 v87, v176, v177
    ds_write_b128 v169, v[84:87] offset:0
    buffer_load_dwordx4 v56, s[8:11], s78 offen offset:3072 lds
    v_readlane_b32 s97, v128, 28
    v_readlane_b32 s100, v130, 28
    v_xor_b32 v168, 96, v2
    v_dot2_f32_bf16 v170, v88, v25, s96
    v_dot2_f32_bf16 v171, v88, v48, s96
    v_dot2_f32_bf16 v172, v89, v25, s96
    v_dot2_f32_bf16 v173, v89, v48, s96
    v_dot2_f32_bf16 v174, v90, v25, s96
    v_dot2_f32_bf16 v175, v90, v48, s96
    v_dot2_f32_bf16 v176, v91, v25, s96
    v_dot2_f32_bf16 v177, v91, v48, s96
    v_pk_mul_f32 v[170:171], v[170:171], s[98:99] op_sel_hi:[1,0]
    v_pk_mul_f32 v[172:173], v[172:173], s[98:99] op_sel_hi:[1,0]
    v_pk_mul_f32 v[174:175], v[174:175], s[98:99] op_sel_hi:[1,0]
    v_pk_mul_f32 v[176:177], v[176:177], s[98:99] op_sel_hi:[1,0]
    v_cvt_pk_bf16_f32 v88, v170, v171
    v_cvt_pk_bf16_f32 v89, v172, v173
    v_cvt_pk_bf16_f32 v90, v174, v175
    v_cvt_pk_bf16_f32 v91, v176, v177
    ds_write_b128 v168, v[88:91] offset:0
    s_lshl_b32 s80, s2, 2
    s_add_u32 s80, s80, s62
    s_mul_i32 s80, s80, 512
    s_mov_b64 exec, 0xf
    buffer_load_dword v58, v57, s[12:15], s80 offen
    s_mov_b64 exec, -1
    v_readlane_b32 s96, v128, 32
    v_readlane_b32 s98, v130, 32
    v_xor_b32 v169, 112, v2
    v_dot2_f32_bf16 v170, v92, v25, s97
    v_dot2_f32_bf16 v171, v92, v48, s97
    v_dot2_f32_bf16 v172, v93, v25, s97
    v_dot2_f32_bf16 v173, v93, v48, s97
    v_dot2_f32_bf16 v174, v94, v25, s97
    v_dot2_f32_bf16 v175, v94, v48, s97
    v_dot2_f32_bf16 v176, v95, v25, s97
    v_dot2_f32_bf16 v177, v95, v48, s97
    v_pk_mul_f32 v[170:171], v[170:171], s[100:101] op_sel_hi:[1,0]
    v_pk_mul_f32 v[172:173], v[172:173], s[100:101] op_sel_hi:[1,0]
    v_pk_mul_f32 v[174:175], v[174:175], s[100:101] op_sel_hi:[1,0]
    v_pk_mul_f32 v[176:177], v[176:177], s[100:101] op_sel_hi:[1,0]
    v_cvt_pk_bf16_f32 v92, v170, v171
    v_cvt_pk_bf16_f32 v93, v172, v173
    v_cvt_pk_bf16_f32 v94, v174, v175
    v_cvt_pk_bf16_f32 v95, v176, v177
    ds_write_b128 v169, v[92:95] offset:0
    s_lshl_b32 s80, s2, 2
    s_add_u32 s80, s80, s62
    s_mul_i32 s80, s80, 1792
    s_mov_b64 exec, 0x3fff
    buffer_load_dword v58, v57, s[20:23], s80 offen
    s_mov_b64 exec, -1
    v_readlane_b32 s97, v128, 36
    v_readlane_b32 s100, v130, 36
    v_xor_b32 v168, 128, v2
    v_dot2_f32_bf16 v170, v96, v25, s96
    v_dot2_f32_bf16 v171, v96, v48, s96
    v_dot2_f32_bf16 v172, v97, v25, s96
    v_dot2_f32_bf16 v173, v97, v48, s96
    v_dot2_f32_bf16 v174, v98, v25, s96
    v_dot2_f32_bf16 v175, v98, v48, s96
    v_dot2_f32_bf16 v176, v99, v25, s96
    v_dot2_f32_bf16 v177, v99, v48, s96
    v_pk_mul_f32 v[170:171], v[170:171], s[98:99] op_sel_hi:[1,0]
    v_pk_mul_f32 v[172:173], v[172:173], s[98:99] op_sel_hi:[1,0]
    v_pk_mul_f32 v[174:175], v[174:175], s[98:99] op_sel_hi:[1,0]
    v_pk_mul_f32 v[176:177], v[176:177], s[98:99] op_sel_hi:[1,0]
    v_cvt_pk_bf16_f32 v96, v170, v171
    v_cvt_pk_bf16_f32 v97, v172, v173
    v_cvt_pk_bf16_f32 v98, v174, v175
    v_cvt_pk_bf16_f32 v99, v176, v177
    ds_write_b128 v168, v[96:99] offset:0
    s_lshl_b32 s80, s2, 2
    s_add_u32 s80, s80, s62
    s_mul_i32 s80, s80, 1536
    s_add_u32 s80, s80, 16908288
    v_lshlrev_b32 v59, 9, v0
    s_mov_b64 exec, 7
    buffer_load_dword v58, v59, s[28:31], s80 offen sc1
    s_mov_b64 exec, -1
    v_readlane_b32 s96, v128, 40
    v_readlane_b32 s98, v130, 40
    v_xor_b32 v169, 144, v2
    v_dot2_f32_bf16 v170, v100, v25, s97
    v_dot2_f32_bf16 v171, v100, v48, s97
    v_dot2_f32_bf16 v172, v101, v25, s97
    v_dot2_f32_bf16 v173, v101, v48, s97
    v_dot2_f32_bf16 v174, v102, v25, s97
    v_dot2_f32_bf16 v175, v102, v48, s97
    v_dot2_f32_bf16 v176, v103, v25, s97
    v_dot2_f32_bf16 v177, v103, v48, s97
    v_pk_mul_f32 v[170:171], v[170:171], s[100:101] op_sel_hi:[1,0]
    v_pk_mul_f32 v[172:173], v[172:173], s[100:101] op_sel_hi:[1,0]
    v_pk_mul_f32 v[174:175], v[174:175], s[100:101] op_sel_hi:[1,0]
    v_pk_mul_f32 v[176:177], v[176:177], s[100:101] op_sel_hi:[1,0]
    v_cvt_pk_bf16_f32 v100, v170, v171
    v_cvt_pk_bf16_f32 v101, v172, v173
    v_cvt_pk_bf16_f32 v102, v174, v175
    v_cvt_pk_bf16_f32 v103, v176, v177
    ds_write_b128 v169, v[100:103] offset:0
    v_readlane_b32 s97, v128, 44
    v_readlane_b32 s100, v130, 44
    v_xor_b32 v168, 160, v2
    v_dot2_f32_bf16 v170, v104, v25, s96
    v_dot2_f32_bf16 v171, v104, v48, s96
    v_dot2_f32_bf16 v172, v105, v25, s96
    v_dot2_f32_bf16 v173, v105, v48, s96
    v_dot2_f32_bf16 v174, v106, v25, s96
    v_dot2_f32_bf16 v175, v106, v48, s96
    v_dot2_f32_bf16 v176, v107, v25, s96
    v_dot2_f32_bf16 v177, v107, v48, s96
    v_pk_mul_f32 v[170:171], v[170:171], s[98:99] op_sel_hi:[1,0]
    v_pk_mul_f32 v[172:173], v[172:173], s[98:99] op_sel_hi:[1,0]
    v_pk_mul_f32 v[174:175], v[174:175], s[98:99] op_sel_hi:[1,0]
    v_pk_mul_f32 v[176:177], v[176:177], s[98:99] op_sel_hi:[1,0]
    v_cvt_pk_bf16_f32 v104, v170, v171
    v_cvt_pk_bf16_f32 v105, v172, v173
    v_cvt_pk_bf16_f32 v106, v174, v175
    v_cvt_pk_bf16_f32 v107, v176, v177
    ds_write_b128 v168, v[104:107] offset:0
    v_readlane_b32 s96, v128, 48
    v_readlane_b32 s98, v130, 48
    v_xor_b32 v169, 176, v2
    v_dot2_f32_bf16 v170, v108, v25, s97
    v_dot2_f32_bf16 v171, v108, v48, s97
    v_dot2_f32_bf16 v172, v109, v25, s97
    v_dot2_f32_bf16 v173, v109, v48, s97
    v_dot2_f32_bf16 v174, v110, v25, s97
    v_dot2_f32_bf16 v175, v110, v48, s97
    v_dot2_f32_bf16 v176, v111, v25, s97
    v_dot2_f32_bf16 v177, v111, v48, s97
    v_pk_mul_f32 v[170:171], v[170:171], s[100:101] op_sel_hi:[1,0]
    v_pk_mul_f32 v[172:173], v[172:173], s[100:101] op_sel_hi:[1,0]
    v_pk_mul_f32 v[174:175], v[174:175], s[100:101] op_sel_hi:[1,0]
    v_pk_mul_f32 v[176:177], v[176:177], s[100:101] op_sel_hi:[1,0]
    v_cvt_pk_bf16_f32 v108, v170, v171
    v_cvt_pk_bf16_f32 v109, v172, v173
    v_cvt_pk_bf16_f32 v110, v174, v175
    v_cvt_pk_bf16_f32 v111, v176, v177
    ds_write_b128 v169, v[108:111] offset:0
    v_readlane_b32 s97, v128, 52
    v_readlane_b32 s100, v130, 52
    v_xor_b32 v168, 192, v2
    v_dot2_f32_bf16 v170, v112, v25, s96
    v_dot2_f32_bf16 v171, v112, v48, s96
    v_dot2_f32_bf16 v172, v113, v25, s96
    v_dot2_f32_bf16 v173, v113, v48, s96
    v_dot2_f32_bf16 v174, v114, v25, s96
    v_dot2_f32_bf16 v175, v114, v48, s96
    v_dot2_f32_bf16 v176, v115, v25, s96
    v_dot2_f32_bf16 v177, v115, v48, s96
    v_pk_mul_f32 v[170:171], v[170:171], s[98:99] op_sel_hi:[1,0]
    v_pk_mul_f32 v[172:173], v[172:173], s[98:99] op_sel_hi:[1,0]
    v_pk_mul_f32 v[174:175], v[174:175], s[98:99] op_sel_hi:[1,0]
    v_pk_mul_f32 v[176:177], v[176:177], s[98:99] op_sel_hi:[1,0]
    v_cvt_pk_bf16_f32 v112, v170, v171
    v_cvt_pk_bf16_f32 v113, v172, v173
    v_cvt_pk_bf16_f32 v114, v174, v175
    v_cvt_pk_bf16_f32 v115, v176, v177
    ds_write_b128 v168, v[112:115] offset:0
    v_readlane_b32 s96, v128, 56
    v_readlane_b32 s98, v130, 56
    v_xor_b32 v169, 208, v2
    v_dot2_f32_bf16 v170, v116, v25, s97
    v_dot2_f32_bf16 v171, v116, v48, s97
    v_dot2_f32_bf16 v172, v117, v25, s97
    v_dot2_f32_bf16 v173, v117, v48, s97
    v_dot2_f32_bf16 v174, v118, v25, s97
    v_dot2_f32_bf16 v175, v118, v48, s97
    v_dot2_f32_bf16 v176, v119, v25, s97
    v_dot2_f32_bf16 v177, v119, v48, s97
    v_pk_mul_f32 v[170:171], v[170:171], s[100:101] op_sel_hi:[1,0]
    v_pk_mul_f32 v[172:173], v[172:173], s[100:101] op_sel_hi:[1,0]
    v_pk_mul_f32 v[174:175], v[174:175], s[100:101] op_sel_hi:[1,0]
    v_pk_mul_f32 v[176:177], v[176:177], s[100:101] op_sel_hi:[1,0]
    v_cvt_pk_bf16_f32 v116, v170, v171
    v_cvt_pk_bf16_f32 v117, v172, v173
    v_cvt_pk_bf16_f32 v118, v174, v175
    v_cvt_pk_bf16_f32 v119, v176, v177
    ds_write_b128 v169, v[116:119] offset:0
    v_readlane_b32 s97, v128, 60
    v_readlane_b32 s100, v130, 60
    v_xor_b32 v168, 224, v2
    v_dot2_f32_bf16 v170, v120, v25, s96
    v_dot2_f32_bf16 v171, v120, v48, s96
    v_dot2_f32_bf16 v172, v121, v25, s96
    v_dot2_f32_bf16 v173, v121, v48, s96
    v_dot2_f32_bf16 v174, v122, v25, s96
    v_dot2_f32_bf16 v175, v122, v48, s96
    v_dot2_f32_bf16 v176, v123, v25, s96
    v_dot2_f32_bf16 v177, v123, v48, s96
    v_pk_mul_f32 v[170:171], v[170:171], s[98:99] op_sel_hi:[1,0]
    v_pk_mul_f32 v[172:173], v[172:173], s[98:99] op_sel_hi:[1,0]
    v_pk_mul_f32 v[174:175], v[174:175], s[98:99] op_sel_hi:[1,0]
    v_pk_mul_f32 v[176:177], v[176:177], s[98:99] op_sel_hi:[1,0]
    v_cvt_pk_bf16_f32 v120, v170, v171
    v_cvt_pk_bf16_f32 v121, v172, v173
    v_cvt_pk_bf16_f32 v122, v174, v175
    v_cvt_pk_bf16_f32 v123, v176, v177
    ds_write_b128 v168, v[120:123] offset:0
    v_xor_b32 v169, 240, v2
    v_dot2_f32_bf16 v170, v124, v25, s97
    v_dot2_f32_bf16 v171, v124, v48, s97
    v_dot2_f32_bf16 v172, v125, v25, s97
    v_dot2_f32_bf16 v173, v125, v48, s97
    v_dot2_f32_bf16 v174, v126, v25, s97
    v_dot2_f32_bf16 v175, v126, v48, s97
    v_dot2_f32_bf16 v176, v127, v25, s97
    v_dot2_f32_bf16 v177, v127, v48, s97
    v_pk_mul_f32 v[170:171], v[170:171], s[100:101] op_sel_hi:[1,0]
    v_pk_mul_f32 v[172:173], v[172:173], s[100:101] op_sel_hi:[1,0]
    v_pk_mul_f32 v[174:175], v[174:175], s[100:101] op_sel_hi:[1,0]
    v_pk_mul_f32 v[176:177], v[176:177], s[100:101] op_sel_hi:[1,0]
    v_cvt_pk_bf16_f32 v124, v170, v171
    v_cvt_pk_bf16_f32 v125, v172, v173
    v_cvt_pk_bf16_f32 v126, v174, v175
    v_cvt_pk_bf16_f32 v127, v176, v177
    ds_write_b128 v169, v[124:127] offset:0
    s_waitcnt vmcnt(21) lgkmcnt(0)
    s_barrier
    buffer_load_dword v7, v6, s[92:95], 0 offen sc1
    ds_read_b128 a[128:131], v160 offset:0
    ds_read_b64_tr_b16 v[108:109], v61 offset:0
    ds_read_b64_tr_b16 v[110:111], v61 offset:512
    ds_read_b64_tr_b16 v[96:97], v61 offset:8192
    ds_read_b64_tr_b16 v[98:99], v61 offset:8704
    ds_read_b128 a[132:135], v161 offset:1024
    ds_read_b64_tr_b16 v[112:113], v61 offset:2048
    ds_read_b64_tr_b16 v[114:115], v61 offset:2560
    ds_read_b64_tr_b16 v[100:101], v61 offset:10240
    ds_read_b64_tr_b16 v[102:103], v61 offset:10752
    s_waitcnt lgkmcnt(7)
    v_mfma_f32_32x32x16_bf16 v[64:79], v[108:111], a[128:131], 0
    ds_read_b128 a[136:139], v162 offset:2048
    ds_read_b64_tr_b16 v[116:117], v61 offset:4096
    ds_read_b64_tr_b16 v[118:119], v61 offset:4608
    s_waitcnt lgkmcnt(8)
    v_mfma_f32_32x32x16_bf16 v[80:95], a[128:131], v[96:99], 0
    ds_read_b64_tr_b16 v[104:105], v61 offset:12288
    ds_read_b64_tr_b16 v[106:107], v61 offset:12800
    s_waitcnt lgkmcnt(7)
    v_mfma_f32_32x32x16_bf16 v[64:79], v[112:115], a[132:135], v[64:79]
    ds_read_b128 a[140:143], v163 offset:3072
    ds_read_b64_tr_b16 v[108:109], v61 offset:6144
    ds_read_b64_tr_b16 v[110:111], v61 offset:6656
    s_waitcnt lgkmcnt(8)
    v_mfma_f32_32x32x16_bf16 v[80:95], a[132:135], v[100:103], v[80:95]
    ds_read_b64_tr_b16 v[96:97], v61 offset:14336
    ds_read_b64_tr_b16 v[98:99], v61 offset:14848
    s_waitcnt lgkmcnt(7)
    v_mfma_f32_32x32x16_bf16 v[64:79], v[116:119], a[136:139], v[64:79]
    ds_read_b128 a[144:147], v160 offset:4096
    ds_read_b64_tr_b16 v[112:113], v61 offset:16384
    ds_read_b64_tr_b16 v[114:115], v61 offset:16896
    s_waitcnt lgkmcnt(8)
    v_mfma_f32_32x32x16_bf16 v[80:95], a[136:139], v[104:107], v[80:95]
    ds_read_b64_tr_b16 v[100:101], v61 offset:24576
    ds_read_b64_tr_b16 v[102:103], v61 offset:25088
    s_waitcnt lgkmcnt(7)
    v_mfma_f32_32x32x16_bf16 v[64:79], v[108:111], a[140:143], v[64:79]
    ds_read_b128 a[148:151], v161 offset:5120
    ds_read_b64_tr_b16 v[116:117], v61 offset:18432
    ds_read_b64_tr_b16 v[118:119], v61 offset:18944
    s_waitcnt lgkmcnt(8)
    v_mfma_f32_32x32x16_bf16 v[80:95], a[140:143], v[96:99], v[80:95]
    ds_read_b64_tr_b16 v[104:105], v61 offset:26624
    ds_read_b64_tr_b16 v[106:107], v61 offset:27136
    s_waitcnt lgkmcnt(7)
    v_mfma_f32_32x32x16_bf16 v[64:79], v[112:115], a[144:147], v[64:79]
    ds_read_b128 a[152:155], v162 offset:6144
    ds_read_b64_tr_b16 v[108:109], v61 offset:20480
    ds_read_b64_tr_b16 v[110:111], v61 offset:20992
    s_waitcnt lgkmcnt(8)
    v_mfma_f32_32x32x16_bf16 v[80:95], a[144:147], v[100:103], v[80:95]
    ds_read_b64_tr_b16 v[96:97], v61 offset:28672
    ds_read_b64_tr_b16 v[98:99], v61 offset:29184
    s_waitcnt lgkmcnt(7)
    v_mfma_f32_32x32x16_bf16 v[64:79], v[116:119], a[148:151], v[64:79]
    ds_read_b128 a[156:159], v163 offset:7168
    ds_read_b64_tr_b16 v[112:113], v61 offset:22528
    ds_read_b64_tr_b16 v[114:115], v61 offset:23040
    s_waitcnt lgkmcnt(8)
    v_mfma_f32_32x32x16_bf16 v[80:95], a[148:151], v[104:107], v[80:95]
    ds_read_b64_tr_b16 v[100:101], v61 offset:30720
    ds_read_b64_tr_b16 v[102:103], v61 offset:31232
    s_waitcnt vmcnt(13)
    s_waitcnt lgkmcnt(0)
    s_barrier
    v_mfma_f32_32x32x16_bf16 v[64:79], v[108:111], a[152:155], v[64:79]
    ds_read_b128 a[160:163], v160 offset:8192
    ds_read_b64_tr_b16 v[116:117], v61 offset:32768
    ds_read_b64_tr_b16 v[118:119], v61 offset:33280
    v_mfma_f32_32x32x16_bf16 v[80:95], a[152:155], v[96:99], v[80:95]
    ds_read_b64_tr_b16 v[104:105], v61 offset:40960
    ds_read_b64_tr_b16 v[106:107], v61 offset:41472
    v_mfma_f32_32x32x16_bf16 v[64:79], v[112:115], a[156:159], v[64:79]
    ds_read_b128 a[164:167], v161 offset:9216
    ds_read_b64_tr_b16 v[108:109], v61 offset:34816
    ds_read_b64_tr_b16 v[110:111], v61 offset:35328
    s_add_u32 m0, s41, 0
    s_add_u32 s78, s40, 1179648
    buffer_load_dwordx4 v53, s[8:11], s78 offen offset:0 lds
    v_mfma_f32_32x32x16_bf16 v[80:95], a[156:159], v[100:103], v[80:95]
    ds_read_b64_tr_b16 v[96:97], v61 offset:43008
    ds_read_b64_tr_b16 v[98:99], v61 offset:43520
    buffer_load_dwordx4 v54, s[8:11], s78 offen offset:1024 lds
    buffer_load_dwordx4 v55, s[8:11], s78 offen offset:2048 lds
    buffer_load_dwordx4 v56, s[8:11], s78 offen offset:3072 lds
    s_waitcnt lgkmcnt(7)
    v_mfma_f32_32x32x16_bf16 v[64:79], v[116:119], a[160:163], v[64:79]
    ds_read_b128 a[168:171], v162 offset:10240
    ds_read_b64_tr_b16 v[112:113], v61 offset:36864
    ds_read_b64_tr_b16 v[114:115], v61 offset:37376
    s_waitcnt lgkmcnt(8)
    v_mfma_f32_32x32x16_bf16 v[80:95], a[160:163], v[104:107], v[80:95]
    ds_read_b64_tr_b16 v[100:101], v61 offset:45056
    ds_read_b64_tr_b16 v[102:103], v61 offset:45568
    s_waitcnt lgkmcnt(7)
    v_mfma_f32_32x32x16_bf16 v[64:79], v[108:111], a[164:167], v[64:79]
    ds_read_b128 a[172:175], v163 offset:11264
    ds_read_b64_tr_b16 v[116:117], v61 offset:38912
    ds_read_b64_tr_b16 v[118:119], v61 offset:39424
    s_add_u32 m0, s41, 16384
    s_add_u32 s78, s40, 1376256
    buffer_load_dwordx4 v53, s[8:11], s78 offen offset:0 lds
    s_waitcnt lgkmcnt(8)
    v_mfma_f32_32x32x16_bf16 v[80:95], a[164:167], v[96:99], v[80:95]
    ds_read_b64_tr_b16 v[104:105], v61 offset:47104
    ds_read_b64_tr_b16 v[106:107], v61 offset:47616
    buffer_load_dwordx4 v54, s[8:11], s78 offen offset:1024 lds
    buffer_load_dwordx4 v55, s[8:11], s78 offen offset:2048 lds
    buffer_load_dwordx4 v56, s[8:11], s78 offen offset:3072 lds
    s_waitcnt lgkmcnt(7)
    v_mfma_f32_32x32x16_bf16 v[64:79], v[112:115], a[168:171], v[64:79]
    ds_read_b128 a[176:179], v160 offset:12288
    ds_read_b64_tr_b16 v[108:109], v61 offset:49152
    ds_read_b64_tr_b16 v[110:111], v61 offset:49664
    s_waitcnt lgkmcnt(8)
    v_mfma_f32_32x32x16_bf16 v[80:95], a[168:171], v[100:103], v[80:95]
    ds_read_b64_tr_b16 v[96:97], v61 offset:57344
    ds_read_b64_tr_b16 v[98:99], v61 offset:57856
    s_waitcnt lgkmcnt(7)
    v_mfma_f32_32x32x16_bf16 v[64:79], v[116:119], a[172:175], v[64:79]
    ds_read_b128 a[180:183], v161 offset:13312
    ds_read_b64_tr_b16 v[112:113], v61 offset:51200
    ds_read_b64_tr_b16 v[114:115], v61 offset:51712
    buffer_load_dwordx4 v[28:31], v17, s[4:7], s44 offen
    s_waitcnt lgkmcnt(8)
    v_mfma_f32_32x32x16_bf16 v[80:95], a[172:175], v[104:107], v[80:95]
    ds_read_b64_tr_b16 v[100:101], v61 offset:59392
    ds_read_b64_tr_b16 v[102:103], v61 offset:59904
    buffer_load_dwordx4 v[32:35], v17, s[4:7], s45 offen
    s_waitcnt lgkmcnt(7)
    v_mfma_f32_32x32x16_bf16 v[64:79], v[108:111], a[176:179], v[64:79]
    ds_read_b128 a[184:187], v162 offset:14336
    ds_read_b64_tr_b16 v[116:117], v61 offset:53248
    ds_read_b64_tr_b16 v[118:119], v61 offset:53760
    s_waitcnt lgkmcnt(8)
    v_mfma_f32_32x32x16_bf16 v[80:95], a[176:179], v[96:99], v[80:95]
    ds_read_b64_tr_b16 v[104:105], v61 offset:61440
    ds_read_b64_tr_b16 v[106:107], v61 offset:61952
    s_waitcnt lgkmcnt(7)
    v_mfma_f32_32x32x16_bf16 v[64:79], v[112:115], a[180:183], v[64:79]
    ds_read_b128 a[188:191], v163 offset:15360
    ds_read_b64_tr_b16 v[108:109], v61 offset:55296
    ds_read_b64_tr_b16 v[110:111], v61 offset:55808
    s_waitcnt lgkmcnt(8)
    v_mfma_f32_32x32x16_bf16 v[80:95], a[180:183], v[100:103], v[80:95]
    ds_read_b64_tr_b16 v[96:97], v61 offset:63488
    ds_read_b64_tr_b16 v[98:99], v61 offset:64000
    s_waitcnt vmcnt(14)
    s_waitcnt lgkmcnt(0)
    s_barrier
    v_mfma_f32_32x32x16_bf16 v[64:79], v[116:119], a[184:187], v[64:79]
    ds_read_b128 a[192:195], v160 offset:16384
    ds_read_b64_tr_b16 v[112:113], v62 offset:0
    ds_read_b64_tr_b16 v[114:115], v62 offset:512
    v_mfma_f32_32x32x16_bf16 v[80:95], a[184:187], v[104:107], v[80:95]
    ds_read_b64_tr_b16 v[100:101], v62 offset:8192
    ds_read_b64_tr_b16 v[102:103], v62 offset:8704
    v_mfma_f32_32x32x16_bf16 v[64:79], v[108:111], a[188:191], v[64:79]
    ds_read_b128 a[196:199], v161 offset:17408
    ds_read_b64_tr_b16 v[116:117], v62 offset:2048
    ds_read_b64_tr_b16 v[118:119], v62 offset:2560
    s_add_u32 m0, s43, 0
    s_add_u32 s78, s42, 0
    buffer_load_dwordx4 v53, s[8:11], s78 offen offset:0 lds
    buffer_load_dwordx4 v54, s[8:11], s78 offen offset:1024 lds
    v_mfma_f32_32x32x16_bf16 v[80:95], a[188:191], v[96:99], v[80:95]
    ds_read_b64_tr_b16 v[104:105], v62 offset:10240
    ds_read_b64_tr_b16 v[106:107], v62 offset:10752
    s_add_u32 m0, s43, 8192
    s_add_u32 s78, s42, 196608
    buffer_load_dwordx4 v53, s[8:11], s78 offen offset:0 lds
    buffer_load_dwordx4 v54, s[8:11], s78 offen offset:1024 lds
    s_waitcnt lgkmcnt(7)
    v_mfma_f32_32x32x16_bf16 v[64:79], v[112:115], a[192:195], v[64:79]
    ds_read_b128 a[200:203], v162 offset:18432
    ds_read_b64_tr_b16 v[108:109], v62 offset:4096
    ds_read_b64_tr_b16 v[110:111], v62 offset:4608
    s_waitcnt lgkmcnt(8)
    v_mfma_f32_32x32x16_bf16 v[80:95], a[192:195], v[100:103], v[80:95]
    ds_read_b64_tr_b16 v[96:97], v62 offset:12288
    ds_read_b64_tr_b16 v[98:99], v62 offset:12800
    s_waitcnt lgkmcnt(7)
    v_mfma_f32_32x32x16_bf16 v[64:79], v[116:119], a[196:199], v[64:79]
    ds_read_b128 a[204:207], v163 offset:19456
    ds_read_b64_tr_b16 v[112:113], v62 offset:6144
    ds_read_b64_tr_b16 v[114:115], v62 offset:6656
    s_waitcnt lgkmcnt(8)
    v_mfma_f32_32x32x16_bf16 v[80:95], a[196:199], v[104:107], v[80:95]
    ds_read_b64_tr_b16 v[100:101], v62 offset:14336
    ds_read_b64_tr_b16 v[102:103], v62 offset:14848
    s_waitcnt lgkmcnt(7)
    v_mfma_f32_32x32x16_bf16 v[64:79], v[108:111], a[200:203], v[64:79]
    ds_read_b128 a[208:211], v160 offset:20480
    ds_read_b64_tr_b16 v[116:117], v62 offset:16384
    ds_read_b64_tr_b16 v[118:119], v62 offset:16896
    s_add_u32 m0, s43, 16384
    s_add_u32 s78, s42, 393216
    buffer_load_dwordx4 v53, s[8:11], s78 offen offset:0 lds
    buffer_load_dwordx4 v54, s[8:11], s78 offen offset:1024 lds
    s_waitcnt lgkmcnt(8)
    v_mfma_f32_32x32x16_bf16 v[80:95], a[200:203], v[96:99], v[80:95]
    ds_read_b64_tr_b16 v[104:105], v62 offset:24576
    ds_read_b64_tr_b16 v[106:107], v62 offset:25088
    s_add_u32 m0, s43, 24576
    s_add_u32 s78, s42, 589824
    buffer_load_dwordx4 v53, s[8:11], s78 offen offset:0 lds
    buffer_load_dwordx4 v54, s[8:11], s78 offen offset:1024 lds
    s_waitcnt lgkmcnt(7)
    v_mfma_f32_32x32x16_bf16 v[64:79], v[112:115], a[204:207], v[64:79]
    ds_read_b128 a[212:215], v161 offset:21504
    ds_read_b64_tr_b16 v[108:109], v62 offset:18432
    ds_read_b64_tr_b16 v[110:111], v62 offset:18944
    s_waitcnt lgkmcnt(8)
    v_mfma_f32_32x32x16_bf16 v[80:95], a[204:207], v[100:103], v[80:95]
    ds_read_b64_tr_b16 v[96:97], v62 offset:26624
    ds_read_b64_tr_b16 v[98:99], v62 offset:27136
    s_waitcnt lgkmcnt(7)
    v_mfma_f32_32x32x16_bf16 v[64:79], v[116:119], a[208:211], v[64:79]
    ds_read_b128 a[216:219], v162 offset:22528
    ds_read_b64_tr_b16 v[112:113], v62 offset:20480
    ds_read_b64_tr_b16 v[114:115], v62 offset:20992
    s_waitcnt lgkmcnt(8)
    v_mfma_f32_32x32x16_bf16 v[80:95], a[208:211], v[104:107], v[80:95]
    ds_read_b64_tr_b16 v[100:101], v62 offset:28672
    ds_read_b64_tr_b16 v[102:103], v62 offset:29184
    s_waitcnt lgkmcnt(7)
    v_mfma_f32_32x32x16_bf16 v[64:79], v[108:111], a[212:215], v[64:79]
    ds_read_b128 a[220:223], v163 offset:23552
    ds_read_b64_tr_b16 v[116:117], v62 offset:22528
    ds_read_b64_tr_b16 v[118:119], v62 offset:23040
    s_waitcnt lgkmcnt(8)
    v_mfma_f32_32x32x16_bf16 v[80:95], a[212:215], v[96:99], v[80:95]
    ds_read_b64_tr_b16 v[104:105], v62 offset:30720
    ds_read_b64_tr_b16 v[106:107], v62 offset:31232
    s_waitcnt vmcnt(10)
    s_waitcnt lgkmcnt(0)
    s_barrier
    v_mfma_f32_32x32x16_bf16 v[64:79], v[112:115], a[216:219], v[64:79]
    ds_read_b128 a[224:227], v160 offset:24576
    ds_read_b64_tr_b16 v[108:109], v61 offset:0
    ds_read_b64_tr_b16 v[110:111], v61 offset:512
    v_mfma_f32_32x32x16_bf16 v[80:95], a[216:219], v[100:103], v[80:95]
    ds_read_b64_tr_b16 v[96:97], v61 offset:8192
    ds_read_b64_tr_b16 v[98:99], v61 offset:8704
    v_mfma_f32_32x32x16_bf16 v[64:79], v[116:119], a[220:223], v[64:79]
    ds_read_b128 a[228:231], v161 offset:25600
    ds_read_b64_tr_b16 v[112:113], v61 offset:2048
    ds_read_b64_tr_b16 v[114:115], v61 offset:2560
    s_add_u32 m0, s43, 32768
    s_add_u32 s78, s42, 786432
    buffer_load_dwordx4 v53, s[8:11], s78 offen offset:0 lds
    buffer_load_dwordx4 v54, s[8:11], s78 offen offset:1024 lds
    v_mfma_f32_32x32x16_bf16 v[80:95], a[220:223], v[104:107], v[80:95]
    ds_read_b64_tr_b16 v[100:101], v61 offset:10240
    ds_read_b64_tr_b16 v[102:103], v61 offset:10752
    s_add_u32 m0, s43, 40960
    s_add_u32 s78, s42, 983040
    buffer_load_dwordx4 v53, s[8:11], s78 offen offset:0 lds
    buffer_load_dwordx4 v54, s[8:11], s78 offen offset:1024 lds
    s_waitcnt lgkmcnt(7)
    v_mfma_f32_32x32x16_bf16 v[64:79], v[108:111], a[224:227], v[64:79]
    ds_read_b128 a[232:235], v162 offset:26624
    ds_read_b64_tr_b16 v[116:117], v61 offset:4096
    ds_read_b64_tr_b16 v[118:119], v61 offset:4608
    s_waitcnt lgkmcnt(8)
    v_mfma_f32_32x32x16_bf16 v[80:95], a[224:227], v[96:99], v[80:95]
    ds_read_b64_tr_b16 v[104:105], v61 offset:12288
    ds_read_b64_tr_b16 v[106:107], v61 offset:12800
    s_waitcnt lgkmcnt(7)
    v_mfma_f32_32x32x16_bf16 v[64:79], v[112:115], a[228:231], v[64:79]
    ds_read_b128 a[236:239], v163 offset:27648
    ds_read_b64_tr_b16 v[108:109], v61 offset:6144
    ds_read_b64_tr_b16 v[110:111], v61 offset:6656
    s_waitcnt lgkmcnt(8)
    v_mfma_f32_32x32x16_bf16 v[80:95], a[228:231], v[100:103], v[80:95]
    ds_read_b64_tr_b16 v[96:97], v61 offset:14336
    ds_read_b64_tr_b16 v[98:99], v61 offset:14848
    s_waitcnt lgkmcnt(7)
    v_mfma_f32_32x32x16_bf16 v[64:79], v[116:119], a[232:235], v[64:79]
    ds_read_b128 a[240:243], v160 offset:28672
    ds_read_b64_tr_b16 v[112:113], v61 offset:16384
    ds_read_b64_tr_b16 v[114:115], v61 offset:16896
    s_add_u32 m0, s43, 49152
    s_add_u32 s78, s42, 1179648
    buffer_load_dwordx4 v53, s[8:11], s78 offen offset:0 lds
    buffer_load_dwordx4 v54, s[8:11], s78 offen offset:1024 lds
    s_waitcnt lgkmcnt(8)
    v_mfma_f32_32x32x16_bf16 v[80:95], a[232:235], v[104:107], v[80:95]
    ds_read_b64_tr_b16 v[100:101], v61 offset:24576
    ds_read_b64_tr_b16 v[102:103], v61 offset:25088
    s_add_u32 m0, s43, 57344
    s_add_u32 s78, s42, 1376256
    buffer_load_dwordx4 v53, s[8:11], s78 offen offset:0 lds
    buffer_load_dwordx4 v54, s[8:11], s78 offen offset:1024 lds
    s_waitcnt lgkmcnt(7)
    v_mfma_f32_32x32x16_bf16 v[64:79], v[108:111], a[236:239], v[64:79]
    ds_read_b128 a[244:247], v161 offset:29696
    ds_read_b64_tr_b16 v[116:117], v61 offset:18432
    ds_read_b64_tr_b16 v[118:119], v61 offset:18944
    s_waitcnt lgkmcnt(8)
    v_mfma_f32_32x32x16_bf16 v[80:95], a[236:239], v[96:99], v[80:95]
    ds_read_b64_tr_b16 v[104:105], v61 offset:26624
    ds_read_b64_tr_b16 v[106:107], v61 offset:27136
    s_waitcnt lgkmcnt(7)
    v_mfma_f32_32x32x16_bf16 v[64:79], v[112:115], a[240:243], v[64:79]
    ds_read_b128 a[248:251], v162 offset:30720
    ds_read_b64_tr_b16 v[108:109], v61 offset:20480
    ds_read_b64_tr_b16 v[110:111], v61 offset:20992
    s_waitcnt lgkmcnt(8)
    v_mfma_f32_32x32x16_bf16 v[80:95], a[240:243], v[100:103], v[80:95]
    ds_read_b64_tr_b16 v[96:97], v61 offset:28672
    ds_read_b64_tr_b16 v[98:99], v61 offset:29184
    s_waitcnt lgkmcnt(7)
    v_mfma_f32_32x32x16_bf16 v[64:79], v[116:119], a[244:247], v[64:79]
    ds_read_b128 a[252:255], v163 offset:31744
    ds_read_b64_tr_b16 v[112:113], v61 offset:22528
    ds_read_b64_tr_b16 v[114:115], v61 offset:23040
    s_waitcnt lgkmcnt(8)
    v_mfma_f32_32x32x16_bf16 v[80:95], a[244:247], v[104:107], v[80:95]
    ds_read_b64_tr_b16 v[100:101], v61 offset:30720
    ds_read_b64_tr_b16 v[102:103], v61 offset:31232
    s_waitcnt vmcnt(8)
    s_waitcnt lgkmcnt(0)
    s_barrier
    v_mfma_f32_32x32x16_bf16 v[64:79], v[108:111], a[248:251], v[64:79]
    ds_read_b64_tr_b16 v[116:117], v164 offset:0
    ds_read_b64_tr_b16 v[118:119], v164 offset:512
    v_mfma_f32_32x32x16_bf16 v[80:95], a[248:251], v[96:99], v[80:95]
    v_mfma_f32_32x32x16_bf16 v[64:79], v[112:115], a[252:255], v[64:79]
    ds_read_b64_tr_b16 v[108:109], v164 offset:2048
    ds_read_b64_tr_b16 v[110:111], v164 offset:2560
    v_mfma_f32_32x32x16_bf16 v[80:95], a[252:255], v[100:103], v[80:95]
    s_waitcnt lgkmcnt(2)
    v_mfma_f32_32x32x16_bf16 v[120:135], v[116:119], a[128:131], 0
    ds_read_b64_tr_b16 v[112:113], v164 offset:4096
    ds_read_b64_tr_b16 v[114:115], v164 offset:4608
    s_waitcnt lgkmcnt(2)
    v_mfma_f32_32x32x16_bf16 v[120:135], v[108:111], a[132:135], v[120:135]
    ds_read_b64_tr_b16 v[116:117], v164 offset:6144
    ds_read_b64_tr_b16 v[118:119], v164 offset:6656
    s_nop 0
    v_cvt_pk_bf16_f32 v136, v64, v65
    v_cvt_pk_bf16_f32 v137, v66, v67
    v_cvt_pk_bf16_f32 v138, v68, v69
    v_cvt_pk_bf16_f32 v139, v70, v71
    s_barrier
    s_waitcnt lgkmcnt(2)
    v_mfma_f32_32x32x16_bf16 v[120:135], v[112:115], a[136:139], v[120:135]
    ds_read_b64_tr_b16 v[108:109], v164 offset:8192
    ds_read_b64_tr_b16 v[110:111], v164 offset:8704
    v_cvt_pk_bf16_f32 v140, v72, v73
    v_cvt_pk_bf16_f32 v141, v74, v75
    v_cvt_pk_bf16_f32 v142, v76, v77
    v_cvt_pk_bf16_f32 v143, v78, v79
    s_waitcnt lgkmcnt(2)
    v_mfma_f32_32x32x16_bf16 v[120:135], v[116:119], a[140:143], v[120:135]
    ds_read_b64_tr_b16 v[112:113], v164 offset:10240
    ds_read_b64_tr_b16 v[114:115], v164 offset:10752
    buffer_store_dwordx4 v[136:139], v1, s[28:31], s50 offen sc1
    buffer_store_dwordx4 v[140:143], v1, s[28:31], s50 offen offset:1024 sc1
    v_cvt_pk_bf16_f32 v144, v80, v81
    v_cvt_pk_bf16_f32 v145, v82, v83
    s_waitcnt lgkmcnt(2)
    v_mfma_f32_32x32x16_bf16 v[120:135], v[108:111], a[144:147], v[120:135]
    ds_read_b64_tr_b16 v[116:117], v164 offset:12288
    ds_read_b64_tr_b16 v[118:119], v164 offset:12800
    v_cvt_pk_bf16_f32 v146, v84, v85
    v_cvt_pk_bf16_f32 v147, v86, v87
    v_cvt_pk_bf16_f32 v148, v88, v89
    v_cvt_pk_bf16_f32 v149, v90, v91
    s_waitcnt lgkmcnt(2)
    v_mfma_f32_32x32x16_bf16 v[120:135], v[112:115], a[148:151], v[120:135]
    ds_read_b64_tr_b16 v[108:109], v164 offset:14336
    ds_read_b64_tr_b16 v[110:111], v164 offset:14848
    v_cvt_pk_bf16_f32 v150, v92, v93
    v_cvt_pk_bf16_f32 v151, v94, v95
    buffer_store_dwordx4 v[144:147], v204, s[28:31], s51 offen sc1
    buffer_store_dwordx4 v[148:151], v204, s[28:31], s51 offen offset:512 sc1
    s_waitcnt lgkmcnt(2)
    v_mfma_f32_32x32x16_bf16 v[120:135], v[116:119], a[152:155], v[120:135]
    ds_read_b64_tr_b16 v[112:113], v164 offset:16384
    ds_read_b64_tr_b16 v[114:115], v164 offset:16896
    s_waitcnt lgkmcnt(2)
    v_mfma_f32_32x32x16_bf16 v[120:135], v[108:111], a[156:159], v[120:135]
    ds_read_b64_tr_b16 v[116:117], v164 offset:18432
    ds_read_b64_tr_b16 v[118:119], v164 offset:18944
    s_waitcnt lgkmcnt(2)
    v_mfma_f32_32x32x16_bf16 v[120:135], v[112:115], a[160:163], v[120:135]
    ds_read_b64_tr_b16 v[108:109], v164 offset:20480
    ds_read_b64_tr_b16 v[110:111], v164 offset:20992
    s_waitcnt lgkmcnt(2)
    v_mfma_f32_32x32x16_bf16 v[120:135], v[116:119], a[164:167], v[120:135]
    ds_read_b64_tr_b16 v[112:113], v164 offset:22528
    ds_read_b64_tr_b16 v[114:115], v164 offset:23040
    s_waitcnt lgkmcnt(2)
    v_mfma_f32_32x32x16_bf16 v[120:135], v[108:111], a[168:171], v[120:135]
    ds_read_b64_tr_b16 v[116:117], v164 offset:24576
    ds_read_b64_tr_b16 v[118:119], v164 offset:25088
    s_waitcnt lgkmcnt(2)
    v_mfma_f32_32x32x16_bf16 v[120:135], v[112:115], a[172:175], v[120:135]
    ds_read_b64_tr_b16 v[108:109], v164 offset:26624
    ds_read_b64_tr_b16 v[110:111], v164 offset:27136
    s_add_u32 m0, s54, 0
    s_add_u32 s78, s53, 0
    buffer_load_dwordx4 v11, s[12:15], s78 offen offset:0 lds
    buffer_load_dwordx4 v12, s[12:15], s78 offen offset:1024 lds
    s_waitcnt lgkmcnt(2)
    v_mfma_f32_32x32x16_bf16 v[120:135], v[116:119], a[176:179], v[120:135]
    ds_read_b64_tr_b16 v[112:113], v164 offset:28672
    ds_read_b64_tr_b16 v[114:115], v164 offset:29184
    v_readfirstlane_b32 s70, v7
    s_nop 0
    s_cmp_eq_u32 s70, 0
    s_cbranch_scc1 L_tagretry
L_tagok:
    s_waitcnt lgkmcnt(2)
    v_mfma_f32_32x32x16_bf16 v[120:135], v[108:111], a[180:183], v[120:135]
    ds_read_b64_tr_b16 v[116:117], v164 offset:30720
    ds_read_b64_tr_b16 v[118:119], v164 offset:31232
    s_add_u32 m0, s54, 2048
    s_add_u32 s78, s53, 16384
    buffer_load_dwordx4 v11, s[12:15], s78 offen offset:0 lds
    buffer_load_dwordx4 v12, s[12:15], s78 offen offset:1024 lds
    s_waitcnt vmcnt(8)
    s_barrier
    s_waitcnt lgkmcnt(2)
    v_mfma_f32_32x32x16_bf16 v[120:135], v[112:115], a[184:187], v[120:135]
    ds_read_b64_tr_b16 v[108:109], v165 offset:0
    ds_read_b64_tr_b16 v[110:111], v165 offset:512
    s_waitcnt lgkmcnt(2)
    v_mfma_f32_32x32x16_bf16 v[120:135], v[116:119], a[188:191], v[120:135]
    ds_read_b64_tr_b16 v[112:113], v165 offset:2048
    ds_read_b64_tr_b16 v[114:115], v165 offset:2560
    s_add_u32 m0, s54, 4096
    s_add_u32 s78, s53, 32768
    buffer_load_dwordx4 v11, s[12:15], s78 offen offset:0 lds
    buffer_load_dwordx4 v12, s[12:15], s78 offen offset:1024 lds
    s_waitcnt lgkmcnt(2)
    v_mfma_f32_32x32x16_bf16 v[120:135], v[108:111], a[192:195], v[120:135]
    ds_read_b64_tr_b16 v[116:117], v165 offset:4096
    ds_read_b64_tr_b16 v[118:119], v165 offset:4608
    s_waitcnt lgkmcnt(2)
    v_mfma_f32_32x32x16_bf16 v[120:135], v[112:115], a[196:199], v[120:135]
    ds_read_b64_tr_b16 v[108:109], v165 offset:6144
    ds_read_b64_tr_b16 v[110:111], v165 offset:6656
    s_add_u32 m0, s54, 6144
    s_add_u32 s78, s53, 49152
    buffer_load_dwordx4 v11, s[12:15], s78 offen offset:0 lds
    buffer_load_dwordx4 v12, s[12:15], s78 offen offset:1024 lds
    s_waitcnt lgkmcnt(2)
    v_mfma_f32_32x32x16_bf16 v[120:135], v[116:119], a[200:203], v[120:135]
    ds_read_b64_tr_b16 v[112:113], v165 offset:8192
    ds_read_b64_tr_b16 v[114:115], v165 offset:8704
    s_waitcnt vmcnt(8)
    s_barrier
    s_cmp_lg_u32 s62, 0
    s_cbranch_scc1 L_nofl_1
    s_lshl_b32 s82, s52, 5
    s_add_u32 s82, s82, 16777216
    s_mov_b64 exec, 1
    buffer_store_dword v7, v6, s[28:31], s82 offen sc1
    s_mov_b64 exec, -1
L_nofl_1:
    s_waitcnt lgkmcnt(2)
    v_mfma_f32_32x32x16_bf16 v[120:135], v[108:111], a[204:207], v[120:135]
    ds_read_b64_tr_b16 v[116:117], v165 offset:10240
    ds_read_b64_tr_b16 v[118:119], v165 offset:10752
    s_add_u32 m0, s54, 65536
    s_add_u32 s78, s53, 65536
    buffer_load_dwordx4 v11, s[12:15], s78 offen offset:0 lds
    buffer_load_dwordx4 v12, s[12:15], s78 offen offset:1024 lds
    s_waitcnt lgkmcnt(2)
    v_mfma_f32_32x32x16_bf16 v[120:135], v[112:115], a[208:211], v[120:135]
    ds_read_b64_tr_b16 v[108:109], v165 offset:12288
    ds_read_b64_tr_b16 v[110:111], v165 offset:12800
    s_waitcnt lgkmcnt(2)
    v_mfma_f32_32x32x16_bf16 v[120:135], v[116:119], a[212:215], v[120:135]
    ds_read_b64_tr_b16 v[112:113], v165 offset:14336
    ds_read_b64_tr_b16 v[114:115], v165 offset:14848
    s_add_u32 m0, s54, 67584
    s_add_u32 s78, s53, 81920
    buffer_load_dwordx4 v11, s[12:15], s78 offen offset:0 lds
    buffer_load_dwordx4 v12, s[12:15], s78 offen offset:1024 lds
    s_waitcnt lgkmcnt(2)
    v_mfma_f32_32x32x16_bf16 v[120:135], v[108:111], a[216:219], v[120:135]
    ds_read_b64_tr_b16 v[116:117], v165 offset:16384
    ds_read_b64_tr_b16 v[118:119], v165 offset:16896
    s_waitcnt lgkmcnt(2)
    v_mfma_f32_32x32x16_bf16 v[120:135], v[112:115], a[220:223], v[120:135]
    ds_read_b64_tr_b16 v[108:109], v165 offset:18432
    ds_read_b64_tr_b16 v[110:111], v165 offset:18944
    s_add_u32 m0, s54, 69632
    s_add_u32 s78, s53, 98304
    buffer_load_dwordx4 v11, s[12:15], s78 offen offset:0 lds
    buffer_load_dwordx4 v12, s[12:15], s78 offen offset:1024 lds
    s_waitcnt lgkmcnt(2)
    v_mfma_f32_32x32x16_bf16 v[120:135], v[116:119], a[224:227], v[120:135]
    ds_read_b64_tr_b16 v[112:113], v165 offset:20480
    ds_read_b64_tr_b16 v[114:115], v165 offset:20992
    s_waitcnt lgkmcnt(2)
    v_mfma_f32_32x32x16_bf16 v[120:135], v[108:111], a[228:231], v[120:135]
    ds_read_b64_tr_b16 v[116:117], v165 offset:22528
    ds_read_b64_tr_b16 v[118:119], v165 offset:23040
    s_waitcnt lgkmcnt(2)
    v_mfma_f32_32x32x16_bf16 v[120:135], v[112:115], a[232:235], v[120:135]
    ds_read_b64_tr_b16 v[108:109], v165 offset:24576
    ds_read_b64_tr_b16 v[110:111], v165 offset:25088
    s_add_u32 m0, s54, 71680
    s_add_u32 s78, s53, 114688
    buffer_load_dwordx4 v11, s[12:15], s78 offen offset:0 lds
    buffer_load_dwordx4 v12, s[12:15], s78 offen offset:1024 lds
    s_waitcnt lgkmcnt(2)
    v_mfma_f32_32x32x16_bf16 v[120:135], v[116:119], a[236:239], v[120:135]
    ds_read_b64_tr_b16 v[112:113], v165 offset:26624
    ds_read_b64_tr_b16 v[114:115], v165 offset:27136
    s_waitcnt lgkmcnt(2)
    v_mfma_f32_32x32x16_bf16 v[120:135], v[108:111], a[240:243], v[120:135]
    ds_read_b64_tr_b16 v[116:117], v165 offset:28672
    ds_read_b64_tr_b16 v[118:119], v165 offset:29184
    s_waitcnt lgkmcnt(2)
    v_mfma_f32_32x32x16_bf16 v[120:135], v[112:115], a[244:247], v[120:135]
    ds_read_b64_tr_b16 v[108:109], v165 offset:30720
    ds_read_b64_tr_b16 v[110:111], v165 offset:31232
    s_waitcnt lgkmcnt(2)
    v_mfma_f32_32x32x16_bf16 v[120:135], v[116:119], a[248:251], v[120:135]
    s_waitcnt lgkmcnt(0)
    v_mfma_f32_32x32x16_bf16 v[120:135], v[108:111], a[252:255], v[120:135]
    s_nop 11
    v_mul_f32 v120, 0x3eb8aa3b, v120
    v_mul_f32 v121, 0x3eb8aa3b, v121
    v_mul_f32 v122, 0x3eb8aa3b, v122
    v_mul_f32 v123, 0x3eb8aa3b, v123
    v_mul_f32 v124, 0x3eb8aa3b, v124
    v_mul_f32 v125, 0x3eb8aa3b, v125
    v_mul_f32 v126, 0x3eb8aa3b, v126
    v_mul_f32 v127, 0x3eb8aa3b, v127
    v_mul_f32 v128, 0x3eb8aa3b, v128
    v_mul_f32 v129, 0x3eb8aa3b, v129
    v_mul_f32 v130, 0x3eb8aa3b, v130
    v_mul_f32 v131, 0x3eb8aa3b, v131
    v_mul_f32 v132, 0x3eb8aa3b, v132
    v_mul_f32 v133, 0x3eb8aa3b, v133
    v_mul_f32 v134, 0x3eb8aa3b, v134
    v_mul_f32 v135, 0x3eb8aa3b, v135
    v_cvt_pk_bf16_f32 v64, v120, v121
    v_cvt_pk_bf16_f32 v65, v122, v123
    v_cvt_pk_bf16_f32 v66, v124, v125
    v_cvt_pk_bf16_f32 v67, v126, v127
    v_cvt_pk_bf16_f32 v68, v128, v129
    v_cvt_pk_bf16_f32 v69, v130, v131
    v_cvt_pk_bf16_f32 v70, v132, v133
    v_cvt_pk_bf16_f32 v71, v134, v135
    ds_write_b128 v200, v[64:67]
    ds_write_b128 v200, v[68:71] offset:2048
    v_and_b32 v5, -13, v9
    v_lshlrev_b32 v5, 5, v5
    s_lshl_b32 s84, s60, 5
    s_add_u32 s84, s84, 16777216
    buffer_load_dword v8, v5, s[28:31], s84 offen sc1
    s_lshl_b32 s75, s64, 2
    s_add_u32 s75, s75, s62
    s_lshl_b32 s75, s75, 10
    s_lshl_b32 s74, s63, 1
    s_add_i32 s76, s74, -8
    s_max_i32 s76, s76, 0
    s_lshl_b32 s76, s76, 15
    s_add_u32 s85, s76, s75
    s_add_i32 s76, s74, -7
    s_max_i32 s76, s76, 0
    s_lshl_b32 s76, s76, 15
    s_add_u32 s86, s76, s75
    s_add_i32 s76, s74, -6
    s_max_i32 s76, s76, 0
    s_lshl_b32 s76, s76, 15
    s_add_u32 s87, s76, s75
    s_add_i32 s76, s74, -5
    s_max_i32 s76, s76, 0
    s_lshl_b32 s76, s76, 15
    s_add_u32 s88, s76, s75
    s_add_i32 s76, s74, -4
    s_max_i32 s76, s76, 0
    s_lshl_b32 s76, s76, 15
    s_add_u32 s89, s76, s75
    s_add_i32 s76, s74, -3
    s_max_i32 s76, s76, 0
    s_lshl_b32 s76, s76, 15
    s_add_u32 s90, s76, s75
    s_add_i32 s76, s74, -2
    s_max_i32 s76, s76, 0
    s_lshl_b32 s76, s76, 15
    s_add_u32 s91, s76, s75
    s_add_i32 s76, s74, -1
    s_max_i32 s76, s76, 0
    s_lshl_b32 s76, s76, 15
    s_add_u32 s92, s76, s75
    s_add_i32 s76, s74, 0
    s_max_i32 s76, s76, 0
    s_lshl_b32 s76, s76, 15
    s_add_u32 s93, s76, s75
    s_add_i32 s76, s74, 1
    s_max_i32 s76, s76, 0
    s_lshl_b32 s76, s76, 15
    s_add_u32 s94, s76, s75
    s_waitcnt lgkmcnt(0)
    s_barrier
    ds_read_b128 v[64:67], v201
    ds_read_b128 v[68:71], v201 offset:1024
    s_cmp_eq_u32 s69, 0
    s_cselect_b32 s74, 128, 0
    s_sub_u32 s40, s56, s74
    s_waitcnt vmcnt(0)
    v_cmp_ne_u32 vcc, s70, v8
    s_nop 0
    s_cbranch_vccnz L_retry_2
L_back_3:
    buffer_load_dwordx4 a[32:35], v207, s[28:31], s93 offen sc1
    s_mov_b32 exec_lo, 0xffff
    s_mov_b32 exec_hi, 0xffff
    buffer_load_dwordx4 a[104:107], v206, s[28:31], s93 offen offset:0 sc1
    buffer_load_dwordx4 a[108:111], v206, s[28:31], s93 offen offset:512 sc1
    s_mov_b64 exec, -1
    buffer_load_dwordx4 a[28:31], v207, s[28:31], s92 offen sc1
    s_mov_b32 exec_lo, 0xffff
    s_mov_b32 exec_hi, 0xffff
    buffer_load_dwordx4 a[96:99], v206, s[28:31], s92 offen offset:0 sc1
    buffer_load_dwordx4 a[100:103], v206, s[28:31], s92 offen offset:512 sc1
    s_mov_b64 exec, -1
    buffer_load_dwordx4 a[24:27], v207, s[28:31], s91 offen sc1
    s_mov_b32 exec_lo, 0xffff
    s_mov_b32 exec_hi, 0xffff
    buffer_load_dwordx4 a[88:91], v206, s[28:31], s91 offen offset:0 sc1
    buffer_load_dwordx4 a[92:95], v206, s[28:31], s91 offen offset:512 sc1
    s_mov_b64 exec, -1
    buffer_load_dwordx4 a[20:23], v207, s[28:31], s90 offen sc1
    s_mov_b32 exec_lo, 0xffff
    s_mov_b32 exec_hi, 0xffff
    buffer_load_dwordx4 a[80:83], v206, s[28:31], s90 offen offset:0 sc1
    buffer_load_dwordx4 a[84:87], v206, s[28:31], s90 offen offset:512 sc1
    s_mov_b64 exec, -1
    buffer_load_dwordx4 a[16:19], v207, s[28:31], s89 offen sc1
    s_mov_b32 exec_lo, 0xffff
    s_mov_b32 exec_hi, 0xffff
    buffer_load_dwordx4 a[72:75], v206, s[28:31], s89 offen offset:0 sc1
    buffer_load_dwordx4 a[76:79], v206, s[28:31], s89 offen offset:512 sc1
    s_mov_b64 exec, -1
    v_min_u32 v9, 7, v0
    v_lshlrev_b32 v9, 2, v9
    ds_read_b64_tr_b16 a[120:121], v15 offset:0
    ds_read_b64_tr_b16 a[122:123], v15 offset:1024
    ds_read_b64_tr_b16 a[124:125], v16 offset:0
    ds_read_b64_tr_b16 a[126:127], v16 offset:1024
    ds_read_b64_tr_b16 a[128:129], v15 offset:2048
    ds_read_b64_tr_b16 a[130:131], v15 offset:3072
    ds_read_b64_tr_b16 a[132:133], v16 offset:2048
    ds_read_b64_tr_b16 a[134:135], v16 offset:3072
    ds_read_b64_tr_b16 a[136:137], v15 offset:4096
    ds_read_b64_tr_b16 a[138:139], v15 offset:5120
    ds_read_b64_tr_b16 a[140:141], v16 offset:4096
    ds_read_b64_tr_b16 a[142:143], v16 offset:5120
    ds_read_b64_tr_b16 a[144:145], v15 offset:6144
    ds_read_b64_tr_b16 a[146:147], v15 offset:7168
    ds_read_b64_tr_b16 a[148:149], v16 offset:6144
    ds_read_b64_tr_b16 a[150:151], v16 offset:7168
    ds_read_b64_tr_b16 a[152:153], v44 offset:0
    ds_read_b64_tr_b16 a[154:155], v44 offset:1024
    ds_read_b64_tr_b16 a[156:157], v45 offset:0
    ds_read_b64_tr_b16 a[158:159], v45 offset:1024
    ds_read_b64_tr_b16 a[160:161], v44 offset:2048
    ds_read_b64_tr_b16 a[162:163], v44 offset:3072
    ds_read_b64_tr_b16 a[164:165], v45 offset:2048
    ds_read_b64_tr_b16 a[166:167], v45 offset:3072
    ds_read_b64_tr_b16 a[168:169], v44 offset:4096
    ds_read_b64_tr_b16 a[170:171], v44 offset:5120
    ds_read_b64_tr_b16 a[172:173], v45 offset:4096
    ds_read_b64_tr_b16 a[174:175], v45 offset:5120
    ds_read_b64_tr_b16 a[176:177], v44 offset:6144
    ds_read_b64_tr_b16 a[178:179], v44 offset:7168
    ds_read_b64_tr_b16 a[180:181], v45 offset:6144
    ds_read_b64_tr_b16 a[182:183], v45 offset:7168
    s_waitcnt lgkmcnt(0)
    s_barrier
    s_cmp_lt_u32 s63, 4
    s_cbranch_scc1 L_att_small
    s_waitcnt vmcnt(14)
    v_mfma_f32_32x32x16_bf16 v[104:119], a[32:35], v[64:67], v[224:239]
    buffer_load_dwordx4 a[12:15], v207, s[28:31], s88 offen sc1
    s_mov_b32 exec_lo, 0xffff
    s_mov_b32 exec_hi, 0xffff
    buffer_load_dwordx4 a[64:67], v206, s[28:31], s88 offen offset:0 sc1
    buffer_load_dwordx4 a[68:71], v206, s[28:31], s88 offen offset:512 sc1
    s_mov_b64 exec, -1
    s_nop 5
    v_max3_f32 v200, v104, v105, v106
    v_max3_f32 v201, v107, v108, v109
    v_max3_f32 v200, v110, v111, v200
    v_max3_f32 v201, v112, v113, v201
    v_max3_f32 v200, v114, v115, v200
    v_max3_f32 v201, v116, v117, v201
    v_max3_f32 v200, v118, v119, v200
    v_max_f32 v200, v200, v201
    v_mov_b32 v201, v200
    s_nop 1
    v_permlane32_swap_b32 v200, v201
    v_max_f32 v200, v200, v201
    v_cvt_pk_bf16_f32 v216, -v200, 0
    s_nop 1
    v_mfma_f32_32x32x16_bf16 v[120:135], v[212:215], v[216:219], 0
    v_mfma_f32_32x32x16_bf16 v[72:87], v[212:215], v[216:219], v[224:239]
    v_mfma_f32_32x32x16_bf16 v[72:87], a[32:35], v[64:67], v[72:87]
    s_nop 11
    v_exp_f32 v72, v72
    v_exp_f32 v73, v73
    v_exp_f32 v74, v74
    v_exp_f32 v75, v75
    v_exp_f32 v76, v76
    v_cvt_pk_bf16_f32 v152, v72, v73
    s_waitcnt vmcnt(14)
    v_mfma_f32_32x32x16_bf16 v[88:103], a[28:31], v[64:67], v[120:135]
    v_exp_f32 v77, v77
    v_cvt_pk_bf16_f32 v153, v74, v75
    v_exp_f32 v78, v78
    v_exp_f32 v79, v79
    v_exp_f32 v80, v80
    v_cvt_pk_bf16_f32 v154, v76, v77
    v_exp_f32 v81, v81
    v_cvt_pk_bf16_f32 v155, v78, v79
    v_exp_f32 v82, v82
    v_exp_f32 v83, v83
    v_mfma_f32_32x32x16_bf16 v[160:175], a[104:107], v[152:155], 0
    buffer_load_dwordx4 a[8:11], v207, s[28:31], s87 offen sc1
    s_mov_b32 exec_lo, 0xffff
    s_mov_b32 exec_hi, 0xffff
    buffer_load_dwordx4 a[56:59], v206, s[28:31], s87 offen offset:0 sc1
    buffer_load_dwordx4 a[60:63], v206, s[28:31], s87 offen offset:512 sc1
    s_mov_b64 exec, -1
    v_exp_f32 v84, v84
    v_cvt_pk_bf16_f32 v156, v80, v81
    v_exp_f32 v85, v85
    v_cvt_pk_bf16_f32 v157, v82, v83
    v_exp_f32 v86, v86
    v_exp_f32 v87, v87
    v_cvt_pk_bf16_f32 v158, v84, v85
    s_add_u32 m0, s54, 32768
    s_add_u32 s78, s55, 0
    buffer_load_dwordx4 v208, s[16:19], s78 offen offset:0 lds
    buffer_load_dwordx4 v209, s[16:19], s78 offen offset:1024 lds
    v_cvt_pk_bf16_f32 v159, v86, v87
    v_exp_f32 v88, v88
    v_exp_f32 v89, v89
    v_mfma_f32_32x32x16_bf16 v[160:175], a[108:111], v[156:159], v[160:175]
    v_exp_f32 v90, v90
    v_exp_f32 v91, v91
    v_exp_f32 v92, v92
    v_cvt_pk_bf16_f32 v152, v88, v89
    s_waitcnt vmcnt(16)
    v_mfma_f32_32x32x16_bf16 v[72:87], a[24:27], v[64:67], v[120:135]
    v_exp_f32 v93, v93
    v_cvt_pk_bf16_f32 v153, v90, v91
    v_exp_f32 v94, v94
    v_exp_f32 v95, v95
    v_exp_f32 v96, v96
    v_cvt_pk_bf16_f32 v154, v92, v93
    v_exp_f32 v97, v97
    v_cvt_pk_bf16_f32 v155, v94, v95
    v_exp_f32 v98, v98
    v_exp_f32 v99, v99
    v_mfma_f32_32x32x16_bf16 v[160:175], a[96:99], v[152:155], v[160:175]
    buffer_load_dwordx4 a[4:7], v207, s[28:31], s86 offen sc1
    s_mov_b32 exec_lo, 0xffff
    s_mov_b32 exec_hi, 0xffff
    buffer_load_dwordx4 a[48:51], v206, s[28:31], s86 offen offset:0 sc1
    buffer_load_dwordx4 a[52:55], v206, s[28:31], s86 offen offset:512 sc1
    s_mov_b64 exec, -1
    v_exp_f32 v100, v100
    v_cvt_pk_bf16_f32 v156, v96, v97
    v_exp_f32 v101, v101
    v_cvt_pk_bf16_f32 v157, v98, v99
    v_exp_f32 v102, v102
    v_exp_f32 v103, v103
    v_cvt_pk_bf16_f32 v158, v100, v101
    s_add_u32 m0, s54, 34816
    s_add_u32 s78, s55, 28672
    buffer_load_dwordx4 v208, s[16:19], s78 offen offset:0 lds
    buffer_load_dwordx4 v209, s[16:19], s78 offen offset:1024 lds
    v_cvt_pk_bf16_f32 v159, v102, v103
    v_exp_f32 v72, v72
    v_exp_f32 v73, v73
    v_mfma_f32_32x32x16_bf16 v[160:175], a[100:103], v[156:159], v[160:175]
    v_exp_f32 v74, v74
    v_exp_f32 v75, v75
    v_exp_f32 v76, v76
    v_cvt_pk_bf16_f32 v152, v72, v73
    s_waitcnt vmcnt(18)
    v_mfma_f32_32x32x16_bf16 v[88:103], a[20:23], v[64:67], v[120:135]
    v_exp_f32 v77, v77
    v_cvt_pk_bf16_f32 v153, v74, v75
    v_exp_f32 v78, v78
    v_exp_f32 v79, v79
    v_exp_f32 v80, v80
    v_cvt_pk_bf16_f32 v154, v76, v77
    v_exp_f32 v81, v81
    v_cvt_pk_bf16_f32 v155, v78, v79
    v_exp_f32 v82, v82
    v_exp_f32 v83, v83
    v_mfma_f32_32x32x16_bf16 v[160:175], a[88:91], v[152:155], v[160:175]
    buffer_load_dwordx4 a[0:3], v207, s[28:31], s85 offen sc1
    s_mov_b32 exec_lo, 0xffff
    s_mov_b32 exec_hi, 0xffff
    buffer_load_dwordx4 a[40:43], v206, s[28:31], s85 offen offset:0 sc1
    buffer_load_dwordx4 a[44:47], v206, s[28:31], s85 offen offset:512 sc1
    s_mov_b64 exec, -1
    v_exp_f32 v84, v84
    v_cvt_pk_bf16_f32 v156, v80, v81
    v_exp_f32 v85, v85
    v_cvt_pk_bf16_f32 v157, v82, v83
    v_exp_f32 v86, v86
    v_exp_f32 v87, v87
    v_cvt_pk_bf16_f32 v158, v84, v85
    s_add_u32 m0, s54, 36864
    s_add_u32 s78, s55, 57344
    buffer_load_dwordx4 v208, s[16:19], s78 offen offset:0 lds
    buffer_load_dwordx4 v209, s[16:19], s78 offen offset:1024 lds
    v_cvt_pk_bf16_f32 v159, v86, v87
    v_exp_f32 v88, v88
    v_exp_f32 v89, v89
    v_mfma_f32_32x32x16_bf16 v[160:175], a[92:95], v[156:159], v[160:175]
    v_exp_f32 v90, v90
    v_exp_f32 v91, v91
    v_exp_f32 v92, v92
    v_cvt_pk_bf16_f32 v152, v88, v89
    s_waitcnt vmcnt(20)
    v_mfma_f32_32x32x16_bf16 v[72:87], a[16:19], v[64:67], v[120:135]
    v_exp_f32 v93, v93
    v_cvt_pk_bf16_f32 v153, v90, v91
    v_exp_f32 v94, v94
    v_exp_f32 v95, v95
    v_exp_f32 v96, v96
    v_cvt_pk_bf16_f32 v154, v92, v93
    v_exp_f32 v97, v97
    v_cvt_pk_bf16_f32 v155, v94, v95
    v_exp_f32 v98, v98
    v_exp_f32 v99, v99
    v_mfma_f32_32x32x16_bf16 v[160:175], a[80:83], v[152:155], v[160:175]
    buffer_load_dwordx4 a[36:39], v207, s[28:31], s94 offen sc1
    s_mov_b32 exec_lo, 0xffff
    s_mov_b32 exec_hi, 0xffff
    buffer_load_dwordx4 a[112:115], v206, s[28:31], s94 offen offset:0 sc1
    buffer_load_dwordx4 a[116:119], v206, s[28:31], s94 offen offset:512 sc1
    s_mov_b64 exec, -1
    v_exp_f32 v100, v100
    v_cvt_pk_bf16_f32 v156, v96, v97
    v_exp_f32 v101, v101
    v_cvt_pk_bf16_f32 v157, v98, v99
    v_exp_f32 v102, v102
    v_exp_f32 v103, v103
    v_cvt_pk_bf16_f32 v158, v100, v101
    s_add_u32 m0, s54, 38912
    s_add_u32 s78, s55, 86016
    buffer_load_dwordx4 v208, s[16:19], s78 offen offset:0 lds
    buffer_load_dwordx4 v209, s[16:19], s78 offen offset:1024 lds
    v_cvt_pk_bf16_f32 v159, v102, v103
    v_exp_f32 v72, v72
    v_exp_f32 v73, v73
    v_mfma_f32_32x32x16_bf16 v[160:175], a[84:87], v[156:159], v[160:175]
    v_exp_f32 v74, v74
    v_exp_f32 v75, v75
    v_exp_f32 v76, v76
    v_cvt_pk_bf16_f32 v152, v72, v73
    s_waitcnt vmcnt(22)
    v_mfma_f32_32x32x16_bf16 v[88:103], a[12:15], v[64:67], v[120:135]
    v_exp_f32 v77, v77
    v_cvt_pk_bf16_f32 v153, v74, v75
    v_exp_f32 v78, v78
    v_exp_f32 v79, v79
    v_exp_f32 v80, v80
    v_cvt_pk_bf16_f32 v154, v76, v77
    v_exp_f32 v81, v81
    v_cvt_pk_bf16_f32 v155, v78, v79
    v_exp_f32 v82, v82
    v_exp_f32 v83, v83
    v_mfma_f32_32x32x16_bf16 v[160:175], a[72:75], v[152:155], v[160:175]
    s_add_u32 m0, s54, 0
    s_add_u32 s78, s40, 0
    buffer_load_dwordx4 v11, s[20:23], s78 offen offset:0 lds
    buffer_load_dwordx4 v12, s[20:23], s78 offen offset:1024 lds
    v_exp_f32 v84, v84
    v_cvt_pk_bf16_f32 v156, v80, v81
    v_exp_f32 v85, v85
    v_cvt_pk_bf16_f32 v157, v82, v83
    v_exp_f32 v86, v86
    v_exp_f32 v87, v87
    v_cvt_pk_bf16_f32 v158, v84, v85
    s_add_u32 m0, s54, 2048
    s_add_u32 s78, s40, 16384
    buffer_load_dwordx4 v11, s[20:23], s78 offen offset:0 lds
    buffer_load_dwordx4 v12, s[20:23], s78 offen offset:1024 lds
    v_cvt_pk_bf16_f32 v159, v86, v87
    v_exp_f32 v88, v88
    v_exp_f32 v89, v89
    v_mfma_f32_32x32x16_bf16 v[160:175], a[76:79], v[156:159], v[160:175]
    v_exp_f32 v90, v90
    v_exp_f32 v91, v91
    v_exp_f32 v92, v92
    v_cvt_pk_bf16_f32 v152, v88, v89
    s_waitcnt vmcnt(23)
    v_mfma_f32_32x32x16_bf16 v[72:87], a[8:11], v[64:67], v[120:135]
    v_exp_f32 v93, v93
    v_cvt_pk_bf16_f32 v153, v90, v91
    v_exp_f32 v94, v94
    v_exp_f32 v95, v95
    v_exp_f32 v96, v96
    v_cvt_pk_bf16_f32 v154, v92, v93
    v_exp_f32 v97, v97
    v_cvt_pk_bf16_f32 v155, v94, v95
    v_exp_f32 v98, v98
    v_exp_f32 v99, v99
    v_mfma_f32_32x32x16_bf16 v[160:175], a[64:67], v[152:155], v[160:175]
    s_add_u32 m0, s54, 4096
    s_add_u32 s78, s40, 32768
    buffer_load_dwordx4 v11, s[20:23], s78 offen offset:0 lds
    buffer_load_dwordx4 v12, s[20:23], s78 offen offset:1024 lds
    v_exp_f32 v100, v100
    v_cvt_pk_bf16_f32 v156, v96, v97
    v_exp_f32 v101, v101
    v_cvt_pk_bf16_f32 v157, v98, v99
    v_exp_f32 v102, v102
    v_exp_f32 v103, v103
    v_cvt_pk_bf16_f32 v158, v100, v101
    s_add_u32 m0, s54, 65536
    s_add_u32 s78, s55, 458752
    buffer_load_dwordx4 v208, s[16:19], s78 offen offset:0 lds
    buffer_load_dwordx4 v209, s[16:19], s78 offen offset:1024 lds
    v_cvt_pk_bf16_f32 v159, v102, v103
    v_exp_f32 v72, v72
    v_exp_f32 v73, v73
    v_mfma_f32_32x32x16_bf16 v[160:175], a[68:71], v[156:159], v[160:175]
    v_exp_f32 v74, v74
    v_exp_f32 v75, v75
    v_exp_f32 v76, v76
    v_cvt_pk_bf16_f32 v152, v72, v73
    s_waitcnt vmcnt(22)
    v_mfma_f32_32x32x16_bf16 v[88:103], a[4:7], v[64:67], v[120:135]
    s_waitcnt vmcnt(12)
    v_mfma_f32_32x32x16_bf16 v[104:119], a[36:39], v[68:71], v[224:239]
    v_exp_f32 v77, v77
    v_cvt_pk_bf16_f32 v153, v74, v75
    v_exp_f32 v78, v78
    v_exp_f32 v79, v79
    v_exp_f32 v80, v80
    v_cvt_pk_bf16_f32 v154, v76, v77
    v_exp_f32 v81, v81
    v_cvt_pk_bf16_f32 v155, v78, v79
    v_exp_f32 v82, v82
    v_exp_f32 v83, v83
    v_mfma_f32_32x32x16_bf16 v[160:175], a[56:59], v[152:155], v[160:175]
    s_add_u32 m0, s54, 67584
    s_add_u32 s78, s55, 487424
    buffer_load_dwordx4 v208, s[16:19], s78 offen offset:0 lds
    buffer_load_dwordx4 v209, s[16:19], s78 offen offset:1024 lds
    v_exp_f32 v84, v84
    v_cvt_pk_bf16_f32 v156, v80, v81
    v_exp_f32 v85, v85
    v_cvt_pk_bf16_f32 v157, v82, v83
    v_exp_f32 v86, v86
    v_exp_f32 v87, v87
    v_cvt_pk_bf16_f32 v158, v84, v85
    s_add_u32 m0, s54, 69632
    s_add_u32 s78, s55, 516096
    buffer_load_dwordx4 v208, s[16:19], s78 offen offset:0 lds
    buffer_load_dwordx4 v209, s[16:19], s78 offen offset:1024 lds
    v_cvt_pk_bf16_f32 v159, v86, v87
    v_exp_f32 v88, v88
    v_exp_f32 v89, v89
    v_mfma_f32_32x32x16_bf16 v[160:175], a[60:63], v[156:159], v[160:175]
    v_exp_f32 v90, v90
    v_exp_f32 v91, v91
    v_exp_f32 v92, v92
    v_cvt_pk_bf16_f32 v152, v88, v89
    v_max3_f32 v202, v104, v105, v106
    v_max3_f32 v203, v107, v108, v109
    v_max3_f32 v202, v110, v111, v202
    v_max3_f32 v203, v112, v113, v203
    v_max3_f32 v202, v114, v115, v202
    v_max3_f32 v203, v116, v117, v203
    v_max3_f32 v202, v118, v119, v202
    v_max_f32 v202, v202, v203
    v_mov_b32 v203, v202
    s_nop 1
    v_permlane32_swap_b32 v202, v203
    v_max_f32 v202, v202, v203
    v_cvt_pk_bf16_f32 v220, -v202, 0
    s_nop 1
    v_mfma_f32_32x32x16_bf16 v[136:151], v[212:215], v[220:223], 0
    v_mfma_f32_32x32x16_bf16 v[72:87], v[212:215], v[216:219], v[240:255]
    v_exp_f32 v93, v93
    v_cvt_pk_bf16_f32 v153, v90, v91
    v_exp_f32 v94, v94
    v_exp_f32 v95, v95
    v_mfma_f32_32x32x16_bf16 v[72:87], a[0:3], v[64:67], v[72:87]
    v_exp_f32 v96, v96
    v_cvt_pk_bf16_f32 v154, v92, v93
    v_exp_f32 v97, v97
    v_cvt_pk_bf16_f32 v155, v94, v95
    v_exp_f32 v98, v98
    v_exp_f32 v99, v99
    v_mfma_f32_32x32x16_bf16 v[160:175], a[48:51], v[152:155], v[160:175]
    s_add_u32 m0, s54, 71680
    s_add_u32 s78, s55, 544768
    buffer_load_dwordx4 v208, s[16:19], s78 offen offset:0 lds
    buffer_load_dwordx4 v209, s[16:19], s78 offen offset:1024 lds
    v_exp_f32 v100, v100
    v_cvt_pk_bf16_f32 v156, v96, v97
    v_exp_f32 v101, v101
    v_cvt_pk_bf16_f32 v157, v98, v99
    v_exp_f32 v102, v102
    v_exp_f32 v103, v103
    v_cvt_pk_bf16_f32 v158, v100, v101
    s_waitcnt vmcnt(8)
    ds_read_b64_tr_b16 a[184:185], v15 offset:0
    ds_read_b64_tr_b16 a[186:187], v15 offset:1024
    ds_read_b64_tr_b16 a[188:189], v16 offset:0
    ds_read_b64_tr_b16 a[190:191], v16 offset:1024
    ds_read_b64_tr_b16 a[192:193], v15 offset:2048
    ds_read_b64_tr_b16 a[194:195], v15 offset:3072
    v_cvt_pk_bf16_f32 v159, v102, v103
    v_exp_f32 v72, v72
    v_exp_f32 v73, v73
    v_mfma_f32_32x32x16_bf16 v[160:175], a[52:55], v[156:159], v[160:175]
    v_exp_f32 v74, v74
    v_exp_f32 v75, v75
    v_exp_f32 v76, v76
    v_cvt_pk_bf16_f32 v152, v72, v73
    v_mfma_f32_32x32x16_bf16 v[88:103], v[212:215], v[220:223], v[224:239]
    v_exp_f32 v77, v77
    v_cvt_pk_bf16_f32 v153, v74, v75
    v_exp_f32 v78, v78
    v_exp_f32 v79, v79
    v_mfma_f32_32x32x16_bf16 v[88:103], a[36:39], v[68:71], v[88:103]
    v_exp_f32 v80, v80
    v_cvt_pk_bf16_f32 v154, v76, v77
    v_exp_f32 v81, v81
    v_cvt_pk_bf16_f32 v155, v78, v79
    v_exp_f32 v82, v82
    v_exp_f32 v83, v83
    v_mfma_f32_32x32x16_bf16 v[160:175], a[40:43], v[152:155], v[160:175]
    ds_read_b64_tr_b16 a[196:197], v16 offset:2048
    ds_read_b64_tr_b16 a[198:199], v16 offset:3072
    ds_read_b64_tr_b16 a[200:201], v15 offset:4096
    ds_read_b64_tr_b16 a[202:203], v15 offset:5120
    ds_read_b64_tr_b16 a[204:205], v16 offset:4096
    ds_read_b64_tr_b16 a[206:207], v16 offset:5120
    v_exp_f32 v84, v84
    v_cvt_pk_bf16_f32 v156, v80, v81
    v_exp_f32 v85, v85
    v_cvt_pk_bf16_f32 v157, v82, v83
    v_exp_f32 v86, v86
    v_exp_f32 v87, v87
    v_cvt_pk_bf16_f32 v158, v84, v85
    s_add_u32 m0, s54, 98304
    s_add_u32 s78, s55, 917504
    buffer_load_dwordx4 v208, s[16:19], s78 offen offset:0 lds
    buffer_load_dwordx4 v209, s[16:19], s78 offen offset:1024 lds
    v_cvt_pk_bf16_f32 v159, v86, v87
    v_exp_f32 v88, v88
    v_exp_f32 v89, v89
    v_mfma_f32_32x32x16_bf16 v[160:175], a[44:47], v[156:159], v[160:175]
    v_exp_f32 v90, v90
    v_exp_f32 v91, v91
    v_exp_f32 v92, v92
    v_cvt_pk_bf16_f32 v152, v88, v89
    v_mfma_f32_32x32x16_bf16 v[72:87], a[32:35], v[68:71], v[136:151]
    v_exp_f32 v93, v93
    v_cvt_pk_bf16_f32 v153, v90, v91
    v_exp_f32 v94, v94
    v_exp_f32 v95, v95
    v_exp_f32 v96, v96
    v_cvt_pk_bf16_f32 v154, v92, v93
    v_exp_f32 v97, v97
    v_cvt_pk_bf16_f32 v155, v94, v95
    v_exp_f32 v98, v98
    v_exp_f32 v99, v99
    v_mfma_f32_32x32x16_bf16 v[176:191], a[112:115], v[152:155], 0
    s_waitcnt lgkmcnt(0)
    s_add_u32 m0, s54, 0
    s_add_u32 s78, s40, 49152
    buffer_load_dwordx4 v11, s[20:23], s78 offen offset:0 lds
    buffer_load_dwordx4 v12, s[20:23], s78 offen offset:1024 lds
    v_exp_f32 v100, v100
    v_cvt_pk_bf16_f32 v156, v96, v97
    v_exp_f32 v101, v101
    v_cvt_pk_bf16_f32 v157, v98, v99
    v_exp_f32 v102, v102
    v_exp_f32 v103, v103
    v_cmp_nge_f32 vcc, 0x53800000, v168
    s_nop 0
    s_cbranch_vccnz L_exact_4
L_exact_4_back:
    v_rcp_f32 v204, v168
    s_nop 0
    v_mul_f32 v160, v204, v160
    v_mul_f32 v161, v204, v161
    v_mul_f32 v162, v204, v162
    v_mul_f32 v163, v204, v163
    v_mul_f32 v164, v204, v164
    v_mul_f32 v165, v204, v165
    v_mul_f32 v166, v204, v166
    v_mul_f32 v167, v204, v167
    v_cvt_pk_bf16_f32 v192, v160, v161
    v_cvt_pk_bf16_f32 v193, v162, v163
    v_cvt_pk_bf16_f32 v194, v164, v165
    v_cvt_pk_bf16_f32 v195, v166, v167
    buffer_store_dwordx4 v[192:195], v1, s[28:31], s57 offen sc1
    v_cvt_pk_bf16_f32 v158, v100, v101
    s_add_u32 m0, s54, 2048
    s_add_u32 s78, s40, 65536
    buffer_load_dwordx4 v11, s[20:23], s78 offen offset:0 lds
    buffer_load_dwordx4 v12, s[20:23], s78 offen offset:1024 lds
    v_cvt_pk_bf16_f32 v159, v102, v103
    v_exp_f32 v72, v72
    v_exp_f32 v73, v73
    v_mfma_f32_32x32x16_bf16 v[176:191], a[116:119], v[156:159], v[176:191]
    v_exp_f32 v74, v74
    v_exp_f32 v75, v75
    v_exp_f32 v76, v76
    v_cvt_pk_bf16_f32 v152, v72, v73
    v_mfma_f32_32x32x16_bf16 v[88:103], a[28:31], v[68:71], v[136:151]
    v_exp_f32 v77, v77
    v_cvt_pk_bf16_f32 v153, v74, v75
    v_exp_f32 v78, v78
    v_exp_f32 v79, v79
    v_exp_f32 v80, v80
    v_cvt_pk_bf16_f32 v154, v76, v77
    v_exp_f32 v81, v81
    v_cvt_pk_bf16_f32 v155, v78, v79
    v_exp_f32 v82, v82
    v_exp_f32 v83, v83
    v_mfma_f32_32x32x16_bf16 v[176:191], a[104:107], v[152:155], v[176:191]
    s_add_u32 m0, s54, 4096
    s_add_u32 s78, s40, 81920
    buffer_load_dwordx4 v11, s[20:23], s78 offen offset:0 lds
    buffer_load_dwordx4 v12, s[20:23], s78 offen offset:1024 lds
    v_exp_f32 v84, v84
    v_cvt_pk_bf16_f32 v156, v80, v81
    v_exp_f32 v85, v85
    v_cvt_pk_bf16_f32 v157, v82, v83
    v_exp_f32 v86, v86
    v_exp_f32 v87, v87
    v_cvt_pk_bf16_f32 v158, v84, v85
    s_add_u32 m0, s54, 100352
    s_add_u32 s78, s55, 946176
    buffer_load_dwordx4 v208, s[16:19], s78 offen offset:0 lds
    buffer_load_dwordx4 v209, s[16:19], s78 offen offset:1024 lds
    v_cvt_pk_bf16_f32 v159, v86, v87
    v_exp_f32 v88, v88
    v_exp_f32 v89, v89
    v_mfma_f32_32x32x16_bf16 v[176:191], a[108:111], v[156:159], v[176:191]
    v_exp_f32 v90, v90
    v_exp_f32 v91, v91
    v_exp_f32 v92, v92
    v_cvt_pk_bf16_f32 v152, v88, v89
    v_mfma_f32_32x32x16_bf16 v[72:87], a[24:27], v[68:71], v[136:151]
    v_exp_f32 v93, v93
    v_cvt_pk_bf16_f32 v153, v90, v91
    v_exp_f32 v94, v94
    v_exp_f32 v95, v95
    v_exp_f32 v96, v96
    v_cvt_pk_bf16_f32 v154, v92, v93
    v_exp_f32 v97, v97
    v_cvt_pk_bf16_f32 v155, v94, v95
    v_exp_f32 v98, v98
    v_exp_f32 v99, v99
    v_mfma_f32_32x32x16_bf16 v[176:191], a[96:99], v[152:155], v[176:191]
    s_add_u32 m0, s54, 102400
    s_add_u32 s78, s55, 974848
    buffer_load_dwordx4 v208, s[16:19], s78 offen offset:0 lds
    buffer_load_dwordx4 v209, s[16:19], s78 offen offset:1024 lds
    v_exp_f32 v100, v100
    v_cvt_pk_bf16_f32 v156, v96, v97
    v_exp_f32 v101, v101
    v_cvt_pk_bf16_f32 v157, v98, v99
    v_exp_f32 v102, v102
    v_exp_f32 v103, v103
    v_cvt_pk_bf16_f32 v158, v100, v101
    s_add_u32 m0, s54, 104448
    s_add_u32 s78, s55, 1003520
    buffer_load_dwordx4 v208, s[16:19], s78 offen offset:0 lds
    buffer_load_dwordx4 v209, s[16:19], s78 offen offset:1024 lds
    v_cvt_pk_bf16_f32 v159, v102, v103
    v_exp_f32 v72, v72
    v_exp_f32 v73, v73
    v_mfma_f32_32x32x16_bf16 v[176:191], a[100:103], v[156:159], v[176:191]
    v_exp_f32 v74, v74
    v_exp_f32 v75, v75
    v_exp_f32 v76, v76
    v_cvt_pk_bf16_f32 v152, v72, v73
    v_mfma_f32_32x32x16_bf16 v[88:103], a[20:23], v[68:71], v[136:151]
    v_exp_f32 v77, v77
    v_cvt_pk_bf16_f32 v153, v74, v75
    v_exp_f32 v78, v78
    v_exp_f32 v79, v79
    v_exp_f32 v80, v80
    v_cvt_pk_bf16_f32 v154, v76, v77
    v_exp_f32 v81, v81
    v_cvt_pk_bf16_f32 v155, v78, v79
    v_exp_f32 v82, v82
    v_exp_f32 v83, v83
    v_mfma_f32_32x32x16_bf16 v[176:191], a[88:91], v[152:155], v[176:191]
    s_waitcnt vmcnt(6)
    ds_read_b64_tr_b16 a[208:209], v15 offset:0
    ds_read_b64_tr_b16 a[210:211], v15 offset:1024
    ds_read_b64_tr_b16 a[212:213], v16 offset:0
    ds_read_b64_tr_b16 a[214:215], v16 offset:1024
    ds_read_b64_tr_b16 a[216:217], v15 offset:2048
    ds_read_b64_tr_b16 a[218:219], v15 offset:3072
    v_exp_f32 v84, v84
    v_cvt_pk_bf16_f32 v156, v80, v81
    v_exp_f32 v85, v85
    v_cvt_pk_bf16_f32 v157, v82, v83
    v_exp_f32 v86, v86
    v_exp_f32 v87, v87
    v_cvt_pk_bf16_f32 v158, v84, v85
    ds_read_b64_tr_b16 a[220:221], v16 offset:2048
    ds_read_b64_tr_b16 a[222:223], v16 offset:3072
    ds_read_b64_tr_b16 a[224:225], v15 offset:4096
    ds_read_b64_tr_b16 a[226:227], v15 offset:5120
    ds_read_b64_tr_b16 a[228:229], v16 offset:4096
    ds_read_b64_tr_b16 a[230:231], v16 offset:5120
    v_cvt_pk_bf16_f32 v159, v86, v87
    v_exp_f32 v88, v88
    v_exp_f32 v89, v89
    v_mfma_f32_32x32x16_bf16 v[176:191], a[92:95], v[156:159], v[176:191]
    v_exp_f32 v90, v90
    v_exp_f32 v91, v91
    v_exp_f32 v92, v92
    v_cvt_pk_bf16_f32 v152, v88, v89
    v_mfma_f32_32x32x16_bf16 v[72:87], a[16:19], v[68:71], v[136:151]
    v_exp_f32 v93, v93
    v_cvt_pk_bf16_f32 v153, v90, v91
    v_exp_f32 v94, v94
    v_exp_f32 v95, v95
    v_exp_f32 v96, v96
    v_cvt_pk_bf16_f32 v154, v92, v93
    v_exp_f32 v97, v97
    v_cvt_pk_bf16_f32 v155, v94, v95
    v_exp_f32 v98, v98
    v_exp_f32 v99, v99
    v_mfma_f32_32x32x16_bf16 v[176:191], a[80:83], v[152:155], v[176:191]
    s_add_u32 m0, s54, 131072
    s_add_u32 s78, s55, 1376256
    buffer_load_dwordx4 v208, s[16:19], s78 offen offset:0 lds
    buffer_load_dwordx4 v209, s[16:19], s78 offen offset:1024 lds
    v_exp_f32 v100, v100
    v_cvt_pk_bf16_f32 v156, v96, v97
    v_exp_f32 v101, v101
    v_cvt_pk_bf16_f32 v157, v98, v99
    v_exp_f32 v102, v102
    v_exp_f32 v103, v103
    v_cvt_pk_bf16_f32 v158, v100, v101
    s_waitcnt lgkmcnt(0)
    s_add_u32 m0, s54, 0
    s_add_u32 s78, s40, 98304
    buffer_load_dwordx4 v11, s[20:23], s78 offen offset:0 lds
    buffer_load_dwordx4 v12, s[20:23], s78 offen offset:1024 lds
    v_cvt_pk_bf16_f32 v159, v102, v103
    s_barrier
    s_cmp_lg_u32 s62, 0
    s_cbranch_scc1 L_nofl_5
    s_lshl_b32 s82, s58, 5
    s_add_u32 s82, s82, 16777216
    s_mov_b64 exec, 1
    buffer_store_dword v7, v6, s[28:31], s82 offen sc1
    s_mov_b64 exec, -1
L_nofl_5:
    v_exp_f32 v72, v72
    v_exp_f32 v73, v73
    v_mfma_f32_32x32x16_bf16 v[176:191], a[84:87], v[156:159], v[176:191]
    v_exp_f32 v74, v74
    v_exp_f32 v75, v75
    v_exp_f32 v76, v76
    v_cvt_pk_bf16_f32 v152, v72, v73
    v_mfma_f32_32x32x16_bf16 v[88:103], a[12:15], v[68:71], v[136:151]
    v_exp_f32 v77, v77
    v_cvt_pk_bf16_f32 v153, v74, v75
    v_exp_f32 v78, v78
    v_exp_f32 v79, v79
    v_exp_f32 v80, v80
    v_cvt_pk_bf16_f32 v154, v76, v77
    v_exp_f32 v81, v81
    v_cvt_pk_bf16_f32 v155, v78, v79
    v_exp_f32 v82, v82
    v_exp_f32 v83, v83
    v_mfma_f32_32x32x16_bf16 v[176:191], a[72:75], v[152:155], v[176:191]
    s_add_u32 m0, s54, 2048
    s_add_u32 s78, s40, 114688
    buffer_load_dwordx4 v11, s[20:23], s78 offen offset:0 lds
    buffer_load_dwordx4 v12, s[20:23], s78 offen offset:1024 lds
    v_exp_f32 v84, v84
    v_cvt_pk_bf16_f32 v156, v80, v81
    v_exp_f32 v85, v85
    v_cvt_pk_bf16_f32 v157, v82, v83
    v_exp_f32 v86, v86
    v_exp_f32 v87, v87
    v_cvt_pk_bf16_f32 v158, v84, v85
    s_add_u32 m0, s54, 4096
    s_add_u32 s78, s40, 131072
    buffer_load_dwordx4 v11, s[20:23], s78 offen offset:0 lds
    buffer_load_dwordx4 v12, s[20:23], s78 offen offset:1024 lds
    v_cvt_pk_bf16_f32 v159, v86, v87
    v_exp_f32 v88, v88
    v_exp_f32 v89, v89
    v_mfma_f32_32x32x16_bf16 v[176:191], a[76:79], v[156:159], v[176:191]
    v_exp_f32 v90, v90
    v_exp_f32 v91, v91
    v_exp_f32 v92, v92
    v_cvt_pk_bf16_f32 v152, v88, v89
    v_mfma_f32_32x32x16_bf16 v[72:87], a[8:11], v[68:71], v[136:151]
    v_exp_f32 v93, v93
    v_cvt_pk_bf16_f32 v153, v90, v91
    v_exp_f32 v94, v94
    v_exp_f32 v95, v95
    v_exp_f32 v96, v96
    v_cvt_pk_bf16_f32 v154, v92, v93
    v_exp_f32 v97, v97
    v_cvt_pk_bf16_f32 v155, v94, v95
    v_exp_f32 v98, v98
    v_exp_f32 v99, v99
    v_mfma_f32_32x32x16_bf16 v[176:191], a[64:67], v[152:155], v[176:191]
    s_add_u32 m0, s54, 133120
    s_add_u32 s78, s55, 1404928
    buffer_load_dwordx4 v208, s[16:19], s78 offen offset:0 lds
    buffer_load_dwordx4 v209, s[16:19], s78 offen offset:1024 lds
    v_exp_f32 v100, v100
    v_cvt_pk_bf16_f32 v156, v96, v97
    v_exp_f32 v101, v101
    v_cvt_pk_bf16_f32 v157, v98, v99
    v_exp_f32 v102, v102
    v_exp_f32 v103, v103
    v_cvt_pk_bf16_f32 v158, v100, v101
    s_add_u32 m0, s54, 135168
    s_add_u32 s78, s55, 1433600
    buffer_load_dwordx4 v208, s[16:19], s78 offen offset:0 lds
    buffer_load_dwordx4 v209, s[16:19], s78 offen offset:1024 lds
    v_cvt_pk_bf16_f32 v159, v102, v103
    v_exp_f32 v72, v72
    v_exp_f32 v73, v73
    v_mfma_f32_32x32x16_bf16 v[176:191], a[68:71], v[156:159], v[176:191]
    v_exp_f32 v74, v74
    v_exp_f32 v75, v75
    v_exp_f32 v76, v76
    v_cvt_pk_bf16_f32 v152, v72, v73
    v_mfma_f32_32x32x16_bf16 v[88:103], v[212:215], v[220:223], v[240:255]
    v_exp_f32 v77, v77
    v_cvt_pk_bf16_f32 v153, v74, v75
    v_exp_f32 v78, v78
    v_exp_f32 v79, v79
    v_mfma_f32_32x32x16_bf16 v[88:103], a[4:7], v[68:71], v[88:103]
    v_exp_f32 v80, v80
    v_cvt_pk_bf16_f32 v154, v76, v77
    v_exp_f32 v81, v81
    v_cvt_pk_bf16_f32 v155, v78, v79
    v_exp_f32 v82, v82
    v_exp_f32 v83, v83
    v_mfma_f32_32x32x16_bf16 v[176:191], a[56:59], v[152:155], v[176:191]
    s_add_u32 m0, s54, 137216
    s_add_u32 s78, s55, 1462272
    buffer_load_dwordx4 v208, s[16:19], s78 offen offset:0 lds
    buffer_load_dwordx4 v209, s[16:19], s78 offen offset:1024 lds
    v_exp_f32 v84, v84
    v_cvt_pk_bf16_f32 v156, v80, v81
    v_exp_f32 v85, v85
    v_cvt_pk_bf16_f32 v157, v82, v83
    v_exp_f32 v86, v86
    v_exp_f32 v87, v87
    v_cvt_pk_bf16_f32 v158, v84, v85
    v_cvt_pk_bf16_f32 v159, v86, v87
    v_exp_f32 v88, v88
    v_exp_f32 v89, v89
    v_mfma_f32_32x32x16_bf16 v[176:191], a[60:63], v[156:159], v[176:191]
    v_exp_f32 v90, v90
    v_exp_f32 v91, v91
    v_exp_f32 v92, v92
    v_cvt_pk_bf16_f32 v152, v88, v89
    v_exp_f32 v93, v93
    v_cvt_pk_bf16_f32 v153, v90, v91
    v_exp_f32 v94, v94
    v_exp_f32 v95, v95
    v_exp_f32 v96, v96
    v_cvt_pk_bf16_f32 v154, v92, v93
    v_exp_f32 v97, v97
    v_cvt_pk_bf16_f32 v155, v94, v95
    v_exp_f32 v98, v98
    v_exp_f32 v99, v99
    v_mfma_f32_32x32x16_bf16 v[176:191], a[48:51], v[152:155], v[176:191]
    v_exp_f32 v100, v100
    v_cvt_pk_bf16_f32 v156, v96, v97
    v_exp_f32 v101, v101
    v_cvt_pk_bf16_f32 v157, v98, v99
    v_exp_f32 v102, v102
    v_exp_f32 v103, v103
    v_cvt_pk_bf16_f32 v158, v100, v101
    v_cvt_pk_bf16_f32 v159, v102, v103
    v_and_b32 v5, -13, v9
    v_lshlrev_b32 v5, 5, v5
    s_lshl_b32 s84, s59, 5
    s_add_u32 s84, s84, 16777216
    buffer_load_dword v8, v5, s[28:31], s84 offen sc1
    s_nop 1
    v_mfma_f32_32x32x16_bf16 v[176:191], a[52:55], v[156:159], v[176:191]
    s_waitcnt vmcnt(7)
    ds_read_b64_tr_b16 a[232:233], v15 offset:0
    ds_read_b64_tr_b16 a[234:235], v15 offset:1024
    ds_read_b64_tr_b16 a[236:237], v16 offset:0
    ds_read_b64_tr_b16 a[238:239], v16 offset:1024
    ds_read_b64_tr_b16 a[240:241], v15 offset:2048
    ds_read_b64_tr_b16 a[242:243], v15 offset:3072
    ds_read_b64_tr_b16 a[244:245], v16 offset:2048
    ds_read_b64_tr_b16 a[246:247], v16 offset:3072
    ds_read_b64_tr_b16 a[248:249], v15 offset:4096
    ds_read_b64_tr_b16 a[250:251], v15 offset:5120
    ds_read_b64_tr_b16 a[252:253], v16 offset:4096
    ds_read_b64_tr_b16 a[254:255], v16 offset:5120
    v_cmp_nge_f32 vcc, 0x53800000, v184
    s_nop 0
    s_cbranch_vccnz L_exact_6
L_exact_6_back:
    v_rcp_f32 v204, v184
    s_add_u32 s79, s57, 32768
    v_mul_f32 v176, v204, v176
    v_mul_f32 v177, v204, v177
    v_mul_f32 v178, v204, v178
    v_mul_f32 v179, v204, v179
    v_mul_f32 v180, v204, v180
    v_mul_f32 v181, v204, v181
    v_mul_f32 v182, v204, v182
    v_mul_f32 v183, v204, v183
    v_cvt_pk_bf16_f32 v196, v176, v177
    v_cvt_pk_bf16_f32 v197, v178, v179
    v_cvt_pk_bf16_f32 v198, v180, v181
    v_cvt_pk_bf16_f32 v199, v182, v183
    buffer_store_dwordx4 v[196:199], v1, s[28:31], s79 offen sc1
L_att_done:
    s_lshl_b32 s74, s65, 16
    s_add_u32 s75, s74, s54
    s_add_u32 s40, s75, 5242880
    s_lshl_b32 s75, s66, 12
    s_add_u32 s75, s74, s75
    s_lshl_b32 s76, s62, 7
    s_add_u32 s75, s75, s76
    s_add_u32 s41, s75, 7340032
    s_lshl_b32 s75, s65, 13
    s_lshl_b32 s76, s66, 9
    s_add_u32 s75, s75, s76
    s_lshl_b32 s76, s62, 7
    s_add_u32 s75, s75, s76
    s_add_u32 s42, s75, 65536
    s_lshl_b32 s75, s65, 5
    s_lshl_b32 s76, s66, 2
    s_add_u32 s75, s75, s76
    s_add_u32 s75, s75, s62
    s_lshl_b32 s75, s75, 2
    s_add_u32 s43, s75, 16384
    s_waitcnt vmcnt(1)
    v_cmp_ne_u32 vcc, s70, v8
    s_nop 0
    s_cbranch_vccnz L_retry_19
L_back_20:
    s_add_u32 s81, s40, 0
    buffer_load_dwordx4 v[64:67], v1, s[28:31], s81 offen offset:0 sc1
    buffer_load_dwordx4 v[68:71], v1, s[28:31], s81 offen offset:1024 sc1
    buffer_load_dwordx4 v[72:75], v1, s[28:31], s81 offen offset:2048 sc1
    buffer_load_dwordx4 v[76:79], v1, s[28:31], s81 offen offset:3072 sc1
    s_add_u32 s81, s40, 4096
    buffer_load_dwordx4 v[80:83], v1, s[28:31], s81 offen offset:0 sc1
    buffer_load_dwordx4 v[84:87], v1, s[28:31], s81 offen offset:1024 sc1
    buffer_load_dwordx4 v[88:91], v1, s[28:31], s81 offen offset:2048 sc1
    buffer_load_dwordx4 v[92:95], v1, s[28:31], s81 offen offset:3072 sc1
    s_waitcnt vmcnt(8)
    s_waitcnt lgkmcnt(0)
    s_add_u32 s79, s58, 4096
    s_barrier
    s_cmp_lg_u32 s62, 0
    s_cbranch_scc1 L_nofl_21
    s_lshl_b32 s82, s79, 5
    s_add_u32 s82, s82, 16777216
    s_mov_b64 exec, 1
    buffer_store_dword v7, v6, s[28:31], s82 offen sc1
    s_mov_b64 exec, -1
L_nofl_21:
    ds_read_b64_tr_b16 v[128:129], v49 offset:0
    ds_read_b64_tr_b16 v[130:131], v49 offset:1024
    ds_read_b64_tr_b16 v[132:133], v49 offset:4096
    ds_read_b64_tr_b16 v[134:135], v49 offset:5120
    ds_read_b64_tr_b16 v[136:137], v49 offset:8192
    ds_read_b64_tr_b16 v[138:139], v49 offset:9216
    ds_read_b64_tr_b16 v[140:141], v49 offset:12288
    ds_read_b64_tr_b16 v[142:143], v49 offset:13312
    ds_read_b64_tr_b16 v[144:145], v49 offset:16384
    ds_read_b64_tr_b16 v[146:147], v49 offset:17408
    ds_read_b64_tr_b16 v[148:149], v49 offset:20480
    ds_read_b64_tr_b16 v[150:151], v49 offset:21504
    ds_read_b64_tr_b16 v[152:153], v49 offset:24576
    ds_read_b64_tr_b16 v[154:155], v49 offset:25600
    ds_read_b64_tr_b16 v[156:157], v49 offset:28672
    ds_read_b64_tr_b16 v[158:159], v49 offset:29696
    ds_read_b64_tr_b16 v[160:161], v49 offset:32768
    ds_read_b64_tr_b16 v[162:163], v49 offset:33792
    ds_read_b64_tr_b16 v[164:165], v49 offset:36864
    ds_read_b64_tr_b16 v[166:167], v49 offset:37888
    ds_read_b64_tr_b16 v[168:169], v49 offset:40960
    ds_read_b64_tr_b16 v[170:171], v49 offset:41984
    ds_read_b64_tr_b16 v[172:173], v49 offset:45056
    ds_read_b64_tr_b16 v[174:175], v49 offset:46080
    ds_read_b64_tr_b16 v[176:177], v49 offset:49152
    ds_read_b64_tr_b16 v[178:179], v49 offset:50176
    ds_read_b64_tr_b16 v[180:181], v49 offset:53248
    ds_read_b64_tr_b16 v[182:183], v49 offset:54272
    ds_read_b64_tr_b16 v[184:185], v49 offset:57344
    ds_read_b64_tr_b16 v[186:187], v49 offset:58368
    ds_read_b64_tr_b16 v[188:189], v49 offset:61440
    ds_read_b64_tr_b16 v[190:191], v49 offset:62464
    s_add_u32 s59, s59, 4096
    s_waitcnt lgkmcnt(0)
    s_barrier
    s_waitcnt vmcnt(7)
    v_mfma_f32_32x32x16_bf16 v[96:111], a[120:123], v[64:67], 0
    s_waitcnt vmcnt(6)
    v_mfma_f32_32x32x16_bf16 v[96:111], a[128:131], v[68:71], v[96:111]
    s_add_u32 m0, s54, 65536
    s_add_u32 s78, s56, 147456
    buffer_load_dwordx4 v11, s[20:23], s78 offen offset:0 lds
    buffer_load_dwordx4 v12, s[20:23], s78 offen offset:1024 lds
    s_waitcnt vmcnt(7)
    v_mfma_f32_32x32x16_bf16 v[96:111], a[136:139], v[72:75], v[96:111]
    s_waitcnt vmcnt(6)
    v_mfma_f32_32x32x16_bf16 v[96:111], a[144:147], v[76:79], v[96:111]
    s_waitcnt vmcnt(5)
    v_mfma_f32_32x32x16_bf16 v[96:111], a[152:155], v[80:83], v[96:111]
    v_lshlrev_b32 v56, 16, v28
    v_and_b32 v57, 0xffff0000, v28
    s_waitcnt vmcnt(4)
    v_mfma_f32_32x32x16_bf16 v[96:111], a[160:163], v[84:87], v[96:111]
    v_lshlrev_b32 v58, 16, v29
    v_and_b32 v59, 0xffff0000, v29
    s_add_u32 m0, s54, 67584
    s_add_u32 s78, s56, 163840
    buffer_load_dwordx4 v11, s[20:23], s78 offen offset:0 lds
    buffer_load_dwordx4 v12, s[20:23], s78 offen offset:1024 lds
    s_waitcnt vmcnt(5)
    v_mfma_f32_32x32x16_bf16 v[96:111], a[168:171], v[88:91], v[96:111]
    v_lshlrev_b32 v60, 16, v30
    v_and_b32 v61, 0xffff0000, v30
    s_waitcnt vmcnt(4)
    v_mfma_f32_32x32x16_bf16 v[96:111], a[176:179], v[92:95], v[96:111]
    v_lshlrev_b32 v62, 16, v31
    v_and_b32 v63, 0xffff0000, v31
    v_mfma_f32_32x32x16_bf16 v[112:127], a[124:127], v[64:67], 0
    v_mfma_f32_32x32x16_bf16 v[112:127], a[132:135], v[68:71], v[112:127]
    s_add_u32 m0, s54, 69632
    s_add_u32 s78, s56, 180224
    buffer_load_dwordx4 v11, s[20:23], s78 offen offset:0 lds
    buffer_load_dwordx4 v12, s[20:23], s78 offen offset:1024 lds
    v_mfma_f32_32x32x16_bf16 v[112:127], a[140:143], v[72:75], v[112:127]
    v_mfma_f32_32x32x16_bf16 v[112:127], a[148:151], v[76:79], v[112:127]
    v_mfma_f32_32x32x16_bf16 v[112:127], a[156:159], v[80:83], v[112:127]
    s_nop 0
    ds_write_b128 v20, v[96:99] offset:0
    v_mfma_f32_32x32x16_bf16 v[112:127], a[164:167], v[84:87], v[112:127]
    ds_write_b128 v21, v[100:103] offset:0
    s_add_u32 m0, s54, 71680
    s_add_u32 s78, s56, 196608
    buffer_load_dwordx4 v11, s[20:23], s78 offen offset:0 lds
    buffer_load_dwordx4 v12, s[20:23], s78 offen offset:1024 lds
    v_mfma_f32_32x32x16_bf16 v[112:127], a[172:175], v[88:91], v[112:127]
    ds_write_b128 v22, v[104:107] offset:0
    v_mfma_f32_32x32x16_bf16 v[112:127], a[180:183], v[92:95], v[112:127]
    ds_write_b128 v23, v[108:111] offset:0
    v_and_b32 v5, -13, v9
    v_lshlrev_b32 v5, 5, v5
    s_lshl_b32 s84, s59, 5
    s_add_u32 s84, s84, 16777216
    buffer_load_dword v8, v5, s[28:31], s84 offen sc1
    s_nop 5
    ds_write_b128 v20, v[112:115] offset:128
    ds_write_b128 v21, v[116:119] offset:128
    ds_write_b128 v22, v[120:123] offset:128
    ds_write_b128 v23, v[124:127] offset:128
    s_waitcnt lgkmcnt(0)
    s_barrier
    ds_read_b128 v[64:67], v18 offset:0
    ds_read_b128 v[68:71], v19 offset:0
    ds_read_b128 v[72:75], v18 offset:8192
    ds_read_b128 v[76:79], v19 offset:8192
    ds_read_b128 v[80:83], v18 offset:16384
    ds_read_b128 v[84:87], v19 offset:16384
    ds_read_b128 v[88:91], v18 offset:24576
    ds_read_b128 v[92:95], v19 offset:24576
    s_waitcnt lgkmcnt(5)
    v_add_f32 v64, v64, v72
    v_add_f32 v65, v65, v73
    v_add_f32 v66, v66, v74
    v_add_f32 v67, v67, v75
    s_waitcnt lgkmcnt(4)
    v_add_f32 v68, v68, v76
    v_add_f32 v69, v69, v77
    v_add_f32 v70, v70, v78
    v_add_f32 v71, v71, v79
    s_waitcnt lgkmcnt(1)
    v_add_f32 v80, v80, v88
    v_add_f32 v81, v81, v89
    v_add_f32 v82, v82, v90
    v_add_f32 v83, v83, v91
    s_waitcnt lgkmcnt(0)
    v_add_f32 v84, v84, v92
    v_add_f32 v85, v85, v93
    v_add_f32 v86, v86, v94
    v_add_f32 v87, v87, v95
    v_add_f32 v64, v64, v80
    v_add_f32 v65, v65, v81
    v_add_f32 v66, v66, v82
    v_add_f32 v67, v67, v83
    v_add_f32 v68, v68, v84
    v_add_f32 v69, v69, v85
    v_add_f32 v70, v70, v86
    v_add_f32 v71, v71, v87
    v_add_f32 v64, v64, v56
    v_add_f32 v65, v65, v57
    v_add_f32 v66, v66, v58
    v_add_f32 v67, v67, v59
    v_add_f32 v68, v68, v60
    v_add_f32 v69, v69, v61
    v_add_f32 v70, v70, v62
    v_add_f32 v71, v71, v63
    s_add_u32 s78, s41, 0
    v_cvt_pk_bf16_f32 v28, v64, v65
    v_cvt_pk_bf16_f32 v29, v66, v67
    v_cvt_pk_bf16_f32 v30, v68, v69
    v_cvt_pk_bf16_f32 v31, v70, v71
    buffer_store_dwordx4 v[28:31], v52, s[28:31], s78 offen sc1
    v_dot2_f32_bf16 v56, v28, v24, 0
    v_dot2_f32_bf16 v57, v28, v28, 0
    v_dot2_f32_bf16 v56, v29, v24, v56
    v_dot2_f32_bf16 v57, v29, v29, v57
    v_dot2_f32_bf16 v56, v30, v24, v56
    v_dot2_f32_bf16 v57, v30, v30, v57
    v_dot2_f32_bf16 v56, v31, v24, v56
    v_dot2_f32_bf16 v57, v31, v31, v57
    s_nop 1
    v_add_f32_dpp v58, v56, v56 quad_perm:[1,0,3,2] row_mask:0xf bank_mask:0xf
    v_add_f32_dpp v59, v57, v57 quad_perm:[1,0,3,2] row_mask:0xf bank_mask:0xf
    s_nop 0
    v_add_f32_dpp v56, v58, v58 quad_perm:[2,3,0,1] row_mask:0xf bank_mask:0xf
    v_add_f32_dpp v57, v59, v59 quad_perm:[2,3,0,1] row_mask:0xf bank_mask:0xf
    s_nop 0
    v_add_f32_dpp v58, v56, v56 row_half_mirror row_mask:0xf bank_mask:0xf
    v_add_f32_dpp v59, v57, v57 row_half_mirror row_mask:0xf bank_mask:0xf
    v_mov_b32 v60, v58
    v_mov_b32 v61, v59
    s_add_u32 s78, s42, 0
    s_mov_b32 exec_lo, 0x01010101
    s_mov_b32 exec_hi, 0x01010101
    buffer_store_dwordx4 v[58:61], v10, s[28:31], s78 offen sc1
    s_mov_b64 exec, -1
    s_waitcnt vmcnt(2)
    v_cmp_ne_u32 vcc, s70, v8
    s_nop 0
    s_cbranch_vccnz L_retry_22
L_back_23:
    s_add_u32 s81, s40, 32768
    buffer_load_dwordx4 a[88:91], v1, s[28:31], s81 offen offset:0 sc1
    buffer_load_dwordx4 a[92:95], v1, s[28:31], s81 offen offset:1024 sc1
    buffer_load_dwordx4 a[96:99], v1, s[28:31], s81 offen offset:2048 sc1
    buffer_load_dwordx4 a[100:103], v1, s[28:31], s81 offen offset:3072 sc1
    s_add_u32 s81, s40, 36864
    buffer_load_dwordx4 a[104:107], v1, s[28:31], s81 offen offset:0 sc1
    buffer_load_dwordx4 a[108:111], v1, s[28:31], s81 offen offset:1024 sc1
    buffer_load_dwordx4 a[112:115], v1, s[28:31], s81 offen offset:2048 sc1
    buffer_load_dwordx4 a[116:119], v1, s[28:31], s81 offen offset:3072 sc1
    ds_read_b64_tr_b16 v[192:193], v50 offset:0
    ds_read_b64_tr_b16 v[194:195], v50 offset:1024
    ds_read_b64_tr_b16 v[196:197], v50 offset:4096
    ds_read_b64_tr_b16 v[198:199], v50 offset:5120
    ds_read_b64_tr_b16 v[200:201], v50 offset:8192
    ds_read_b64_tr_b16 v[202:203], v50 offset:9216
    ds_read_b64_tr_b16 v[204:205], v50 offset:12288
    ds_read_b64_tr_b16 v[206:207], v50 offset:13312
    ds_read_b64_tr_b16 v[208:209], v50 offset:16384
    ds_read_b64_tr_b16 v[210:211], v50 offset:17408
    ds_read_b64_tr_b16 v[212:213], v50 offset:20480
    ds_read_b64_tr_b16 v[214:215], v50 offset:21504
    ds_read_b64_tr_b16 v[216:217], v50 offset:24576
    ds_read_b64_tr_b16 v[218:219], v50 offset:25600
    ds_read_b64_tr_b16 v[220:221], v50 offset:28672
    ds_read_b64_tr_b16 v[222:223], v50 offset:29696
    ds_read_b64_tr_b16 v[224:225], v50 offset:32768
    ds_read_b64_tr_b16 v[226:227], v50 offset:33792
    ds_read_b64_tr_b16 v[228:229], v50 offset:36864
    ds_read_b64_tr_b16 v[230:231], v50 offset:37888
    ds_read_b64_tr_b16 v[232:233], v50 offset:40960
    ds_read_b64_tr_b16 v[234:235], v50 offset:41984
    ds_read_b64_tr_b16 v[236:237], v50 offset:45056
    ds_read_b64_tr_b16 v[238:239], v50 offset:46080
    ds_read_b64_tr_b16 v[240:241], v50 offset:49152
    ds_read_b64_tr_b16 v[242:243], v50 offset:50176
    ds_read_b64_tr_b16 v[244:245], v50 offset:53248
    ds_read_b64_tr_b16 v[246:247], v50 offset:54272
    ds_read_b64_tr_b16 v[248:249], v50 offset:57344
    ds_read_b64_tr_b16 v[250:251], v50 offset:58368
    ds_read_b64_tr_b16 v[252:253], v50 offset:61440
    ds_read_b64_tr_b16 v[254:255], v50 offset:62464
    s_lshl_b32 s74, s67, 8
    s_add_u32 s45, s74, 16384
    v_lshlrev_b32 v9, 2, v0
    s_lshl_b32 s74, s67, 17
    s_add_u32 s74, s74, s54
    s_add_u32 s46, s74, 7340032
    s_lshl_b32 s74, s67, 14
    s_lshr_b32 s75, s62, 1
    s_lshl_b32 s75, s75, 13
    s_add_u32 s74, s74, s75
    s_and_b32 s75, s62, 1
    s_lshl_b32 s75, s75, 8
    s_add_u32 s74, s74, s75
    s_add_u32 s47, s74, 65536
    v_and_b32 v2, 15, v0
    v_lshlrev_b32 v2, 4, v2
    v_lshrrev_b32 v3, 4, v0
    v_lshl_add_u32 v25, v3, 10, v2
    s_mul_i32 s74, s67, 458752
    s_lshl_b32 s75, s68, 13
    s_add_u32 s74, s74, s75
    s_lshl_b32 s75, s62, 11
    s_add_u32 s74, s74, s75
    s_add_u32 s48, s74, 9437184
    s_lshl_b32 s74, s67, 9
    s_lshl_b32 s75, s68, 4
    s_add_u32 s74, s74, s75
    s_lshl_b32 s75, s62, 2
    s_add_u32 s74, s74, s75
    s_add_u32 s49, s74, 24576
    s_waitcnt vmcnt(7)
    v_mfma_f32_32x32x16_bf16 v[96:111], a[120:123], a[88:91], 0
    s_waitcnt vmcnt(6)
    v_mfma_f32_32x32x16_bf16 v[96:111], a[128:131], a[92:95], v[96:111]
    ds_read_b64_tr_b16 a[0:1], v44 offset:0
    ds_read_b64_tr_b16 a[2:3], v44 offset:1024
    ds_read_b64_tr_b16 a[4:5], v45 offset:0
    ds_read_b64_tr_b16 a[6:7], v45 offset:1024
    s_waitcnt vmcnt(5)
    v_mfma_f32_32x32x16_bf16 v[96:111], a[136:139], a[96:99], v[96:111]
    s_waitcnt vmcnt(4)
    v_mfma_f32_32x32x16_bf16 v[96:111], a[144:147], a[100:103], v[96:111]
    ds_read_b64_tr_b16 a[8:9], v44 offset:2048
    ds_read_b64_tr_b16 a[10:11], v44 offset:3072
    ds_read_b64_tr_b16 a[12:13], v45 offset:2048
    ds_read_b64_tr_b16 a[14:15], v45 offset:3072
    s_waitcnt lgkmcnt(8)
    s_barrier
    s_cmp_lg_u32 s62, 0
    s_cbranch_scc1 L_nofl_26
    s_lshl_b32 s82, s43, 5
    s_add_u32 s82, s82, 16777216
    s_mov_b64 exec, 1
    buffer_store_dword v7, v6, s[28:31], s82 offen sc1
    s_mov_b64 exec, -1
L_nofl_26:
    s_waitcnt vmcnt(3)
    v_mfma_f32_32x32x16_bf16 v[96:111], a[152:155], a[104:107], v[96:111]
    v_lshlrev_b32 v56, 16, v32
    v_and_b32 v57, 0xffff0000, v32
    s_add_u32 m0, s54, 131072
    s_add_u32 s78, s56, 212992
    buffer_load_dwordx4 v11, s[20:23], s78 offen offset:0 lds
    buffer_load_dwordx4 v12, s[20:23], s78 offen offset:1024 lds
    s_waitcnt vmcnt(4)
    v_mfma_f32_32x32x16_bf16 v[96:111], a[160:163], a[108:111], v[96:111]
    v_lshlrev_b32 v58, 16, v33
    v_and_b32 v59, 0xffff0000, v33
    ds_read_b64_tr_b16 a[16:17], v44 offset:4096
    ds_read_b64_tr_b16 a[18:19], v44 offset:5120
    ds_read_b64_tr_b16 a[20:21], v45 offset:4096
    ds_read_b64_tr_b16 a[22:23], v45 offset:5120
    s_waitcnt vmcnt(3)
    v_mfma_f32_32x32x16_bf16 v[96:111], a[168:171], a[112:115], v[96:111]
    v_lshlrev_b32 v60, 16, v34
    v_and_b32 v61, 0xffff0000, v34
    s_add_u32 m0, s54, 133120
    s_add_u32 s78, s56, 229376
    buffer_load_dwordx4 v11, s[20:23], s78 offen offset:0 lds
    buffer_load_dwordx4 v12, s[20:23], s78 offen offset:1024 lds
    s_waitcnt vmcnt(4)
    v_mfma_f32_32x32x16_bf16 v[96:111], a[176:179], a[116:119], v[96:111]
    v_lshlrev_b32 v62, 16, v35
    v_and_b32 v63, 0xffff0000, v35
    ds_read_b64_tr_b16 a[24:25], v44 offset:6144
    ds_read_b64_tr_b16 a[26:27], v44 offset:7168
    ds_read_b64_tr_b16 a[28:29], v45 offset:6144
    ds_read_b64_tr_b16 a[30:31], v45 offset:7168
    v_mfma_f32_32x32x16_bf16 v[112:127], a[124:127], a[88:91], 0
    s_add_u32 m0, s54, 135168
    s_add_u32 s78, s56, 245760
    buffer_load_dwordx4 v11, s[20:23], s78 offen offset:0 lds
    buffer_load_dwordx4 v12, s[20:23], s78 offen offset:1024 lds
    v_mfma_f32_32x32x16_bf16 v[112:127], a[132:135], a[92:95], v[112:127]
    v_mfma_f32_32x32x16_bf16 v[112:127], a[140:143], a[96:99], v[112:127]
    s_add_u32 m0, s54, 137216
    s_add_u32 s78, s56, 262144
    buffer_load_dwordx4 v11, s[20:23], s78 offen offset:0 lds
    buffer_load_dwordx4 v12, s[20:23], s78 offen offset:1024 lds
    v_mfma_f32_32x32x16_bf16 v[112:127], a[148:151], a[100:103], v[112:127]
    v_mfma_f32_32x32x16_bf16 v[112:127], a[156:159], a[104:107], v[112:127]
    ds_write_b128 v20, v[96:99] offset:32768
    v_mfma_f32_32x32x16_bf16 v[112:127], a[164:167], a[108:111], v[112:127]
    ds_write_b128 v21, v[100:103] offset:32768
    v_mfma_f32_32x32x16_bf16 v[112:127], a[172:175], a[112:115], v[112:127]
    ds_write_b128 v22, v[104:107] offset:32768
    v_mfma_f32_32x32x16_bf16 v[112:127], a[180:183], a[116:119], v[112:127]
    ds_write_b128 v23, v[108:111] offset:32768
    s_nop 10
    ds_write_b128 v20, v[112:115] offset:32896
    ds_write_b128 v21, v[116:119] offset:32896
    ds_write_b128 v22, v[120:123] offset:32896
    ds_write_b128 v23, v[124:127] offset:32896
    s_waitcnt lgkmcnt(0)
    s_barrier
    ds_read_b128 v[64:67], v18 offset:32768
    ds_read_b128 v[68:71], v19 offset:32768
    ds_read_b128 v[72:75], v18 offset:40960
    ds_read_b128 v[76:79], v19 offset:40960
    ds_read_b128 v[80:83], v18 offset:49152
    ds_read_b128 v[84:87], v19 offset:49152
    ds_read_b128 v[88:91], v18 offset:57344
    ds_read_b128 v[92:95], v19 offset:57344
    v_and_b32 v5, -13, v9
    v_lshlrev_b32 v5, 5, v5
    s_lshl_b32 s84, s45, 5
    s_add_u32 s84, s84, 16777216
    buffer_load_dword v8, v5, s[28:31], s84 offen sc1
    s_waitcnt lgkmcnt(5)
    v_add_f32 v64, v64, v72
    v_add_f32 v65, v65, v73
    v_add_f32 v66, v66, v74
    v_add_f32 v67, v67, v75
    s_waitcnt lgkmcnt(4)
    v_add_f32 v68, v68, v76
    v_add_f32 v69, v69, v77
    v_add_f32 v70, v70, v78
    v_add_f32 v71, v71, v79
    s_waitcnt lgkmcnt(1)
    v_add_f32 v80, v80, v88
    v_add_f32 v81, v81, v89
    v_add_f32 v82, v82, v90
    v_add_f32 v83, v83, v91
    s_waitcnt lgkmcnt(0)
    v_add_f32 v84, v84, v92
    v_add_f32 v85, v85, v93
    v_add_f32 v86, v86, v94
    v_add_f32 v87, v87, v95
    v_add_f32 v64, v64, v80
    v_add_f32 v65, v65, v81
    v_add_f32 v66, v66, v82
    v_add_f32 v67, v67, v83
    v_add_f32 v68, v68, v84
    v_add_f32 v69, v69, v85
    v_add_f32 v70, v70, v86
    v_add_f32 v71, v71, v87
    v_add_f32 v64, v64, v56
    v_add_f32 v65, v65, v57
    v_add_f32 v66, v66, v58
    v_add_f32 v67, v67, v59
    v_add_f32 v68, v68, v60
    v_add_f32 v69, v69, v61
    v_add_f32 v70, v70, v62
    v_add_f32 v71, v71, v63
    s_add_u32 s78, s41, 32768
    v_cvt_pk_bf16_f32 v32, v64, v65
    v_cvt_pk_bf16_f32 v33, v66, v67
    v_cvt_pk_bf16_f32 v34, v68, v69
    v_cvt_pk_bf16_f32 v35, v70, v71
    buffer_store_dwordx4 v[32:35], v52, s[28:31], s78 offen sc1
    v_dot2_f32_bf16 v56, v32, v24, 0
    v_dot2_f32_bf16 v57, v32, v32, 0
    v_dot2_f32_bf16 v56, v33, v24, v56
    v_dot2_f32_bf16 v57, v33, v33, v57
    v_dot2_f32_bf16 v56, v34, v24, v56
    v_dot2_f32_bf16 v57, v34, v34, v57
    v_dot2_f32_bf16 v56, v35, v24, v56
    v_dot2_f32_bf16 v57, v35, v35, v57
    s_nop 1
    v_add_f32_dpp v58, v56, v56 quad_perm:[1,0,3,2] row_mask:0xf bank_mask:0xf
    v_add_f32_dpp v59, v57, v57 quad_perm:[1,0,3,2] row_mask:0xf bank_mask:0xf
    s_nop 0
    v_add_f32_dpp v56, v58, v58 quad_perm:[2,3,0,1] row_mask:0xf bank_mask:0xf
    v_add_f32_dpp v57, v59, v59 quad_perm:[2,3,0,1] row_mask:0xf bank_mask:0xf
    s_nop 0
    v_add_f32_dpp v58, v56, v56 row_half_mirror row_mask:0xf bank_mask:0xf
    v_add_f32_dpp v59, v57, v57 row_half_mirror row_mask:0xf bank_mask:0xf
    v_mov_b32 v60, v58
    v_mov_b32 v61, v59
    s_add_u32 s78, s42, 4096
    s_mov_b32 exec_lo, 0x01010101
    s_mov_b32 exec_hi, 0x01010101
    buffer_store_dwordx4 v[58:61], v10, s[28:31], s78 offen sc1
    s_mov_b64 exec, -1
    s_waitcnt vmcnt(2)
    v_cmp_ne_u32 vcc, s70, v8
    s_nop 0
    s_cbranch_vccnz L_retry_24
L_back_25:
    s_add_u32 s78, s47, 0
    buffer_load_dwordx2 v[48:49], v25, s[28:31], s78 offen sc1
    buffer_load_dwordx2 v[50:51], v25, s[28:31], s78 offen offset:512 sc1
    s_add_u32 m0, s54, 65536
    s_add_u32 s78, s46, 0
    buffer_load_dwordx4 v1, s[28:31], s78 offen offset:0 sc1 lds
    buffer_load_dwordx4 v1, s[28:31], s78 offen offset:1024 sc1 lds
    s_add_u32 m0, s54, 67584
    s_add_u32 s78, s46, 2048
    buffer_load_dwordx4 v1, s[28:31], s78 offen offset:0 sc1 lds
    buffer_load_dwordx4 v1, s[28:31], s78 offen offset:1024 sc1 lds
    s_add_u32 m0, s54, 69632
    s_add_u32 s78, s46, 4096
    buffer_load_dwordx4 v1, s[28:31], s78 offen offset:0 sc1 lds
    buffer_load_dwordx4 v1, s[28:31], s78 offen offset:1024 sc1 lds
    s_add_u32 m0, s54, 71680
    s_add_u32 s78, s46, 6144
    buffer_load_dwordx4 v1, s[28:31], s78 offen offset:0 sc1 lds
    buffer_load_dwordx4 v1, s[28:31], s78 offen offset:1024 sc1 lds
    v_and_b32 v2, 31, v0
    v_lshlrev_b32 v10, 5, v2
    v_and_b32 v2, 15, v0
    v_lshlrev_b32 v2, 5, v2
    s_lshl_b32 s74, s62, 9
    s_lshr_b32 s75, s62, 1
    s_mul_i32 s75, s75, 15360
    s_add_u32 s74, s74, s75
    v_add_u32 v26, s74, v2
    v_add_u32 v4, 65536, v1
    v_dot2_f32_bf16 v40, v128, v24, 0
    v_dot2_f32_bf16 v41, v129, v24, 0
    v_dot2_f32_bf16 v43, v130, v24, 0
    v_dot2_f32_bf16 v3, v131, v24, 0
    v_dot2_f32_bf16 v40, v132, v24, v40
    v_dot2_f32_bf16 v41, v133, v24, v41
    v_dot2_f32_bf16 v43, v134, v24, v43
    v_dot2_f32_bf16 v3, v135, v24, v3
    v_dot2_f32_bf16 v40, v136, v24, v40
    v_dot2_f32_bf16 v41, v137, v24, v41
    v_dot2_f32_bf16 v43, v138, v24, v43
    v_dot2_f32_bf16 v3, v139, v24, v3
    v_dot2_f32_bf16 v40, v140, v24, v40
    v_dot2_f32_bf16 v41, v141, v24, v41
    v_dot2_f32_bf16 v43, v142, v24, v43
    v_dot2_f32_bf16 v3, v143, v24, v3
    v_dot2_f32_bf16 v40, v144, v24, v40
    v_dot2_f32_bf16 v41, v145, v24, v41
    v_dot2_f32_bf16 v43, v146, v24, v43
    v_dot2_f32_bf16 v3, v147, v24, v3
    v_dot2_f32_bf16 v40, v148, v24, v40
    v_dot2_f32_bf16 v41, v149, v24, v41
    v_dot2_f32_bf16 v43, v150, v24, v43
    v_dot2_f32_bf16 v3, v151, v24, v3
    v_dot2_f32_bf16 v40, v152, v24, v40
    v_dot2_f32_bf16 v41, v153, v24, v41
    v_dot2_f32_bf16 v43, v154, v24, v43
    v_dot2_f32_bf16 v3, v155, v24, v3
    v_dot2_f32_bf16 v40, v156, v24, v40
    v_dot2_f32_bf16 v41, v157, v24, v41
    v_dot2_f32_bf16 v43, v158, v24, v43
    v_dot2_f32_bf16 v3, v159, v24, v3
    v_dot2_f32_bf16 v40, v160, v24, v40
    v_dot2_f32_bf16 v41, v161, v24, v41
    v_dot2_f32_bf16 v43, v162, v24, v43
    v_dot2_f32_bf16 v3, v163, v24, v3
    v_dot2_f32_bf16 v40, v164, v24, v40
    v_dot2_f32_bf16 v41, v165, v24, v41
    v_dot2_f32_bf16 v43, v166, v24, v43
    v_dot2_f32_bf16 v3, v167, v24, v3
    v_dot2_f32_bf16 v40, v168, v24, v40
    v_dot2_f32_bf16 v41, v169, v24, v41
    v_dot2_f32_bf16 v43, v170, v24, v43
    v_dot2_f32_bf16 v3, v171, v24, v3
    v_dot2_f32_bf16 v40, v172, v24, v40
    v_dot2_f32_bf16 v41, v173, v24, v41
    v_dot2_f32_bf16 v43, v174, v24, v43
    v_dot2_f32_bf16 v3, v175, v24, v3
    v_dot2_f32_bf16 v40, v176, v24, v40
    v_dot2_f32_bf16 v41, v177, v24, v41
    v_dot2_f32_bf16 v43, v178, v24, v43
    v_dot2_f32_bf16 v3, v179, v24, v3
    v_dot2_f32_bf16 v40, v180, v24, v40
    v_dot2_f32_bf16 v41, v181, v24, v41
    v_dot2_f32_bf16 v43, v182, v24, v43
    v_dot2_f32_bf16 v3, v183, v24, v3
    v_dot2_f32_bf16 v40, v184, v24, v40
    v_dot2_f32_bf16 v41, v185, v24, v41
    v_dot2_f32_bf16 v43, v186, v24, v43
    v_dot2_f32_bf16 v3, v187, v24, v3
    v_dot2_f32_bf16 v40, v188, v24, v40
    v_dot2_f32_bf16 v41, v189, v24, v41
    v_dot2_f32_bf16 v43, v190, v24, v43
    v_dot2_f32_bf16 v3, v191, v24, v3
    ds_read_b64_tr_b16 a[32:33], v46 offset:0
    ds_read_b64_tr_b16 a[34:35], v46 offset:1024
    ds_read_b64_tr_b16 a[36:37], v47 offset:0
    ds_read_b64_tr_b16 a[38:39], v47 offset:1024
    ds_read_b64_tr_b16 a[40:41], v46 offset:2048
    ds_read_b64_tr_b16 a[42:43], v46 offset:3072
    ds_read_b64_tr_b16 a[44:45], v47 offset:2048
    ds_read_b64_tr_b16 a[46:47], v47 offset:3072
    ds_read_b64_tr_b16 a[48:49], v46 offset:4096
    ds_read_b64_tr_b16 a[50:51], v46 offset:5120
    ds_read_b64_tr_b16 a[52:53], v47 offset:4096
    ds_read_b64_tr_b16 a[54:55], v47 offset:5120
    ds_read_b64_tr_b16 a[56:57], v46 offset:6144
    ds_read_b64_tr_b16 a[58:59], v46 offset:7168
    ds_read_b64_tr_b16 a[60:61], v47 offset:6144
    ds_read_b64_tr_b16 a[62:63], v47 offset:7168
    s_cmp_eq_u32 s69, 0
    s_cbranch_scc1 L_idle4
    s_waitcnt vmcnt(10)
    s_add_u32 s79, s43, 4096
    s_barrier
    s_cmp_lg_u32 s62, 0
    s_cbranch_scc1 L_nofl_27
    s_lshl_b32 s82, s79, 5
    s_add_u32 s82, s82, 16777216
    s_mov_b64 exec, 1
    buffer_store_dword v7, v6, s[28:31], s82 offen sc1
    s_mov_b64 exec, -1
L_nofl_27:
    s_add_u32 s45, s45, 4096
    s_add_u32 m0, s54, 98304
    s_add_u32 s78, s46, 65536
    buffer_load_dwordx4 v1, s[28:31], s78 offen offset:0 sc1 lds
    buffer_load_dwordx4 v1, s[28:31], s78 offen offset:1024 sc1 lds
    s_add_u32 m0, s54, 100352
    s_add_u32 s78, s46, 67584
    buffer_load_dwordx4 v1, s[28:31], s78 offen offset:0 sc1 lds
    buffer_load_dwordx4 v1, s[28:31], s78 offen offset:1024 sc1 lds
    s_waitcnt vmcnt(12)
    v_add_f32 v48, v48, v50
    v_dot2_f32_bf16 v40, v192, v24, v40
    v_dot2_f32_bf16 v41, v193, v24, v41
    v_add_f32 v49, v49, v51
    v_dot2_f32_bf16 v43, v194, v24, v43
    v_dot2_f32_bf16 v3, v195, v24, v3
    v_dot2_f32_bf16 v40, v196, v24, v40
    v_permlane16_swap_b32 v48, v49
    v_dot2_f32_bf16 v41, v197, v24, v41
    v_dot2_f32_bf16 v43, v198, v24, v43
    v_add_f32 v48, v48, v49
    v_dot2_f32_bf16 v3, v199, v24, v3
    v_dot2_f32_bf16 v40, v200, v24, v40
    v_dot2_f32_bf16 v41, v201, v24, v41
    v_mov_b32 v49, v48
    v_dot2_f32_bf16 v43, v202, v24, v43
    v_dot2_f32_bf16 v3, v203, v24, v3
    v_permlane32_swap_b32 v48, v49
    v_dot2_f32_bf16 v40, v204, v24, v40
    v_dot2_f32_bf16 v41, v205, v24, v41
    v_add_f32 v48, v48, v49
    v_dot2_f32_bf16 v43, v206, v24, v43
    v_dot2_f32_bf16 v3, v207, v24, v3
    v_dot2_f32_bf16 v40, v208, v24, v40
    v_mov_b32 v49, v48
    v_dot2_f32_bf16 v41, v209, v24, v41
    v_dot2_f32_bf16 v43, v210, v24, v43
    v_permlane16_swap_b32 v48, v49
    v_dot2_f32_bf16 v3, v211, v24, v3
    v_dot2_f32_bf16 v40, v212, v24, v40
    v_dot2_f32_bf16 v41, v213, v24, v41
    v_mul_f32 v48, 0x3b000000, v48
    v_dot2_f32_bf16 v43, v214, v24, v43
    v_dot2_f32_bf16 v3, v215, v24, v3
    v_mul_f32 v49, 0x3b000000, v49
    v_dot2_f32_bf16 v40, v216, v24, v40
    v_dot2_f32_bf16 v41, v217, v24, v41
    v_fma_f32 v49, -v48, v48, v49
    v_dot2_f32_bf16 v43, v218, v24, v43
    v_dot2_f32_bf16 v3, v219, v24, v3
    v_dot2_f32_bf16 v40, v220, v24, v40
    v_max_f32 v49, 0, v49
    v_dot2_f32_bf16 v41, v221, v24, v41
    v_dot2_f32_bf16 v43, v222, v24, v43
    v_add_f32 v50, 0x3727c5ac, v49
    v_dot2_f32_bf16 v3, v223, v24, v3
    v_dot2_f32_bf16 v40, v224, v24, v40
    v_dot2_f32_bf16 v41, v225, v24, v41
    v_rcp_f32 v51, v50
    v_dot2_f32_bf16 v43, v226, v24, v43
    v_dot2_f32_bf16 v3, v227, v24, v3
    v_cvt_pk_bf16_f32 v53, v48, v48
    v_dot2_f32_bf16 v40, v228, v24, v40
    v_dot2_f32_bf16 v41, v229, v24, v41
    v_mul_f32 v51, v49, v51
    v_dot2_f32_bf16 v43, v230, v24, v43
    v_dot2_f32_bf16 v3, v231, v24, v3
    v_dot2_f32_bf16 v40, v232, v24, v40
    v_add_f32 v51, 0x3727c5ac, v51
    v_dot2_f32_bf16 v41, v233, v24, v41
    v_dot2_f32_bf16 v43, v234, v24, v43
    v_mul_f32 v51, v51, v50
    v_dot2_f32_bf16 v3, v235, v24, v3
    v_dot2_f32_bf16 v40, v236, v24, v40
    v_dot2_f32_bf16 v41, v237, v24, v41
    v_sqrt_f32 v54, v51
    v_dot2_f32_bf16 v43, v238, v24, v43
    v_dot2_f32_bf16 v3, v239, v24, v3
    v_and_b32 v49, 0xffff0000, v53
    v_dot2_f32_bf16 v40, v240, v24, v40
    v_dot2_f32_bf16 v41, v241, v24, v41
    v_rcp_f32 v51, v54
    v_dot2_f32_bf16 v43, v242, v24, v43
    v_dot2_f32_bf16 v3, v243, v24, v3
    v_dot2_f32_bf16 v40, v244, v24, v40
    v_sub_f32 v49, v48, v49
    v_dot2_f32_bf16 v41, v245, v24, v41
    v_dot2_f32_bf16 v43, v246, v24, v43
    v_mul_f32 v52, 0xc0135761, v51
    v_dot2_f32_bf16 v3, v247, v24, v3
    v_dot2_f32_bf16 v40, v248, v24, v40
    v_dot2_f32_bf16 v41, v249, v24, v41
    v_mul_f32 v55, v51, v51
    v_dot2_f32_bf16 v43, v250, v24, v43
    v_dot2_f32_bf16 v3, v251, v24, v3
    v_mul_f32 v55, v55, v51
    v_dot2_f32_bf16 v40, v252, v24, v40
    v_dot2_f32_bf16 v41, v253, v24, v41
    v_mul_f32 v53, 0xbdd2d3e8, v55
    v_dot2_f32_bf16 v43, v254, v24, v43
    v_dot2_f32_bf16 v3, v255, v24, v3
    s_nop 1
    v_add_f32 v40, v40, v43
    v_cvt_pk_bf16_f32 v55, v48, v49
    v_add_f32 v41, v41, v3
    v_add_f32 v40, v40, v41
    v_cvt_pk_bf16_f32 v49, v48, v54
    v_mov_b32 v41, v40
    s_nop 1
    v_permlane32_swap_b32 v40, v41
    v_and_b32 v50, 0xffff0000, v49
    v_add_f32 v40, v40, v41
    v_sub_f32 v40, 0, v40
    v_sub_f32 v50, v54, v50
    v_cvt_pk_bf16_f32 v43, v40, v40
    v_and_b32 v41, 0xffff0000, v43
    v_cvt_pk_bf16_f32 v50, v50, 0
    v_sub_f32 v40, v40, v41
    v_cvt_pk_bf16_f32 v40, v40, v40
    v_and_b32 v40, 0xffff, v40
    v_mov_b32 v48, v55
    v_lshl_or_b32 v41, v42, 16, v40
    v_mov_b32 v40, v43
    v_mov_b32 v51, 0
    v_mov_b32 v43, 0
    s_mov_b64 exec, 0xffff
    ds_write_b128 v26, v[48:51] offset:6144
    ds_write_b128 v26, v[52:55] offset:6160
    s_mov_b64 exec, -1
    v_cmp_gt_u32 vcc, 32, v0
    s_nop 1
    v_cndmask_b32 v40, v6, v40, vcc
    v_cndmask_b32 v41, v6, v41, vcc
    v_cndmask_b32 v42, v6, v42, vcc
    v_add_u32 v24, 131072, v1
    s_waitcnt vmcnt(4)
    s_waitcnt lgkmcnt(0)
    s_barrier
    ds_read_b128 a[152:155], v4 offset:0
    ds_read_b128 a[156:159], v4 offset:1024
    ds_read_b128 a[160:163], v4 offset:2048
    ds_read_b128 a[164:167], v4 offset:3072
    ds_read_b128 a[168:171], v4 offset:4096
    ds_read_b128 a[172:175], v4 offset:5120
    s_waitcnt lgkmcnt(4)
    v_mfma_f32_32x32x16_bf16 v[96:111], v[128:131], a[152:155], 0
    s_add_u32 m0, s54, 102400
    s_add_u32 s78, s46, 69632
    buffer_load_dwordx4 v1, s[28:31], s78 offen offset:0 sc1 lds
    buffer_load_dwordx4 v1, s[28:31], s78 offen offset:1024 sc1 lds
    v_mfma_f32_32x32x16_bf16 v[96:111], v[132:135], a[156:159], v[96:111]
    ds_read_b128 a[176:179], v4 offset:6144
    ds_read_b128 a[180:183], v4 offset:7168
    s_waitcnt lgkmcnt(4)
    v_mfma_f32_32x32x16_bf16 v[96:111], v[136:139], a[160:163], v[96:111]
    v_mfma_f32_32x32x16_bf16 v[96:111], v[140:143], a[164:167], v[96:111]
    s_add_u32 m0, s54, 104448
    s_add_u32 s78, s46, 71680
    buffer_load_dwordx4 v1, s[28:31], s78 offen offset:0 sc1 lds
    buffer_load_dwordx4 v1, s[28:31], s78 offen offset:1024 sc1 lds
    s_add_u32 m0, s54, 32768
    s_add_u32 s78, s56, 327680
    buffer_load_dwordx4 v11, s[20:23], s78 offen offset:0 lds
    buffer_load_dwordx4 v12, s[20:23], s78 offen offset:1024 lds
    ds_read_b128 v[48:51], v10 offset:6144
    ds_read_b128 a[152:155], v4 offset:8192
    ds_read_b128 a[156:159], v4 offset:9216
    s_waitcnt lgkmcnt(5)
    v_mfma_f32_32x32x16_bf16 v[96:111], v[144:147], a[168:171], v[96:111]
    v_mfma_f32_32x32x16_bf16 v[96:111], v[148:151], a[172:175], v[96:111]
    ds_read_b128 a[160:163], v4 offset:10240
    ds_read_b128 a[164:167], v4 offset:11264
    s_waitcnt lgkmcnt(5)
    v_mfma_f32_32x32x16_bf16 v[96:111], v[152:155], a[176:179], v[96:111]
    v_and_b32 v5, -13, v9
    v_lshlrev_b32 v5, 5, v5
    s_lshl_b32 s84, s45, 5
    s_add_u32 s84, s84, 16777216
    buffer_load_dword v8, v5, s[28:31], s84 offen sc1
    v_mfma_f32_32x32x16_bf16 v[96:111], v[156:159], a[180:183], v[96:111]
    ds_read_b128 a[168:171], v4 offset:12288
    ds_read_b128 a[172:175], v4 offset:13312
    s_waitcnt lgkmcnt(4)
    v_mfma_f32_32x32x16_bf16 v[96:111], v[160:163], a[152:155], v[96:111]
    s_add_u32 m0, s54, 34816
    s_add_u32 s78, s56, 344064
    buffer_load_dwordx4 v11, s[20:23], s78 offen offset:0 lds
    buffer_load_dwordx4 v12, s[20:23], s78 offen offset:1024 lds
    v_mfma_f32_32x32x16_bf16 v[96:111], v[164:167], a[156:159], v[96:111]
    ds_read_b128 a[176:179], v4 offset:14336
    ds_read_b128 a[180:183], v4 offset:15360
    s_waitcnt lgkmcnt(4)
    v_mfma_f32_32x32x16_bf16 v[96:111], v[168:171], a[160:163], v[96:111]
    v_mfma_f32_32x32x16_bf16 v[96:111], v[172:175], a[164:167], v[96:111]
    ds_read_b128 v[52:55], v10 offset:6160
    ds_read_b128 a[152:155], v4 offset:16384
    ds_read_b128 a[156:159], v4 offset:17408
    s_waitcnt lgkmcnt(5)
    v_mfma_f32_32x32x16_bf16 v[96:111], v[176:179], a[168:171], v[96:111]
    v_mfma_f32_32x32x16_bf16 v[96:111], v[180:183], a[172:175], v[96:111]
    s_add_u32 m0, s54, 36864
    s_add_u32 s78, s56, 360448
    buffer_load_dwordx4 v11, s[20:23], s78 offen offset:0 lds
    buffer_load_dwordx4 v12, s[20:23], s78 offen offset:1024 lds
    ds_read_b128 a[160:163], v4 offset:18432
    ds_read_b128 a[164:167], v4 offset:19456
    s_waitcnt lgkmcnt(5)
    v_mfma_f32_32x32x16_bf16 v[96:111], v[184:187], a[176:179], v[96:111]
    v_mfma_f32_32x32x16_bf16 v[96:111], v[188:191], a[180:183], v[96:111]
    ds_read_b128 a[168:171], v4 offset:20480
    ds_read_b128 a[172:175], v4 offset:21504
    s_waitcnt lgkmcnt(4)
    v_mfma_f32_32x32x16_bf16 v[96:111], v[192:195], a[152:155], v[96:111]
    v_mfma_f32_32x32x16_bf16 v[96:111], v[196:199], a[156:159], v[96:111]
    ds_read_b128 a[176:179], v4 offset:22528
    ds_read_b128 a[180:183], v4 offset:23552
    s_waitcnt lgkmcnt(4)
    v_mfma_f32_32x32x16_bf16 v[96:111], v[200:203], a[160:163], v[96:111]
    s_add_u32 m0, s54, 38912
    s_add_u32 s78, s56, 376832
    buffer_load_dwordx4 v11, s[20:23], s78 offen offset:0 lds
    buffer_load_dwordx4 v12, s[20:23], s78 offen offset:1024 lds
    v_mfma_f32_32x32x16_bf16 v[96:111], v[204:207], a[164:167], v[96:111]
    ds_read_b128 v[56:59], v10 offset:22528
    ds_read_b128 a[152:155], v4 offset:24576
    ds_read_b128 a[156:159], v4 offset:25600
    s_waitcnt lgkmcnt(5)
    v_mfma_f32_32x32x16_bf16 v[96:111], v[208:211], a[168:171], v[96:111]
    v_mfma_f32_32x32x16_bf16 v[96:111], v[212:215], a[172:175], v[96:111]
    ds_read_b128 a[160:163], v4 offset:26624
    ds_read_b128 a[164:167], v4 offset:27648
    s_waitcnt lgkmcnt(5)
    v_mfma_f32_32x32x16_bf16 v[96:111], v[216:219], a[176:179], v[96:111]
    s_add_u32 m0, s54, 0
    s_add_u32 s78, s56, 278528
    buffer_load_dwordx4 v11, s[20:23], s78 offen offset:0 lds
    buffer_load_dwordx4 v12, s[20:23], s78 offen offset:1024 lds
    v_mfma_f32_32x32x16_bf16 v[96:111], v[220:223], a[180:183], v[96:111]
    ds_read_b128 a[168:171], v4 offset:28672
    ds_read_b128 a[172:175], v4 offset:29696
    s_waitcnt lgkmcnt(4)
    v_mfma_f32_32x32x16_bf16 v[96:111], v[224:227], a[152:155], v[96:111]
    v_mfma_f32_32x32x16_bf16 v[96:111], v[228:231], a[156:159], v[96:111]
    s_add_u32 m0, s54, 2048
    s_add_u32 s78, s56, 294912
    buffer_load_dwordx4 v11, s[20:23], s78 offen offset:0 lds
    buffer_load_dwordx4 v12, s[20:23], s78 offen offset:1024 lds
    ds_read_b128 a[176:179], v4 offset:30720
    ds_read_b128 a[180:183], v4 offset:31744
    s_waitcnt lgkmcnt(4)
    v_mfma_f32_32x32x16_bf16 v[96:111], v[232:235], a[160:163], v[96:111]
    v_mfma_f32_32x32x16_bf16 v[96:111], v[236:239], a[164:167], v[96:111]
    ds_read_b128 v[60:63], v10 offset:22544
    s_waitcnt lgkmcnt(3)
    v_mfma_f32_32x32x16_bf16 v[96:111], v[240:243], a[168:171], v[96:111]
    s_add_u32 m0, s54, 4096
    s_add_u32 s78, s56, 311296
    buffer_load_dwordx4 v11, s[20:23], s78 offen offset:0 lds
    buffer_load_dwordx4 v12, s[20:23], s78 offen offset:1024 lds
    v_mfma_f32_32x32x16_bf16 v[96:111], v[244:247], a[172:175], v[96:111]
    s_waitcnt lgkmcnt(1)
    v_mfma_f32_32x32x16_bf16 v[96:111], v[248:251], a[176:179], v[96:111]
    v_mfma_f32_32x32x16_bf16 v[96:111], v[252:255], a[180:183], v[96:111]
    v_mfma_f32_32x32x16_bf16 v[96:111], v[40:43], v[48:51], v[96:111]
    s_waitcnt vmcnt(15)
    s_barrier
    ds_read_b128 a[152:155], v4 offset:32768
    ds_read_b128 a[156:159], v4 offset:33792
    ds_read_b128 a[160:163], v4 offset:34816
    ds_read_b128 a[164:167], v4 offset:35840
    ds_read_b128 a[168:171], v4 offset:36864
    ds_read_b128 a[172:175], v4 offset:37888
    s_waitcnt lgkmcnt(4)
    v_mfma_f32_32x32x16_bf16 v[112:127], v[128:131], a[152:155], 0
    s_nop 1
    v_mul_f32 v80, v96, v96
    v_mul_f32 v81, v97, v97
    v_mul_f32 v82, v98, v98
    v_mul_f32 v83, v99, v99
    v_fma_f32 v80, v80, v53, v52
    v_fma_f32 v81, v81, v53, v52
    v_fma_f32 v82, v82, v53, v52
    v_mfma_f32_32x32x16_bf16 v[112:127], v[132:135], a[156:159], v[112:127]
    v_fma_f32 v83, v83, v53, v52
    v_mul_f32 v80, v80, v96
    v_mul_f32 v81, v81, v97
    v_mul_f32 v82, v82, v98
    v_mul_f32 v83, v83, v99
    v_exp_f32 v80, v80
    ds_read_b128 a[176:179], v4 offset:38912
    ds_read_b128 a[180:183], v4 offset:39936
    s_waitcnt lgkmcnt(4)
    v_mfma_f32_32x32x16_bf16 v[112:127], v[136:139], a[160:163], v[112:127]
    s_waitcnt vmcnt(12)
    v_cmp_ne_u32 vcc, s70, v8
    s_nop 0
    s_cbranch_vccnz L_retry_28
L_back_29:
    s_add_u32 s78, s47, 4096
    buffer_load_dwordx2 v[48:49], v25, s[28:31], s78 offen sc1
    buffer_load_dwordx2 v[50:51], v25, s[28:31], s78 offen offset:512 sc1
    s_add_u32 m0, s54, 131072
    s_add_u32 s78, s46, 98304
    buffer_load_dwordx4 v1, s[28:31], s78 offen offset:0 sc1 lds
    buffer_load_dwordx4 v1, s[28:31], s78 offen offset:1024 sc1 lds
    v_exp_f32 v81, v81
    v_exp_f32 v82, v82
    v_exp_f32 v83, v83
    v_fma_f32 v80, v80, v54, v54
    v_mfma_f32_32x32x16_bf16 v[112:127], v[140:143], a[164:167], v[112:127]
    v_fma_f32 v81, v81, v54, v54
    v_fma_f32 v82, v82, v54, v54
    v_fma_f32 v83, v83, v54, v54
    v_rcp_f32 v80, v80
    v_rcp_f32 v81, v81
    ds_read_b128 a[152:155], v4 offset:40960
    ds_read_b128 a[156:159], v4 offset:41984
    s_waitcnt lgkmcnt(4)
    v_mfma_f32_32x32x16_bf16 v[112:127], v[144:147], a[168:171], v[112:127]
    s_add_u32 m0, s54, 133120
    s_add_u32 s78, s46, 100352
    buffer_load_dwordx4 v1, s[28:31], s78 offen offset:0 sc1 lds
    buffer_load_dwordx4 v1, s[28:31], s78 offen offset:1024 sc1 lds
    v_rcp_f32 v82, v82
    v_rcp_f32 v83, v83
    v_mul_f32 v80, v80, v96
    v_mul_f32 v81, v81, v97
    v_mul_f32 v82, v82, v98
    v_mul_f32 v83, v83, v99
    v_mfma_f32_32x32x16_bf16 v[112:127], v[148:151], a[172:175], v[112:127]
    v_cvt_pk_bf16_f32 v88, v80, v81
    v_cvt_pk_bf16_f32 v89, v82, v83
    v_mul_f32 v84, v100, v100
    v_mul_f32 v85, v101, v101
    v_mul_f32 v86, v102, v102
    v_mul_f32 v87, v103, v103
    v_fma_f32 v84, v84, v53, v52
    ds_read_b128 a[160:163], v4 offset:43008
    ds_read_b128 a[164:167], v4 offset:44032
    s_waitcnt lgkmcnt(4)
    v_mfma_f32_32x32x16_bf16 v[112:127], v[152:155], a[176:179], v[112:127]
    s_add_u32 m0, s54, 135168
    s_add_u32 s78, s46, 102400
    buffer_load_dwordx4 v1, s[28:31], s78 offen offset:0 sc1 lds
    buffer_load_dwordx4 v1, s[28:31], s78 offen offset:1024 sc1 lds
    v_fma_f32 v85, v85, v53, v52
    v_fma_f32 v86, v86, v53, v52
    v_fma_f32 v87, v87, v53, v52
    v_mul_f32 v84, v84, v100
    v_mul_f32 v85, v85, v101
    v_mul_f32 v86, v86, v102
    v_mul_f32 v87, v87, v103
    v_mfma_f32_32x32x16_bf16 v[112:127], v[156:159], a[180:183], v[112:127]
    v_exp_f32 v84, v84
    v_exp_f32 v85, v85
    v_exp_f32 v86, v86
    v_exp_f32 v87, v87
    ds_read_b128 a[168:171], v4 offset:45056
    ds_read_b128 a[172:175], v4 offset:46080
    s_waitcnt lgkmcnt(4)
    v_mfma_f32_32x32x16_bf16 v[112:127], v[160:163], a[152:155], v[112:127]
    s_add_u32 m0, s54, 137216
    s_add_u32 s78, s46, 104448
    buffer_load_dwordx4 v1, s[28:31], s78 offen offset:0 sc1 lds
    buffer_load_dwordx4 v1, s[28:31], s78 offen offset:1024 sc1 lds
    v_fma_f32 v84, v84, v54, v54
    v_fma_f32 v85, v85, v54, v54
    v_fma_f32 v86, v86, v54, v54
    v_fma_f32 v87, v87, v54, v54
    v_rcp_f32 v84, v84
    v_mfma_f32_32x32x16_bf16 v[112:127], v[164:167], a[156:159], v[112:127]
    v_rcp_f32 v85, v85
    v_rcp_f32 v86, v86
    v_rcp_f32 v87, v87
    v_mul_f32 v84, v84, v100
    ds_read_b128 a[176:179], v4 offset:47104
    ds_read_b128 a[180:183], v4 offset:48128
    s_waitcnt lgkmcnt(4)
    v_mfma_f32_32x32x16_bf16 v[112:127], v[168:171], a[160:163], v[112:127]
    s_waitcnt vmcnt(16)
    ds_read_b64_tr_b16 a[88:89], v15 offset:32768
    ds_read_b64_tr_b16 a[90:91], v15 offset:33792
    ds_read_b64_tr_b16 a[92:93], v16 offset:32768
    ds_read_b64_tr_b16 a[94:95], v16 offset:33792
    v_mul_f32 v85, v85, v101
    v_mul_f32 v86, v86, v102
    v_mul_f32 v87, v87, v103
    v_cvt_pk_bf16_f32 v90, v84, v85
    v_cvt_pk_bf16_f32 v91, v86, v87
    s_add_u32 s79, s48, 0
    buffer_store_dwordx4 v[88:91], v1, s[28:31], s79 offen offset:0 sc1
    v_mul_f32 v80, v104, v104
    v_mfma_f32_32x32x16_bf16 v[112:127], v[172:175], a[164:167], v[112:127]
    v_mul_f32 v81, v105, v105
    v_mul_f32 v82, v106, v106
    v_mul_f32 v83, v107, v107
    v_fma_f32 v80, v80, v53, v52
    v_fma_f32 v81, v81, v53, v52
    v_fma_f32 v82, v82, v53, v52
    v_fma_f32 v83, v83, v53, v52
    ds_read_b128 a[152:155], v4 offset:49152
    ds_read_b128 a[156:159], v4 offset:50176
    s_waitcnt lgkmcnt(8)
    v_mfma_f32_32x32x16_bf16 v[112:127], v[176:179], a[168:171], v[112:127]
    ds_read_b64_tr_b16 a[96:97], v15 offset:34816
    ds_read_b64_tr_b16 a[98:99], v15 offset:35840
    ds_read_b64_tr_b16 a[100:101], v16 offset:34816
    ds_read_b64_tr_b16 a[102:103], v16 offset:35840
    v_mul_f32 v80, v80, v104
    v_mul_f32 v81, v81, v105
    v_mul_f32 v82, v82, v106
    v_mul_f32 v83, v83, v107
    v_exp_f32 v80, v80
    v_mfma_f32_32x32x16_bf16 v[112:127], v[180:183], a[172:175], v[112:127]
    v_exp_f32 v81, v81
    v_exp_f32 v82, v82
    v_exp_f32 v83, v83
    v_fma_f32 v80, v80, v54, v54
    v_fma_f32 v81, v81, v54, v54
    ds_read_b128 a[160:163], v4 offset:51200
    ds_read_b128 a[164:167], v4 offset:52224
    s_waitcnt lgkmcnt(12)
    v_mfma_f32_32x32x16_bf16 v[112:127], v[184:187], a[176:179], v[112:127]
    ds_read_b64_tr_b16 a[104:105], v15 offset:36864
    ds_read_b64_tr_b16 a[106:107], v15 offset:37888
    ds_read_b64_tr_b16 a[108:109], v16 offset:36864
    ds_read_b64_tr_b16 a[110:111], v16 offset:37888
    v_fma_f32 v82, v82, v54, v54
    v_fma_f32 v83, v83, v54, v54
    v_rcp_f32 v80, v80
    v_rcp_f32 v81, v81
    v_rcp_f32 v82, v82
    v_mfma_f32_32x32x16_bf16 v[112:127], v[188:191], a[180:183], v[112:127]
    v_rcp_f32 v83, v83
    v_mul_f32 v80, v80, v104
    v_mul_f32 v81, v81, v105
    v_mul_f32 v82, v82, v106
    v_mul_f32 v83, v83, v107
    ds_read_b128 a[168:171], v4 offset:53248
    ds_read_b128 a[172:175], v4 offset:54272
    s_waitcnt lgkmcnt(12)
    v_mfma_f32_32x32x16_bf16 v[112:127], v[192:195], a[152:155], v[112:127]
    ds_read_b64_tr_b16 a[112:113], v15 offset:38912
    ds_read_b64_tr_b16 a[114:115], v15 offset:39936
    ds_read_b64_tr_b16 a[116:117], v16 offset:38912
    ds_read_b64_tr_b16 a[118:119], v16 offset:39936
    v_cvt_pk_bf16_f32 v92, v80, v81
    v_cvt_pk_bf16_f32 v93, v82, v83
    v_mul_f32 v84, v108, v108
    v_mul_f32 v85, v109, v109
    v_mul_f32 v86, v110, v110
    v_mul_f32 v87, v111, v111
    v_fma_f32 v84, v84, v53, v52
    v_mfma_f32_32x32x16_bf16 v[112:127], v[196:199], a[156:159], v[112:127]
    v_fma_f32 v85, v85, v53, v52
    v_fma_f32 v86, v86, v53, v52
    v_fma_f32 v87, v87, v53, v52
    v_mul_f32 v84, v84, v108
    v_mul_f32 v85, v85, v109
    v_mul_f32 v86, v86, v110
    v_mul_f32 v87, v87, v111
    ds_read_b128 a[176:179], v4 offset:55296
    ds_read_b128 a[180:183], v4 offset:56320
    s_waitcnt lgkmcnt(12)
    v_mfma_f32_32x32x16_bf16 v[112:127], v[200:203], a[160:163], v[112:127]
    v_exp_f32 v84, v84
    v_exp_f32 v85, v85
    v_exp_f32 v86, v86
    v_exp_f32 v87, v87
    v_mfma_f32_32x32x16_bf16 v[112:127], v[204:207], a[164:167], v[112:127]
    v_fma_f32 v84, v84, v54, v54
    v_fma_f32 v85, v85, v54, v54
    v_fma_f32 v86, v86, v54, v54
    v_fma_f32 v87, v87, v54, v54
    v_rcp_f32 v84, v84
    ds_read_b128 a[152:155], v4 offset:57344
    ds_read_b128 a[156:159], v4 offset:58368
    s_waitcnt lgkmcnt(8)
    v_mfma_f32_32x32x16_bf16 v[112:127], v[208:211], a[168:171], v[112:127]
    v_rcp_f32 v85, v85
    v_rcp_f32 v86, v86
    v_rcp_f32 v87, v87
    v_mul_f32 v84, v84, v108
    v_mul_f32 v85, v85, v109
    v_mfma_f32_32x32x16_bf16 v[112:127], v[212:215], a[172:175], v[112:127]
    v_mul_f32 v86, v86, v110
    v_mul_f32 v87, v87, v111
    v_cvt_pk_bf16_f32 v94, v84, v85
    v_cvt_pk_bf16_f32 v95, v86, v87
    s_add_u32 s79, s48, 0
    buffer_store_dwordx4 v[92:95], v1, s[28:31], s79 offen offset:1024 sc1
    s_waitcnt vmcnt(10)
    v_add_f32 v48, v48, v50
    ds_read_b128 a[160:163], v4 offset:59392
    ds_read_b128 a[164:167], v4 offset:60416
    s_waitcnt lgkmcnt(4)
    v_mfma_f32_32x32x16_bf16 v[112:127], v[216:219], a[176:179], v[112:127]
    v_add_f32 v49, v49, v51
    s_nop 1
    v_permlane16_swap_b32 v48, v49
    v_add_f32 v48, v48, v49
    v_mov_b32 v49, v48
    s_nop 1
    v_permlane32_swap_b32 v48, v49
    v_mfma_f32_32x32x16_bf16 v[112:127], v[220:223], a[180:183], v[112:127]
    v_add_f32 v48, v48, v49
    v_mov_b32 v49, v48
    s_nop 1
    v_permlane16_swap_b32 v48, v49
    v_mul_f32 v48, 0x3b000000, v48
    v_mul_f32 v49, 0x3b000000, v49
    v_fma_f32 v49, -v48, v48, v49
    ds_read_b128 a[168:171], v4 offset:61440
    ds_read_b128 a[172:175], v4 offset:62464
    s_waitcnt lgkmcnt(4)
    v_mfma_f32_32x32x16_bf16 v[112:127], v[224:227], a[152:155], v[112:127]
    v_max_f32 v49, 0, v49
    v_add_f32 v50, 0x3727c5ac, v49
    v_rcp_f32 v51, v50
    v_cvt_pk_bf16_f32 v53, v48, v48
    v_mul_f32 v51, v49, v51
    v_add_f32 v51, 0x3727c5ac, v51
    v_mul_f32 v51, v51, v50
    v_mfma_f32_32x32x16_bf16 v[112:127], v[228:231], a[156:159], v[112:127]
    v_sqrt_f32 v54, v51
    v_and_b32 v49, 0xffff0000, v53
    v_rcp_f32 v51, v54
    v_sub_f32 v49, v48, v49
    v_mul_f32 v52, 0xc0135761, v51
    ds_read_b128 a[176:179], v4 offset:63488
    ds_read_b128 a[180:183], v4 offset:64512
    s_waitcnt lgkmcnt(4)
    v_mfma_f32_32x32x16_bf16 v[112:127], v[232:235], a[160:163], v[112:127]
    v_mul_f32 v55, v51, v51
    v_mul_f32 v55, v55, v51
    v_mul_f32 v53, 0xbdd2d3e8, v55
    v_cvt_pk_bf16_f32 v55, v48, v49
    v_cvt_pk_bf16_f32 v49, v48, v54
    v_and_b32 v50, 0xffff0000, v49
    v_sub_f32 v50, v54, v50
    v_mfma_f32_32x32x16_bf16 v[112:127], v[236:239], a[164:167], v[112:127]
    v_cvt_pk_bf16_f32 v50, v50, 0
    v_mov_b32 v48, v55
    v_mov_b32 v51, 0
    s_mov_b64 exec, 0xffff
    ds_write_b128 v26, v[48:51] offset:14336
    ds_write_b128 v26, v[52:55] offset:14352
    s_mov_b64 exec, -1
    s_waitcnt lgkmcnt(4)
    v_mfma_f32_32x32x16_bf16 v[112:127], v[240:243], a[168:171], v[112:127]
    v_mfma_f32_32x32x16_bf16 v[112:127], v[244:247], a[172:175], v[112:127]
    s_waitcnt lgkmcnt(2)
    v_mfma_f32_32x32x16_bf16 v[112:127], v[248:251], a[176:179], v[112:127]
    v_mfma_f32_32x32x16_bf16 v[112:127], v[252:255], a[180:183], v[112:127]
    v_mfma_f32_32x32x16_bf16 v[112:127], v[40:43], v[56:59], v[112:127]
    s_waitcnt vmcnt(2)
    s_waitcnt lgkmcnt(0)
    s_barrier
    ds_read_b128 a[152:155], v24 offset:0
    ds_read_b128 a[156:159], v24 offset:1024
    ds_read_b128 a[160:163], v24 offset:2048
    ds_read_b128 a[164:167], v24 offset:3072
    ds_read_b128 a[168:171], v24 offset:4096
    ds_read_b128 a[172:175], v24 offset:5120
    s_waitcnt lgkmcnt(4)
    v_mfma_f32_32x32x16_bf16 v[96:111], v[128:131], a[152:155], 0
    s_add_u32 m0, s54, 32768
    s_add_u32 s78, s46, 32768
    buffer_load_dwordx4 v1, s[28:31], s78 offen offset:0 sc1 lds
    buffer_load_dwordx4 v1, s[28:31], s78 offen offset:1024 sc1 lds
    v_mul_f32 v80, v112, v112
    v_mul_f32 v81, v113, v113
    v_mul_f32 v82, v114, v114
    v_mul_f32 v83, v115, v115
    v_fma_f32 v80, v80, v61, v60
    v_fma_f32 v81, v81, v61, v60
    v_fma_f32 v82, v82, v61, v60
    v_fma_f32 v83, v83, v61, v60
    v_mfma_f32_32x32x16_bf16 v[96:111], v[132:135], a[156:159], v[96:111]
    v_mul_f32 v80, v80, v112
    v_mul_f32 v81, v81, v113
    v_mul_f32 v82, v82, v114
    v_mul_f32 v83, v83, v115
    v_exp_f32 v80, v80
    v_exp_f32 v81, v81
    ds_read_b128 a[176:179], v24 offset:6144
    ds_read_b128 a[180:183], v24 offset:7168
    s_waitcnt lgkmcnt(4)
    v_mfma_f32_32x32x16_bf16 v[96:111], v[136:139], a[160:163], v[96:111]
    v_exp_f32 v82, v82
    v_exp_f32 v83, v83
    v_fma_f32 v80, v80, v62, v62
    v_fma_f32 v81, v81, v62, v62
    v_fma_f32 v82, v82, v62, v62
    v_fma_f32 v83, v83, v62, v62
    v_mfma_f32_32x32x16_bf16 v[96:111], v[140:143], a[164:167], v[96:111]
    s_add_u32 m0, s54, 34816
    s_add_u32 s78, s46, 34816
    buffer_load_dwordx4 v1, s[28:31], s78 offen offset:0 sc1 lds
    buffer_load_dwordx4 v1, s[28:31], s78 offen offset:1024 sc1 lds
    v_rcp_f32 v80, v80
    v_rcp_f32 v81, v81
    v_rcp_f32 v82, v82
    v_rcp_f32 v83, v83
    ds_read_b128 a[152:155], v24 offset:8192
    ds_read_b128 a[156:159], v24 offset:9216
    s_waitcnt lgkmcnt(4)
    v_mfma_f32_32x32x16_bf16 v[96:111], v[144:147], a[168:171], v[96:111]
    v_mul_f32 v80, v80, v112
    v_mul_f32 v81, v81, v113
    v_mul_f32 v82, v82, v114
    v_mul_f32 v83, v83, v115
    v_cvt_pk_bf16_f32 v88, v80, v81
    v_cvt_pk_bf16_f32 v89, v82, v83
    v_mul_f32 v84, v116, v116
    v_mul_f32 v85, v117, v117
    v_mfma_f32_32x32x16_bf16 v[96:111], v[148:151], a[172:175], v[96:111]
    v_mul_f32 v86, v118, v118
    v_mul_f32 v87, v119, v119
    v_fma_f32 v84, v84, v61, v60
    v_fma_f32 v85, v85, v61, v60
    v_fma_f32 v86, v86, v61, v60
    v_fma_f32 v87, v87, v61, v60
    v_mul_f32 v84, v84, v116
    ds_read_b128 a[160:163], v24 offset:10240
    ds_read_b128 a[164:167], v24 offset:11264
    s_waitcnt lgkmcnt(4)
    v_mfma_f32_32x32x16_bf16 v[96:111], v[152:155], a[176:179], v[96:111]
    s_add_u32 m0, s54, 36864
    s_add_u32 s78, s46, 36864
    buffer_load_dwordx4 v1, s[28:31], s78 offen offset:0 sc1 lds
    buffer_load_dwordx4 v1, s[28:31], s78 offen offset:1024 sc1 lds
    v_mul_f32 v85, v85, v117
    v_mul_f32 v86, v86, v118
    v_mul_f32 v87, v87, v119
    v_exp_f32 v84, v84
    v_exp_f32 v85, v85
    v_exp_f32 v86, v86
    v_mfma_f32_32x32x16_bf16 v[96:111], v[156:159], a[180:183], v[96:111]
    v_exp_f32 v87, v87
    v_fma_f32 v84, v84, v62, v62
    v_fma_f32 v85, v85, v62, v62
    v_fma_f32 v86, v86, v62, v62
    v_fma_f32 v87, v87, v62, v62
    v_rcp_f32 v84, v84
    ds_read_b128 a[168:171], v24 offset:12288
    ds_read_b128 a[172:175], v24 offset:13312
    s_waitcnt lgkmcnt(4)
    v_mfma_f32_32x32x16_bf16 v[96:111], v[160:163], a[152:155], v[96:111]
    v_rcp_f32 v85, v85
    v_rcp_f32 v86, v86
    v_rcp_f32 v87, v87
    v_mul_f32 v84, v84, v116
    v_mfma_f32_32x32x16_bf16 v[96:111], v[164:167], a[156:159], v[96:111]
    s_add_u32 m0, s54, 38912
    s_add_u32 s78, s46, 38912
    buffer_load_dwordx4 v1, s[28:31], s78 offen offset:0 sc1 lds
    buffer_load_dwordx4 v1, s[28:31], s78 offen offset:1024 sc1 lds
    v_mul_f32 v85, v85, v117
    v_mul_f32 v86, v86, v118
    v_mul_f32 v87, v87, v119
    v_cvt_pk_bf16_f32 v90, v84, v85
    v_cvt_pk_bf16_f32 v91, v86, v87
    s_add_u32 s79, s48, 229376
    buffer_store_dwordx4 v[88:91], v1, s[28:31], s79 offen offset:0 sc1
    v_mul_f32 v80, v120, v120
    ds_read_b128 a[176:179], v24 offset:14336
    ds_read_b128 a[180:183], v24 offset:15360
    s_waitcnt lgkmcnt(4)
    v_mfma_f32_32x32x16_bf16 v[96:111], v[168:171], a[160:163], v[96:111]
    v_mul_f32 v81, v121, v121
    v_mul_f32 v82, v122, v122
    v_mul_f32 v83, v123, v123
    v_fma_f32 v80, v80, v61, v60
    v_fma_f32 v81, v81, v61, v60
    v_fma_f32 v82, v82, v61, v60
    v_fma_f32 v83, v83, v61, v60
    v_mul_f32 v80, v80, v120
    v_mfma_f32_32x32x16_bf16 v[96:111], v[172:175], a[164:167], v[96:111]
    v_mul_f32 v81, v81, v121
    v_mul_f32 v82, v82, v122
    v_mul_f32 v83, v83, v123
    v_exp_f32 v80, v80
    v_exp_f32 v81, v81
    ds_read_b128 a[152:155], v24 offset:16384
    ds_read_b128 a[156:159], v24 offset:17408
    s_waitcnt lgkmcnt(4)
    v_mfma_f32_32x32x16_bf16 v[96:111], v[176:179], a[168:171], v[96:111]
    v_exp_f32 v82, v82
    v_exp_f32 v83, v83
    v_fma_f32 v80, v80, v62, v62
    v_fma_f32 v81, v81, v62, v62
    v_fma_f32 v82, v82, v62, v62
    v_fma_f32 v83, v83, v62, v62
    v_mfma_f32_32x32x16_bf16 v[96:111], v[180:183], a[172:175], v[96:111]
    v_rcp_f32 v80, v80
    v_rcp_f32 v81, v81
    v_rcp_f32 v82, v82
    v_rcp_f32 v83, v83
    v_mul_f32 v80, v80, v120
    ds_read_b128 a[160:163], v24 offset:18432
    ds_read_b128 a[164:167], v24 offset:19456
    s_waitcnt lgkmcnt(4)
    v_mfma_f32_32x32x16_bf16 v[96:111], v[184:187], a[176:179], v[96:111]
    s_waitcnt vmcnt(9)
    s_add_u32 s80, s49, 0
    s_barrier
    s_cmp_lg_u32 s62, 0
    s_cbranch_scc1 L_nofl_30
    s_lshl_b32 s82, s80, 5
    s_add_u32 s82, s82, 16777216
    s_mov_b64 exec, 1
    buffer_store_dword v7, v6, s[28:31], s82 offen sc1
    s_mov_b64 exec, -1
L_nofl_30:
    v_mul_f32 v81, v81, v121
    v_mul_f32 v82, v82, v122
    v_mul_f32 v83, v83, v123
    v_cvt_pk_bf16_f32 v92, v80, v81
    v_cvt_pk_bf16_f32 v93, v82, v83
    v_mul_f32 v84, v124, v124
    v_mul_f32 v85, v125, v125
    v_mul_f32 v86, v126, v126
    v_mfma_f32_32x32x16_bf16 v[96:111], v[188:191], a[180:183], v[96:111]
    v_mul_f32 v87, v127, v127
    v_fma_f32 v84, v84, v61, v60
    v_fma_f32 v85, v85, v61, v60
    v_fma_f32 v86, v86, v61, v60
    v_fma_f32 v87, v87, v61, v60
    v_mul_f32 v84, v84, v124
    v_mul_f32 v85, v85, v125
    ds_read_b128 a[168:171], v24 offset:20480
    ds_read_b128 a[172:175], v24 offset:21504
    s_waitcnt lgkmcnt(4)
    v_mfma_f32_32x32x16_bf16 v[96:111], v[192:195], a[152:155], v[96:111]
    s_add_u32 m0, s54, 65536
    s_add_u32 s78, s56, 393216
    buffer_load_dwordx4 v11, s[20:23], s78 offen offset:0 lds
    buffer_load_dwordx4 v12, s[20:23], s78 offen offset:1024 lds
    v_mul_f32 v86, v86, v126
    v_mul_f32 v87, v87, v127
    v_exp_f32 v84, v84
    v_exp_f32 v85, v85
    v_exp_f32 v86, v86
    v_mfma_f32_32x32x16_bf16 v[96:111], v[196:199], a[156:159], v[96:111]
    v_exp_f32 v87, v87
    v_fma_f32 v84, v84, v62, v62
    v_fma_f32 v85, v85, v62, v62
    v_fma_f32 v86, v86, v62, v62
    v_fma_f32 v87, v87, v62, v62
    v_rcp_f32 v84, v84
    ds_read_b128 a[176:179], v24 offset:22528
    ds_read_b128 a[180:183], v24 offset:23552
    s_waitcnt lgkmcnt(4)
    v_mfma_f32_32x32x16_bf16 v[96:111], v[200:203], a[160:163], v[96:111]
    v_rcp_f32 v85, v85
    v_rcp_f32 v86, v86
    v_rcp_f32 v87, v87
    v_mul_f32 v84, v84, v124
    v_mul_f32 v85, v85, v125
    v_mfma_f32_32x32x16_bf16 v[96:111], v[204:207], a[164:167], v[96:111]
    v_mul_f32 v86, v86, v126
    v_mul_f32 v87, v87, v127
    v_cvt_pk_bf16_f32 v94, v84, v85
    v_cvt_pk_bf16_f32 v95, v86, v87
    s_add_u32 s79, s48, 229376
    buffer_store_dwordx4 v[92:95], v1, s[28:31], s79 offen offset:1024 sc1
    ds_read_b128 v[48:51], v10 offset:30720
    ds_read_b128 v[52:55], v10 offset:30736
    ds_read_b128 a[152:155], v24 offset:24576
    ds_read_b128 a[156:159], v24 offset:25600
    s_waitcnt lgkmcnt(6)
    v_mfma_f32_32x32x16_bf16 v[96:111], v[208:211], a[168:171], v[96:111]
    s_add_u32 m0, s54, 67584
    s_add_u32 s78, s56, 409600
    buffer_load_dwordx4 v11, s[20:23], s78 offen offset:0 lds
    buffer_load_dwordx4 v12, s[20:23], s78 offen offset:1024 lds
    v_mfma_f32_32x32x16_bf16 v[96:111], v[212:215], a[172:175], v[96:111]
    ds_read_b128 a[160:163], v24 offset:26624
    ds_read_b128 a[164:167], v24 offset:27648
    s_waitcnt lgkmcnt(6)
    v_mfma_f32_32x32x16_bf16 v[96:111], v[216:219], a[176:179], v[96:111]
    v_mfma_f32_32x32x16_bf16 v[96:111], v[220:223], a[180:183], v[96:111]
    ds_read_b128 a[168:171], v24 offset:28672
    ds_read_b128 a[172:175], v24 offset:29696
    s_waitcnt lgkmcnt(4)
    v_mfma_f32_32x32x16_bf16 v[96:111], v[224:227], a[152:155], v[96:111]
    s_add_u32 m0, s54, 69632
    s_add_u32 s78, s56, 425984
    buffer_load_dwordx4 v11, s[20:23], s78 offen offset:0 lds
    buffer_load_dwordx4 v12, s[20:23], s78 offen offset:1024 lds
    v_mfma_f32_32x32x16_bf16 v[96:111], v[228:231], a[156:159], v[96:111]
    ds_read_b128 a[176:179], v24 offset:30720
    ds_read_b128 a[180:183], v24 offset:31744
    s_waitcnt lgkmcnt(4)
    v_mfma_f32_32x32x16_bf16 v[96:111], v[232:235], a[160:163], v[96:111]
    v_mfma_f32_32x32x16_bf16 v[96:111], v[236:239], a[164:167], v[96:111]
    s_waitcnt lgkmcnt(2)
    v_mfma_f32_32x32x16_bf16 v[96:111], v[240:243], a[168:171], v[96:111]
    s_add_u32 m0, s54, 71680
    s_add_u32 s78, s56, 442368
    buffer_load_dwordx4 v11, s[20:23], s78 offen offset:0 lds
    buffer_load_dwordx4 v12, s[20:23], s78 offen offset:1024 lds
    v_mfma_f32_32x32x16_bf16 v[96:111], v[244:247], a[172:175], v[96:111]
    s_waitcnt lgkmcnt(0)
    v_mfma_f32_32x32x16_bf16 v[96:111], v[248:251], a[176:179], v[96:111]
    v_mfma_f32_32x32x16_bf16 v[96:111], v[252:255], a[180:183], v[96:111]
    v_mfma_f32_32x32x16_bf16 v[96:111], v[40:43], v[48:51], v[96:111]
    ds_read_b128 v[56:59], v10 offset:14336
    ds_read_b128 v[60:63], v10 offset:14352
    s_waitcnt vmcnt(10)
    s_barrier
    ds_read_b128 a[152:155], v1 offset:32768
    ds_read_b128 a[156:159], v1 offset:33792
    ds_read_b128 a[160:163], v1 offset:34816
    ds_read_b128 a[164:167], v1 offset:35840
    ds_read_b128 a[168:171], v1 offset:36864
    ds_read_b128 a[172:175], v1 offset:37888
    s_waitcnt lgkmcnt(4)
    v_mfma_f32_32x32x16_bf16 v[112:127], v[128:131], a[152:155], 0
    v_mul_f32 v80, v96, v96
    v_mul_f32 v81, v97, v97
    v_mul_f32 v82, v98, v98
    v_mul_f32 v83, v99, v99
    v_fma_f32 v80, v80, v53, v52
    v_mfma_f32_32x32x16_bf16 v[112:127], v[132:135], a[156:159], v[112:127]
    v_fma_f32 v81, v81, v53, v52
    v_fma_f32 v82, v82, v53, v52
    v_fma_f32 v83, v83, v53, v52
    v_mul_f32 v80, v80, v96
    v_mul_f32 v81, v81, v97
    ds_read_b128 a[176:179], v1 offset:38912
    ds_read_b128 a[180:183], v1 offset:39936
    s_waitcnt lgkmcnt(4)
    v_mfma_f32_32x32x16_bf16 v[112:127], v[136:139], a[160:163], v[112:127]
    v_mul_f32 v82, v82, v98
    v_mul_f32 v83, v83, v99
    v_exp_f32 v80, v80
    v_mfma_f32_32x32x16_bf16 v[112:127], v[140:143], a[164:167], v[112:127]
    v_exp_f32 v81, v81
    v_exp_f32 v82, v82
    v_exp_f32 v83, v83
    ds_read_b128 a[152:155], v1 offset:40960
    ds_read_b128 a[156:159], v1 offset:41984
    s_waitcnt lgkmcnt(4)
    v_mfma_f32_32x32x16_bf16 v[112:127], v[144:147], a[168:171], v[112:127]
    v_fma_f32 v80, v80, v54, v54
    v_fma_f32 v81, v81, v54, v54
    v_fma_f32 v82, v82, v54, v54
    v_fma_f32 v83, v83, v54, v54
    v_mfma_f32_32x32x16_bf16 v[112:127], v[148:151], a[172:175], v[112:127]
    v_rcp_f32 v80, v80
    v_rcp_f32 v81, v81
    v_rcp_f32 v82, v82
    ds_read_b128 a[160:163], v1 offset:43008
    ds_read_b128 a[164:167], v1 offset:44032
    s_waitcnt lgkmcnt(4)
    v_mfma_f32_32x32x16_bf16 v[112:127], v[152:155], a[176:179], v[112:127]
    v_rcp_f32 v83, v83
    v_mul_f32 v80, v80, v96
    v_mul_f32 v81, v81, v97
    v_mfma_f32_32x32x16_bf16 v[112:127], v[156:159], a[180:183], v[112:127]
    v_mul_f32 v82, v82, v98
    v_mul_f32 v83, v83, v99
    v_cvt_pk_bf16_f32 v88, v80, v81
    v_cvt_pk_bf16_f32 v89, v82, v83
    v_mul_f32 v84, v100, v100
    ds_read_b128 a[168:171], v1 offset:45056
    ds_read_b128 a[172:175], v1 offset:46080
    s_waitcnt lgkmcnt(4)
    v_mfma_f32_32x32x16_bf16 v[112:127], v[160:163], a[152:155], v[112:127]
    s_waitcnt vmcnt(6)
    s_add_u32 s80, s49, 256
    s_barrier
    s_cmp_lg_u32 s62, 0
    s_cbranch_scc1 L_nofl_31
    s_lshl_b32 s82, s80, 5
    s_add_u32 s82, s82, 16777216
    s_mov_b64 exec, 1
    buffer_store_dword v7, v6, s[28:31], s82 offen sc1
    s_mov_b64 exec, -1
L_nofl_31:
    v_mul_f32 v85, v101, v101
    v_mul_f32 v86, v102, v102
    v_mul_f32 v87, v103, v103
    v_fma_f32 v84, v84, v53, v52
    v_fma_f32 v85, v85, v53, v52
    v_mfma_f32_32x32x16_bf16 v[112:127], v[164:167], a[156:159], v[112:127]
    v_fma_f32 v86, v86, v53, v52
    v_fma_f32 v87, v87, v53, v52
    v_mul_f32 v84, v84, v100
    v_mul_f32 v85, v85, v101
    v_mul_f32 v86, v86, v102
    ds_read_b128 a[176:179], v1 offset:47104
    ds_read_b128 a[180:183], v1 offset:48128
    s_waitcnt lgkmcnt(4)
    v_mfma_f32_32x32x16_bf16 v[112:127], v[168:171], a[160:163], v[112:127]
    v_mul_f32 v87, v87, v103
    v_exp_f32 v84, v84
    v_exp_f32 v85, v85
    v_mfma_f32_32x32x16_bf16 v[112:127], v[172:175], a[164:167], v[112:127]
    v_exp_f32 v86, v86
    v_exp_f32 v87, v87
    v_fma_f32 v84, v84, v54, v54
    ds_read_b128 a[152:155], v1 offset:49152
    ds_read_b128 a[156:159], v1 offset:50176
    s_waitcnt lgkmcnt(4)
    v_mfma_f32_32x32x16_bf16 v[112:127], v[176:179], a[168:171], v[112:127]
    v_fma_f32 v85, v85, v54, v54
    v_fma_f32 v86, v86, v54, v54
    v_fma_f32 v87, v87, v54, v54
    v_rcp_f32 v84, v84
    v_mfma_f32_32x32x16_bf16 v[112:127], v[180:183], a[172:175], v[112:127]
    v_rcp_f32 v85, v85
    v_rcp_f32 v86, v86
    ds_read_b128 a[160:163], v1 offset:51200
    ds_read_b128 a[164:167], v1 offset:52224
    s_waitcnt lgkmcnt(4)
    v_mfma_f32_32x32x16_bf16 v[112:127], v[184:187], a[176:179], v[112:127]
    v_rcp_f32 v87, v87
    v_mul_f32 v84, v84, v100
    v_mul_f32 v85, v85, v101
    v_mul_f32 v86, v86, v102
    v_mfma_f32_32x32x16_bf16 v[112:127], v[188:191], a[180:183], v[112:127]
    v_mul_f32 v87, v87, v103
    v_cvt_pk_bf16_f32 v90, v84, v85
    v_cvt_pk_bf16_f32 v91, v86, v87
    s_add_u32 s79, s48, 344064
    buffer_store_dwordx4 v[88:91], v1, s[28:31], s79 offen offset:0 sc1
    ds_read_b128 a[168:171], v1 offset:53248
    ds_read_b128 a[172:175], v1 offset:54272
    s_waitcnt lgkmcnt(4)
    v_mfma_f32_32x32x16_bf16 v[112:127], v[192:195], a[152:155], v[112:127]
    v_mul_f32 v80, v104, v104
    v_mul_f32 v81, v105, v105
    v_mul_f32 v82, v106, v106
    v_mul_f32 v83, v107, v107
    v_fma_f32 v80, v80, v53, v52
    v_mfma_f32_32x32x16_bf16 v[112:127], v[196:199], a[156:159], v[112:127]
    v_fma_f32 v81, v81, v53, v52
    v_fma_f32 v82, v82, v53, v52
    v_fma_f32 v83, v83, v53, v52
    v_mul_f32 v80, v80, v104
    v_mul_f32 v81, v81, v105
    ds_read_b128 a[176:179], v1 offset:55296
    ds_read_b128 a[180:183], v1 offset:56320
    s_waitcnt lgkmcnt(4)
    v_mfma_f32_32x32x16_bf16 v[112:127], v[200:203], a[160:163], v[112:127]
    v_mul_f32 v82, v82, v106
    v_mul_f32 v83, v83, v107
    v_exp_f32 v80, v80
    v_mfma_f32_32x32x16_bf16 v[112:127], v[204:207], a[164:167], v[112:127]
    v_exp_f32 v81, v81
    v_exp_f32 v82, v82
    v_exp_f32 v83, v83
    ds_read_b128 a[152:155], v1 offset:57344
    ds_read_b128 a[156:159], v1 offset:58368
    s_waitcnt lgkmcnt(4)
    v_mfma_f32_32x32x16_bf16 v[112:127], v[208:211], a[168:171], v[112:127]
    v_fma_f32 v80, v80, v54, v54
    v_fma_f32 v81, v81, v54, v54
    v_fma_f32 v82, v82, v54, v54
    v_fma_f32 v83, v83, v54, v54
    v_mfma_f32_32x32x16_bf16 v[112:127], v[212:215], a[172:175], v[112:127]
    v_rcp_f32 v80, v80
    v_rcp_f32 v81, v81
    v_rcp_f32 v82, v82
    ds_read_b128 a[160:163], v1 offset:59392
    ds_read_b128 a[164:167], v1 offset:60416
    s_waitcnt lgkmcnt(4)
    v_mfma_f32_32x32x16_bf16 v[112:127], v[216:219], a[176:179], v[112:127]
    v_rcp_f32 v83, v83
    v_mul_f32 v80, v80, v104
    v_mul_f32 v81, v81, v105
    v_mfma_f32_32x32x16_bf16 v[112:127], v[220:223], a[180:183], v[112:127]
    v_mul_f32 v82, v82, v106
    v_mul_f32 v83, v83, v107
    v_cvt_pk_bf16_f32 v92, v80, v81
    v_cvt_pk_bf16_f32 v93, v82, v83
    v_mul_f32 v84, v108, v108
    ds_read_b128 a[168:171], v1 offset:61440
    ds_read_b128 a[172:175], v1 offset:62464
    s_waitcnt lgkmcnt(4)
    v_mfma_f32_32x32x16_bf16 v[112:127], v[224:227], a[152:155], v[112:127]
    v_mul_f32 v85, v109, v109
    v_mul_f32 v86, v110, v110
    v_mul_f32 v87, v111, v111
    v_fma_f32 v84, v84, v53, v52
    v_fma_f32 v85, v85, v53, v52
    v_mfma_f32_32x32x16_bf16 v[112:127], v[228:231], a[156:159], v[112:127]
    s_lshl_b32 s74, s65, 8
    s_mul_i32 s75, s62, 56
    s_add_u32 s40, s74, 24576
    v_min_u32 v9, 13, v0
    v_lshl_add_u32 v9, v9, 2, s75
    s_mul_i32 s74, s65, 229376
    s_mul_i32 s75, s62, 28672
    s_add_u32 s74, s74, s75
    s_add_u32 s41, s74, 9437184
    v_fma_f32 v86, v86, v53, v52
    v_fma_f32 v87, v87, v53, v52
    v_mul_f32 v84, v84, v108
    v_mul_f32 v85, v85, v109
    v_mul_f32 v86, v86, v110
    ds_read_b128 a[176:179], v1 offset:63488
    ds_read_b128 a[180:183], v1 offset:64512
    s_waitcnt lgkmcnt(4)
    v_mfma_f32_32x32x16_bf16 v[112:127], v[232:235], a[160:163], v[112:127]
    v_and_b32 v5, -13, v9
    v_lshlrev_b32 v5, 5, v5
    s_lshl_b32 s84, s40, 5
    s_add_u32 s84, s84, 16777216
    buffer_load_dword v8, v5, s[28:31], s84 offen sc1
    v_mul_f32 v87, v87, v111
    v_exp_f32 v84, v84
    v_exp_f32 v85, v85
    v_mfma_f32_32x32x16_bf16 v[112:127], v[236:239], a[164:167], v[112:127]
    v_exp_f32 v86, v86
    v_exp_f32 v87, v87
    v_fma_f32 v84, v84, v54, v54
    s_waitcnt lgkmcnt(2)
    v_mfma_f32_32x32x16_bf16 v[112:127], v[240:243], a[168:171], v[112:127]
    v_fma_f32 v85, v85, v54, v54
    v_fma_f32 v86, v86, v54, v54
    v_fma_f32 v87, v87, v54, v54
    v_rcp_f32 v84, v84
    v_mfma_f32_32x32x16_bf16 v[112:127], v[244:247], a[172:175], v[112:127]
    v_rcp_f32 v85, v85
    v_rcp_f32 v86, v86
    s_waitcnt lgkmcnt(0)
    v_mfma_f32_32x32x16_bf16 v[112:127], v[248:251], a[176:179], v[112:127]
    v_rcp_f32 v87, v87
    v_mul_f32 v84, v84, v108
    v_mul_f32 v85, v85, v109
    v_mul_f32 v86, v86, v110
    v_mfma_f32_32x32x16_bf16 v[112:127], v[252:255], a[180:183], v[112:127]
    v_mul_f32 v87, v87, v111
    v_cvt_pk_bf16_f32 v94, v84, v85
    v_cvt_pk_bf16_f32 v95, v86, v87
    s_add_u32 s79, s48, 344064
    buffer_store_dwordx4 v[92:95], v1, s[28:31], s79 offen offset:1024 sc1
    v_mfma_f32_32x32x16_bf16 v[112:127], v[40:43], v[56:59], v[112:127]
    s_waitcnt vmcnt(1)
    v_cmp_ne_u32 vcc, s70, v8
    s_nop 0
    s_cbranch_vccnz L_retry_32
L_back_33:
    s_add_u32 s81, s41, 0
    buffer_load_dwordx4 v[128:131], v1, s[28:31], s81 offen offset:0 sc1
    s_nop 5
    v_mul_f32 v80, v112, v112
    v_mul_f32 v81, v113, v113
    v_mul_f32 v82, v114, v114
    v_mul_f32 v83, v115, v115
    v_fma_f32 v80, v80, v61, v60
    v_fma_f32 v81, v81, v61, v60
    v_fma_f32 v82, v82, v61, v60
    v_fma_f32 v83, v83, v61, v60
    v_mul_f32 v80, v80, v112
    v_mul_f32 v81, v81, v113
    v_mul_f32 v82, v82, v114
    v_mul_f32 v83, v83, v115
    v_exp_f32 v80, v80
    v_exp_f32 v81, v81
    buffer_load_dwordx4 v[132:135], v1, s[28:31], s81 offen offset:1024 sc1
    v_exp_f32 v82, v82
    v_exp_f32 v83, v83
    v_fma_f32 v80, v80, v62, v62
    v_fma_f32 v81, v81, v62, v62
    v_fma_f32 v82, v82, v62, v62
    v_fma_f32 v83, v83, v62, v62
    v_rcp_f32 v80, v80
    v_rcp_f32 v81, v81
    v_rcp_f32 v82, v82
    v_rcp_f32 v83, v83
    buffer_load_dwordx4 v[136:139], v1, s[28:31], s81 offen offset:2048 sc1
    v_mul_f32 v80, v80, v112
    v_mul_f32 v81, v81, v113
    v_mul_f32 v82, v82, v114
    v_mul_f32 v83, v83, v115
    v_cvt_pk_bf16_f32 v88, v80, v81
    v_cvt_pk_bf16_f32 v89, v82, v83
    v_mul_f32 v84, v116, v116
    v_mul_f32 v85, v117, v117
    v_mul_f32 v86, v118, v118
    v_mul_f32 v87, v119, v119
    v_fma_f32 v84, v84, v61, v60
    v_fma_f32 v85, v85, v61, v60
    v_fma_f32 v86, v86, v61, v60
    v_fma_f32 v87, v87, v61, v60
    v_mul_f32 v84, v84, v116
    buffer_load_dwordx4 v[140:143], v1, s[28:31], s81 offen offset:3072 sc1
    v_mul_f32 v85, v85, v117
    v_mul_f32 v86, v86, v118
    v_mul_f32 v87, v87, v119
    v_exp_f32 v84, v84
    v_exp_f32 v85, v85
    v_exp_f32 v86, v86
    v_exp_f32 v87, v87
    v_fma_f32 v84, v84, v62, v62
    v_fma_f32 v85, v85, v62, v62
    v_fma_f32 v86, v86, v62, v62
    v_fma_f32 v87, v87, v62, v62
    s_add_u32 s81, s41, 4096
    buffer_load_dwordx4 v[144:147], v1, s[28:31], s81 offen offset:0 sc1
    v_rcp_f32 v84, v84
    v_rcp_f32 v85, v85
    v_rcp_f32 v86, v86
    v_rcp_f32 v87, v87
    v_mul_f32 v84, v84, v116
    v_mul_f32 v85, v85, v117
    v_mul_f32 v86, v86, v118
    v_mul_f32 v87, v87, v119
    v_cvt_pk_bf16_f32 v90, v84, v85
    v_cvt_pk_bf16_f32 v91, v86, v87
    s_add_u32 s79, s48, 114688
    buffer_store_dwordx4 v[88:91], v1, s[28:31], s79 offen offset:0 sc1
    buffer_load_dwordx4 v[148:151], v1, s[28:31], s81 offen offset:1024 sc1
    v_mul_f32 v80, v120, v120
    v_mul_f32 v81, v121, v121
    v_mul_f32 v82, v122, v122
    v_mul_f32 v83, v123, v123
    v_fma_f32 v80, v80, v61, v60
    v_fma_f32 v81, v81, v61, v60
    v_fma_f32 v82, v82, v61, v60
    v_fma_f32 v83, v83, v61, v60
    v_mul_f32 v80, v80, v120
    v_mul_f32 v81, v81, v121
    v_mul_f32 v82, v82, v122
    v_mul_f32 v83, v83, v123
    v_exp_f32 v80, v80
    v_exp_f32 v81, v81
    buffer_load_dwordx4 v[152:155], v1, s[28:31], s81 offen offset:2048 sc1
    v_exp_f32 v82, v82
    v_exp_f32 v83, v83
    v_fma_f32 v80, v80, v62, v62
    v_fma_f32 v81, v81, v62, v62
    v_fma_f32 v82, v82, v62, v62
    v_fma_f32 v83, v83, v62, v62
    v_rcp_f32 v80, v80
    v_rcp_f32 v81, v81
    v_rcp_f32 v82, v82
    v_rcp_f32 v83, v83
    buffer_load_dwordx4 v[156:159], v1, s[28:31], s81 offen offset:3072 sc1
    v_mul_f32 v80, v80, v120
    v_mul_f32 v81, v81, v121
    v_mul_f32 v82, v82, v122
    v_mul_f32 v83, v83, v123
    v_cvt_pk_bf16_f32 v92, v80, v81
    v_cvt_pk_bf16_f32 v93, v82, v83
    v_mul_f32 v84, v124, v124
    v_mul_f32 v85, v125, v125
    v_mul_f32 v86, v126, v126
    v_mul_f32 v87, v127, v127
    v_fma_f32 v84, v84, v61, v60
    v_fma_f32 v85, v85, v61, v60
    v_fma_f32 v86, v86, v61, v60
    v_fma_f32 v87, v87, v61, v60
    v_mul_f32 v84, v84, v124
    s_add_u32 s81, s41, 8192
    buffer_load_dwordx4 v[160:163], v1, s[28:31], s81 offen offset:0 sc1
    v_mul_f32 v85, v85, v125
    v_mul_f32 v86, v86, v126
    v_mul_f32 v87, v87, v127
    v_exp_f32 v84, v84
    v_exp_f32 v85, v85
    v_exp_f32 v86, v86
    v_exp_f32 v87, v87
    v_fma_f32 v84, v84, v62, v62
    v_fma_f32 v85, v85, v62, v62
    v_fma_f32 v86, v86, v62, v62
    v_fma_f32 v87, v87, v62, v62
    buffer_load_dwordx4 v[164:167], v1, s[28:31], s81 offen offset:1024 sc1
    v_rcp_f32 v84, v84
    v_rcp_f32 v85, v85
    v_rcp_f32 v86, v86
    v_rcp_f32 v87, v87
    v_mul_f32 v84, v84, v124
    v_mul_f32 v85, v85, v125
    v_mul_f32 v86, v86, v126
    v_mul_f32 v87, v87, v127
    v_cvt_pk_bf16_f32 v94, v84, v85
    v_cvt_pk_bf16_f32 v95, v86, v87
    s_add_u32 s79, s48, 114688
    buffer_store_dwordx4 v[92:95], v1, s[28:31], s79 offen offset:1024 sc1
    s_waitcnt vmcnt(12)
    s_add_u32 s80, s49, 8448
    s_barrier
    s_cmp_lg_u32 s62, 0
    s_cbranch_scc1 L_nofl_34
    s_lshl_b32 s82, s80, 5
    s_add_u32 s82, s82, 16777216
    s_mov_b64 exec, 1
    buffer_store_dword v7, v6, s[28:31], s82 offen sc1
    s_mov_b64 exec, -1
L_nofl_34:
L_s5:
    s_add_u32 s40, s40, 8192
    ds_read_b64_tr_b16 a[64:65], v15 offset:0
    ds_read_b64_tr_b16 a[66:67], v15 offset:1024
    buffer_load_dwordx4 v[168:171], v1, s[28:31], s81 offen offset:2048 sc1
    s_waitcnt vmcnt(12)
    v_mfma_f32_32x32x16_bf16 v[96:111], a[184:187], v[128:131], 0
    v_mfma_f32_32x32x16_bf16 v[112:127], a[188:191], v[128:131], 0
    ds_read_b64_tr_b16 a[68:69], v16 offset:0
    ds_read_b64_tr_b16 a[70:71], v16 offset:1024
    buffer_load_dwordx4 v[172:175], v1, s[28:31], s81 offen offset:3072 sc1
    s_waitcnt vmcnt(12)
    v_mfma_f32_32x32x16_bf16 v[96:111], a[192:195], v[132:135], v[96:111]
    v_mfma_f32_32x32x16_bf16 v[112:127], a[196:199], v[132:135], v[112:127]
    ds_read_b64_tr_b16 a[72:73], v15 offset:2048
    ds_read_b64_tr_b16 a[74:75], v15 offset:3072
    s_add_u32 s81, s41, 12288
    buffer_load_dwordx4 v[176:179], v1, s[28:31], s81 offen offset:0 sc1
    s_waitcnt vmcnt(12)
    v_mfma_f32_32x32x16_bf16 v[96:111], a[200:203], v[136:139], v[96:111]
    v_mfma_f32_32x32x16_bf16 v[112:127], a[204:207], v[136:139], v[112:127]
    ds_read_b64_tr_b16 a[76:77], v16 offset:2048
    ds_read_b64_tr_b16 a[78:79], v16 offset:3072
    buffer_load_dwordx4 v[180:183], v1, s[28:31], s81 offen offset:1024 sc1
    s_waitcnt vmcnt(12)
    v_mfma_f32_32x32x16_bf16 v[96:111], a[208:211], v[140:143], v[96:111]
    v_mfma_f32_32x32x16_bf16 v[112:127], a[212:215], v[140:143], v[112:127]
    ds_read_b64_tr_b16 a[80:81], v15 offset:4096
    ds_read_b64_tr_b16 a[82:83], v15 offset:5120
    buffer_load_dwordx4 v[184:187], v1, s[28:31], s81 offen offset:2048 sc1
    s_waitcnt vmcnt(5)
    s_add_u32 s80, s49, 8192
    s_barrier
    s_cmp_lg_u32 s62, 0
    s_cbranch_scc1 L_nofl_38
    s_lshl_b32 s82, s80, 5
    s_add_u32 s82, s82, 16777216
    s_mov_b64 exec, 1
    buffer_store_dword v7, v6, s[28:31], s82 offen sc1
    s_mov_b64 exec, -1
L_nofl_38:
    v_mfma_f32_32x32x16_bf16 v[96:111], a[216:219], v[144:147], v[96:111]
    v_mfma_f32_32x32x16_bf16 v[112:127], a[220:223], v[144:147], v[112:127]
    ds_read_b64_tr_b16 a[84:85], v16 offset:4096
    ds_read_b64_tr_b16 a[86:87], v16 offset:5120
    buffer_load_dwordx4 v[188:191], v1, s[28:31], s81 offen offset:3072 sc1
    v_mfma_f32_32x32x16_bf16 v[96:111], a[224:227], v[148:151], v[96:111]
    v_mfma_f32_32x32x16_bf16 v[112:127], a[228:231], v[148:151], v[112:127]
    ds_read_b64_tr_b16 a[120:121], v44 offset:0
    ds_read_b64_tr_b16 a[122:123], v44 offset:1024
    s_add_u32 s81, s41, 16384
    buffer_load_dwordx4 v[192:195], v1, s[28:31], s81 offen offset:0 sc1
    v_mfma_f32_32x32x16_bf16 v[96:111], a[232:235], v[152:155], v[96:111]
    v_mfma_f32_32x32x16_bf16 v[112:127], a[236:239], v[152:155], v[112:127]
    ds_read_b64_tr_b16 a[124:125], v45 offset:0
    ds_read_b64_tr_b16 a[126:127], v45 offset:1024
    buffer_load_dwordx4 v[196:199], v1, s[28:31], s81 offen offset:1024 sc1
    v_mfma_f32_32x32x16_bf16 v[96:111], a[240:243], v[156:159], v[96:111]
    v_mfma_f32_32x32x16_bf16 v[112:127], a[244:247], v[156:159], v[112:127]
    ds_read_b64_tr_b16 a[128:129], v44 offset:2048
    ds_read_b64_tr_b16 a[130:131], v44 offset:3072
    buffer_load_dwordx4 v[200:203], v1, s[28:31], s81 offen offset:2048 sc1
    v_mfma_f32_32x32x16_bf16 v[96:111], a[248:251], v[160:163], v[96:111]
    v_mfma_f32_32x32x16_bf16 v[112:127], a[252:255], v[160:163], v[112:127]
    ds_read_b64_tr_b16 a[132:133], v45 offset:2048
    ds_read_b64_tr_b16 a[134:135], v45 offset:3072
    buffer_load_dwordx4 v[204:207], v1, s[28:31], s81 offen offset:3072 sc1
    v_mfma_f32_32x32x16_bf16 v[96:111], a[0:3], v[164:167], v[96:111]
    v_mfma_f32_32x32x16_bf16 v[112:127], a[4:7], v[164:167], v[112:127]
    ds_read_b64_tr_b16 a[136:137], v44 offset:4096
    ds_read_b64_tr_b16 a[138:139], v44 offset:5120
    s_add_u32 s81, s41, 20480
    buffer_load_dwordx4 v[208:211], v1, s[28:31], s81 offen offset:0 sc1
    s_waitcnt vmcnt(10)
    v_mfma_f32_32x32x16_bf16 v[96:111], a[8:11], v[168:171], v[96:111]
    v_mfma_f32_32x32x16_bf16 v[112:127], a[12:15], v[168:171], v[112:127]
    ds_read_b64_tr_b16 a[140:141], v45 offset:4096
    ds_read_b64_tr_b16 a[142:143], v45 offset:5120
    buffer_load_dwordx4 v[212:215], v1, s[28:31], s81 offen offset:1024 sc1
    s_waitcnt vmcnt(10)
    v_mfma_f32_32x32x16_bf16 v[96:111], a[16:19], v[172:175], v[96:111]
    v_mfma_f32_32x32x16_bf16 v[112:127], a[20:23], v[172:175], v[112:127]
    ds_read_b64_tr_b16 a[144:145], v44 offset:6144
    ds_read_b64_tr_b16 a[146:147], v44 offset:7168
    buffer_load_dwordx4 v[216:219], v1, s[28:31], s81 offen offset:2048 sc1
    s_waitcnt vmcnt(10)
    v_mfma_f32_32x32x16_bf16 v[96:111], a[24:27], v[176:179], v[96:111]
    v_mfma_f32_32x32x16_bf16 v[112:127], a[28:31], v[176:179], v[112:127]
    ds_read_b64_tr_b16 a[148:149], v45 offset:6144
    ds_read_b64_tr_b16 a[150:151], v45 offset:7168
    buffer_load_dwordx4 v[220:223], v1, s[28:31], s81 offen offset:3072 sc1
    s_waitcnt vmcnt(10)
    v_mfma_f32_32x32x16_bf16 v[96:111], a[32:35], v[180:183], v[96:111]
    v_mfma_f32_32x32x16_bf16 v[112:127], a[36:39], v[180:183], v[112:127]
    s_add_u32 s81, s41, 24576
    buffer_load_dwordx4 v[224:227], v1, s[28:31], s81 offen offset:0 sc1
    s_waitcnt vmcnt(10)
    v_mfma_f32_32x32x16_bf16 v[96:111], a[40:43], v[184:187], v[96:111]
    v_mfma_f32_32x32x16_bf16 v[112:127], a[44:47], v[184:187], v[112:127]
    buffer_load_dwordx4 v[228:231], v1, s[28:31], s81 offen offset:1024 sc1
    s_waitcnt vmcnt(10)
    v_mfma_f32_32x32x16_bf16 v[96:111], a[48:51], v[188:191], v[96:111]
    v_mfma_f32_32x32x16_bf16 v[112:127], a[52:55], v[188:191], v[112:127]
    buffer_load_dwordx4 v[232:235], v1, s[28:31], s81 offen offset:2048 sc1
    s_waitcnt vmcnt(10)
    v_mfma_f32_32x32x16_bf16 v[96:111], a[56:59], v[192:195], v[96:111]
    v_mfma_f32_32x32x16_bf16 v[112:127], a[60:63], v[192:195], v[112:127]
    buffer_load_dwordx4 v[236:239], v1, s[28:31], s81 offen offset:3072 sc1
    v_and_b32 v5, -13, v9
    v_lshlrev_b32 v5, 5, v5
    s_lshl_b32 s84, s40, 5
    s_add_u32 s84, s84, 16777216
    buffer_load_dword v8, v5, s[28:31], s84 offen sc1
    s_waitcnt vmcnt(11) lgkmcnt(15)
    v_mfma_f32_32x32x16_bf16 v[96:111], a[64:67], v[196:199], v[96:111]
    v_mfma_f32_32x32x16_bf16 v[112:127], a[68:71], v[196:199], v[112:127]
    v_lshlrev_b32 v48, 16, v36
    v_and_b32 v49, 0xffff0000, v36
    v_lshlrev_b32 v50, 16, v37
    s_waitcnt vmcnt(10)
    v_mfma_f32_32x32x16_bf16 v[96:111], a[72:75], v[200:203], v[96:111]
    v_mfma_f32_32x32x16_bf16 v[112:127], a[76:79], v[200:203], v[112:127]
    v_and_b32 v51, 0xffff0000, v37
    v_lshlrev_b32 v52, 16, v38
    v_and_b32 v53, 0xffff0000, v38
    s_waitcnt vmcnt(9)
    v_mfma_f32_32x32x16_bf16 v[96:111], a[80:83], v[204:207], v[96:111]
    v_mfma_f32_32x32x16_bf16 v[112:127], a[84:87], v[204:207], v[112:127]
    v_lshlrev_b32 v54, 16, v39
    v_and_b32 v55, 0xffff0000, v39
    v_lshlrev_b32 v56, 16, v28
    s_waitcnt vmcnt(8)
    v_mfma_f32_32x32x16_bf16 v[96:111], a[88:91], v[208:211], v[96:111]
    v_mfma_f32_32x32x16_bf16 v[112:127], a[92:95], v[208:211], v[112:127]
    v_and_b32 v57, 0xffff0000, v28
    v_lshlrev_b32 v58, 16, v29
    v_and_b32 v59, 0xffff0000, v29
    s_waitcnt vmcnt(7)
    v_mfma_f32_32x32x16_bf16 v[96:111], a[96:99], v[212:215], v[96:111]
    v_mfma_f32_32x32x16_bf16 v[112:127], a[100:103], v[212:215], v[112:127]
    v_lshlrev_b32 v60, 16, v30
    v_and_b32 v61, 0xffff0000, v30
    v_lshlrev_b32 v62, 16, v31
    s_waitcnt vmcnt(6)
    v_mfma_f32_32x32x16_bf16 v[96:111], a[104:107], v[216:219], v[96:111]
    v_mfma_f32_32x32x16_bf16 v[112:127], a[108:111], v[216:219], v[112:127]
    v_and_b32 v63, 0xffff0000, v31
    v_add_f32 v48, v48, v56
    v_add_f32 v49, v49, v57
    s_waitcnt vmcnt(0)
    v_cmp_ne_u32 vcc, s70, v8
    s_nop 0
    s_cbranch_vccnz L_retry_39
L_back_40:
    s_add_u32 s81, s41, 114688
    buffer_load_dwordx4 v[128:131], v1, s[28:31], s81 offen offset:0 sc1
    buffer_load_dwordx4 v[132:135], v1, s[28:31], s81 offen offset:1024 sc1
    v_mfma_f32_32x32x16_bf16 v[96:111], a[112:115], v[220:223], v[96:111]
    v_mfma_f32_32x32x16_bf16 v[112:127], a[116:119], v[220:223], v[112:127]
    v_add_f32 v50, v50, v58
    v_add_f32 v51, v51, v59
    v_add_f32 v52, v52, v60
    buffer_load_dwordx4 v[136:139], v1, s[28:31], s81 offen offset:2048 sc1
    buffer_load_dwordx4 v[140:143], v1, s[28:31], s81 offen offset:3072 sc1
    s_waitcnt lgkmcnt(14)
    v_mfma_f32_32x32x16_bf16 v[96:111], a[120:123], v[224:227], v[96:111]
    s_waitcnt lgkmcnt(12)
    v_mfma_f32_32x32x16_bf16 v[112:127], a[124:127], v[224:227], v[112:127]
    v_add_f32 v53, v53, v61
    v_add_f32 v54, v54, v62
    v_add_f32 v55, v55, v63
    s_add_u32 s81, s41, 118784
    buffer_load_dwordx4 v[144:147], v1, s[28:31], s81 offen offset:0 sc1
    buffer_load_dwordx4 v[148:151], v1, s[28:31], s81 offen offset:1024 sc1
    s_waitcnt lgkmcnt(10)
    v_mfma_f32_32x32x16_bf16 v[96:111], a[128:131], v[228:231], v[96:111]
    s_waitcnt lgkmcnt(8)
    v_mfma_f32_32x32x16_bf16 v[112:127], a[132:135], v[228:231], v[112:127]
    buffer_load_dwordx4 v[152:155], v1, s[28:31], s81 offen offset:2048 sc1
    buffer_load_dwordx4 v[156:159], v1, s[28:31], s81 offen offset:3072 sc1
    s_waitcnt lgkmcnt(6)
    v_mfma_f32_32x32x16_bf16 v[96:111], a[136:139], v[232:235], v[96:111]
    s_waitcnt lgkmcnt(4)
    v_mfma_f32_32x32x16_bf16 v[112:127], a[140:143], v[232:235], v[112:127]
    s_add_u32 s81, s41, 122880
    buffer_load_dwordx4 v[160:163], v1, s[28:31], s81 offen offset:0 sc1
    buffer_load_dwordx4 v[164:167], v1, s[28:31], s81 offen offset:1024 sc1
    s_waitcnt lgkmcnt(2)
    v_mfma_f32_32x32x16_bf16 v[96:111], a[144:147], v[236:239], v[96:111]
    s_waitcnt lgkmcnt(0)
    v_mfma_f32_32x32x16_bf16 v[112:127], a[148:151], v[236:239], v[112:127]
    buffer_load_dwordx4 v[168:171], v1, s[28:31], s81 offen offset:2048 sc1
    buffer_load_dwordx4 v[172:175], v1, s[28:31], s81 offen offset:3072 sc1
    s_barrier
    s_nop 6
    ds_write_b128 v20, v[96:99] offset:0
    ds_write_b128 v21, v[100:103] offset:0
    ds_write_b128 v22, v[104:107] offset:0
    ds_write_b128 v23, v[108:111] offset:0
    ds_write_b128 v20, v[112:115] offset:128
    ds_write_b128 v21, v[116:119] offset:128
    ds_write_b128 v22, v[120:123] offset:128
    ds_write_b128 v23, v[124:127] offset:128
    s_add_u32 s81, s41, 126976
    buffer_load_dwordx4 v[176:179], v1, s[28:31], s81 offen offset:0 sc1
    s_waitcnt vmcnt(12)
    v_mfma_f32_32x32x16_bf16 a[152:167], a[184:187], v[128:131], 0
    v_mfma_f32_32x32x16_bf16 a[168:183], a[188:191], v[128:131], 0
    s_waitcnt lgkmcnt(0)
    s_barrier
    ds_read_b128 v[64:67], v18 offset:0
    ds_read_b128 v[68:71], v19 offset:0
    buffer_load_dwordx4 v[180:183], v1, s[28:31], s81 offen offset:1024 sc1
    s_waitcnt vmcnt(12)
    v_mfma_f32_32x32x16_bf16 a[152:167], a[192:195], v[132:135], a[152:167]
    v_mfma_f32_32x32x16_bf16 a[168:183], a[196:199], v[132:135], a[168:183]
    ds_read_b128 v[72:75], v18 offset:8192
    ds_read_b128 v[76:79], v19 offset:8192
    ds_read_b128 v[80:83], v18 offset:16384
    ds_read_b128 v[84:87], v19 offset:16384
    buffer_load_dwordx4 v[184:187], v1, s[28:31], s81 offen offset:2048 sc1
    s_waitcnt vmcnt(12)
    v_mfma_f32_32x32x16_bf16 a[152:167], a[200:203], v[136:139], a[152:167]
    v_mfma_f32_32x32x16_bf16 a[168:183], a[204:207], v[136:139], a[168:183]
    ds_read_b128 v[88:91], v18 offset:24576
    ds_read_b128 v[92:95], v19 offset:24576
    s_waitcnt lgkmcnt(5)
    v_add_f32 v64, v64, v72
    buffer_load_dwordx4 v[188:191], v1, s[28:31], s81 offen offset:3072 sc1
    s_waitcnt vmcnt(12)
    v_mfma_f32_32x32x16_bf16 a[152:167], a[208:211], v[140:143], a[152:167]
    v_mfma_f32_32x32x16_bf16 a[168:183], a[212:215], v[140:143], a[168:183]
    v_add_f32 v65, v65, v73
    v_add_f32 v66, v66, v74
    v_add_f32 v67, v67, v75
    s_add_u32 s81, s41, 131072
    buffer_load_dwordx4 v[192:195], v1, s[28:31], s81 offen offset:0 sc1
    s_waitcnt vmcnt(12)
    v_mfma_f32_32x32x16_bf16 a[152:167], a[216:219], v[144:147], a[152:167]
    v_mfma_f32_32x32x16_bf16 a[168:183], a[220:223], v[144:147], a[168:183]
    s_waitcnt lgkmcnt(4)
    v_add_f32 v68, v68, v76
    v_add_f32 v69, v69, v77
    v_add_f32 v70, v70, v78
    v_add_f32 v71, v71, v79
    buffer_load_dwordx4 v[196:199], v1, s[28:31], s81 offen offset:1024 sc1
    s_waitcnt vmcnt(12)
    v_mfma_f32_32x32x16_bf16 a[152:167], a[224:227], v[148:151], a[152:167]
    v_mfma_f32_32x32x16_bf16 a[168:183], a[228:231], v[148:151], a[168:183]
    s_waitcnt lgkmcnt(1)
    v_add_f32 v80, v80, v88
    v_add_f32 v81, v81, v89
    v_add_f32 v82, v82, v90
    buffer_load_dwordx4 v[200:203], v1, s[28:31], s81 offen offset:2048 sc1
    s_waitcnt vmcnt(12)
    v_mfma_f32_32x32x16_bf16 a[152:167], a[232:235], v[152:155], a[152:167]
    v_mfma_f32_32x32x16_bf16 a[168:183], a[236:239], v[152:155], a[168:183]
    v_add_f32 v83, v83, v91
    s_waitcnt lgkmcnt(0)
    v_add_f32 v84, v84, v92
    v_add_f32 v85, v85, v93
    v_add_f32 v86, v86, v94
    buffer_load_dwordx4 v[204:207], v1, s[28:31], s81 offen offset:3072 sc1
    s_waitcnt vmcnt(12)
    v_mfma_f32_32x32x16_bf16 a[152:167], a[240:243], v[156:159], a[152:167]
    v_mfma_f32_32x32x16_bf16 a[168:183], a[244:247], v[156:159], a[168:183]
    v_add_f32 v87, v87, v95
    v_add_f32 v64, v64, v80
    v_add_f32 v65, v65, v81
    s_add_u32 s81, s41, 135168
    buffer_load_dwordx4 v[208:211], v1, s[28:31], s81 offen offset:0 sc1
    s_waitcnt vmcnt(12)
    v_mfma_f32_32x32x16_bf16 a[152:167], a[248:251], v[160:163], a[152:167]
    v_mfma_f32_32x32x16_bf16 a[168:183], a[252:255], v[160:163], a[168:183]
    v_add_f32 v66, v66, v82
    v_add_f32 v67, v67, v83
    v_add_f32 v68, v68, v84
    buffer_load_dwordx4 v[212:215], v1, s[28:31], s81 offen offset:1024 sc1
    s_waitcnt vmcnt(12)
    v_mfma_f32_32x32x16_bf16 a[152:167], a[0:3], v[164:167], a[152:167]
    v_mfma_f32_32x32x16_bf16 a[168:183], a[4:7], v[164:167], a[168:183]
    v_add_f32 v69, v69, v85
    v_add_f32 v70, v70, v86
    v_add_f32 v71, v71, v87
    v_add_f32 v64, v64, v48
    buffer_load_dwordx4 v[216:219], v1, s[28:31], s81 offen offset:2048 sc1
    s_waitcnt vmcnt(12)
    v_mfma_f32_32x32x16_bf16 a[152:167], a[8:11], v[168:171], a[152:167]
    v_mfma_f32_32x32x16_bf16 a[168:183], a[12:15], v[168:171], a[168:183]
    v_add_f32 v65, v65, v49
    v_add_f32 v66, v66, v50
    v_add_f32 v67, v67, v51
    buffer_load_dwordx4 v[220:223], v1, s[28:31], s81 offen offset:3072 sc1
    s_waitcnt vmcnt(12)
    v_mfma_f32_32x32x16_bf16 a[152:167], a[16:19], v[172:175], a[152:167]
    v_mfma_f32_32x32x16_bf16 a[168:183], a[20:23], v[172:175], a[168:183]
    v_add_f32 v68, v68, v52
    v_add_f32 v69, v69, v53
    v_add_f32 v70, v70, v54
    s_add_u32 s81, s41, 139264
    buffer_load_dwordx4 v[224:227], v1, s[28:31], s81 offen offset:0 sc1
    s_waitcnt vmcnt(12)
    v_mfma_f32_32x32x16_bf16 a[152:167], a[24:27], v[176:179], a[152:167]
    v_mfma_f32_32x32x16_bf16 a[168:183], a[28:31], v[176:179], a[168:183]
    v_add_f32 v71, v71, v55
    s_add_u32 s78, s44, 0
    v_cvt_pk_bf16_f32 v80, v64, v65
    v_cvt_pk_bf16_f32 v81, v66, v67
    buffer_load_dwordx4 v[228:231], v1, s[28:31], s81 offen offset:1024 sc1
    s_waitcnt vmcnt(12)
    v_mfma_f32_32x32x16_bf16 a[152:167], a[32:35], v[180:183], a[152:167]
    v_mfma_f32_32x32x16_bf16 a[168:183], a[36:39], v[180:183], a[168:183]
    v_cvt_pk_bf16_f32 v82, v68, v69
    v_cvt_pk_bf16_f32 v83, v70, v71
    buffer_store_dwordx4 v[80:83], v17, s[24:27], s78 offen sc1
    buffer_load_dwordx4 v[232:235], v1, s[28:31], s81 offen offset:2048 sc1
    buffer_load_dwordx4 v[236:239], v1, s[28:31], s81 offen offset:3072 sc1
    s_waitcnt vmcnt(14)
    v_mfma_f32_32x32x16_bf16 a[152:167], a[40:43], v[184:187], a[152:167]
    v_mfma_f32_32x32x16_bf16 a[168:183], a[44:47], v[184:187], a[168:183]
    v_lshlrev_b32 v48, 16, v36
    v_and_b32 v49, 0xffff0000, v36
    v_lshlrev_b32 v50, 16, v37
    s_waitcnt vmcnt(13)
    v_mfma_f32_32x32x16_bf16 a[152:167], a[48:51], v[188:191], a[152:167]
    v_mfma_f32_32x32x16_bf16 a[168:183], a[52:55], v[188:191], a[168:183]
    v_and_b32 v51, 0xffff0000, v37
    v_lshlrev_b32 v52, 16, v38
    v_and_b32 v53, 0xffff0000, v38
    s_waitcnt vmcnt(12)
    v_mfma_f32_32x32x16_bf16 a[152:167], a[56:59], v[192:195], a[152:167]
    v_mfma_f32_32x32x16_bf16 a[168:183], a[60:63], v[192:195], a[168:183]
    v_lshlrev_b32 v54, 16, v39
    v_and_b32 v55, 0xffff0000, v39
    v_lshlrev_b32 v56, 16, v32
    s_waitcnt vmcnt(11)
    v_mfma_f32_32x32x16_bf16 a[152:167], a[64:67], v[196:199], a[152:167]
    v_mfma_f32_32x32x16_bf16 a[168:183], a[68:71], v[196:199], a[168:183]
    v_and_b32 v57, 0xffff0000, v32
    v_lshlrev_b32 v58, 16, v33
    v_and_b32 v59, 0xffff0000, v33
    s_waitcnt vmcnt(10)
    v_mfma_f32_32x32x16_bf16 a[152:167], a[72:75], v[200:203], a[152:167]
    v_mfma_f32_32x32x16_bf16 a[168:183], a[76:79], v[200:203], a[168:183]
    v_lshlrev_b32 v60, 16, v34
    v_and_b32 v61, 0xffff0000, v34
    v_lshlrev_b32 v62, 16, v35
    s_waitcnt vmcnt(9)
    v_mfma_f32_32x32x16_bf16 a[152:167], a[80:83], v[204:207], a[152:167]
    v_mfma_f32_32x32x16_bf16 a[168:183], a[84:87], v[204:207], a[168:183]
    v_and_b32 v63, 0xffff0000, v35
    v_add_f32 v48, v48, v56
    v_add_f32 v49, v49, v57
    s_waitcnt vmcnt(8)
    v_mfma_f32_32x32x16_bf16 a[152:167], a[88:91], v[208:211], a[152:167]
    v_mfma_f32_32x32x16_bf16 a[168:183], a[92:95], v[208:211], a[168:183]
    v_add_f32 v50, v50, v58
    v_add_f32 v51, v51, v59
    v_add_f32 v52, v52, v60
    s_waitcnt vmcnt(7)
    v_mfma_f32_32x32x16_bf16 a[152:167], a[96:99], v[212:215], a[152:167]
    v_mfma_f32_32x32x16_bf16 a[168:183], a[100:103], v[212:215], a[168:183]
    v_add_f32 v53, v53, v61
    v_add_f32 v54, v54, v62
    v_add_f32 v55, v55, v63
    s_waitcnt vmcnt(6)
    v_mfma_f32_32x32x16_bf16 a[152:167], a[104:107], v[216:219], a[152:167]
    s_waitcnt vmcnt(5)
    v_mfma_f32_32x32x16_bf16 a[152:167], a[112:115], v[220:223], a[152:167]
    s_waitcnt vmcnt(4)
    v_mfma_f32_32x32x16_bf16 a[152:167], a[120:123], v[224:227], a[152:167]
    s_waitcnt vmcnt(3)
    v_mfma_f32_32x32x16_bf16 a[152:167], a[128:131], v[228:231], a[152:167]
    s_waitcnt vmcnt(1)
    v_mfma_f32_32x32x16_bf16 a[152:167], a[136:139], v[232:235], a[152:167]
    s_waitcnt vmcnt(0)
    v_mfma_f32_32x32x16_bf16 a[152:167], a[144:147], v[236:239], a[152:167]
    v_mfma_f32_32x32x16_bf16 a[168:183], a[108:111], v[216:219], a[168:183]
    v_mfma_f32_32x32x16_bf16 a[168:183], a[116:119], v[220:223], a[168:183]
    v_mfma_f32_32x32x16_bf16 a[168:183], a[124:127], v[224:227], a[168:183]
    s_nop 8
    ds_write_b128 v20, a[152:155] offset:32768
    v_mfma_f32_32x32x16_bf16 a[168:183], a[132:135], v[228:231], a[168:183]
    ds_write_b128 v21, a[156:159] offset:32768
    v_mfma_f32_32x32x16_bf16 a[168:183], a[140:143], v[232:235], a[168:183]
    ds_write_b128 v22, a[160:163] offset:32768
    v_mfma_f32_32x32x16_bf16 a[168:183], a[148:151], v[236:239], a[168:183]
    ds_write_b128 v23, a[164:167] offset:32768
    s_nop 10
    ds_write_b128 v20, a[168:171] offset:32896
    ds_write_b128 v21, a[172:175] offset:32896
    ds_write_b128 v22, a[176:179] offset:32896
    ds_write_b128 v23, a[180:183] offset:32896
    s_waitcnt lgkmcnt(0)
    s_barrier
    ds_read_b128 v[64:67], v18 offset:32768
    ds_read_b128 v[68:71], v19 offset:32768
    ds_read_b128 v[72:75], v18 offset:40960
    ds_read_b128 v[76:79], v19 offset:40960
    ds_read_b128 v[80:83], v18 offset:49152
    ds_read_b128 v[84:87], v19 offset:49152
    ds_read_b128 v[88:91], v18 offset:57344
    ds_read_b128 v[92:95], v19 offset:57344
    s_waitcnt lgkmcnt(5)
    v_add_f32 v64, v64, v72
    v_add_f32 v65, v65, v73
    v_add_f32 v66, v66, v74
    v_add_f32 v67, v67, v75
    s_waitcnt lgkmcnt(4)
    v_add_f32 v68, v68, v76
    v_add_f32 v69, v69, v77
    v_add_f32 v70, v70, v78
    v_add_f32 v71, v71, v79
    s_waitcnt lgkmcnt(1)
    v_add_f32 v80, v80, v88
    v_add_f32 v81, v81, v89
    v_add_f32 v82, v82, v90
    v_add_f32 v83, v83, v91
    s_waitcnt lgkmcnt(0)
    v_add_f32 v84, v84, v92
    v_add_f32 v85, v85, v93
    v_add_f32 v86, v86, v94
    v_add_f32 v87, v87, v95
    v_add_f32 v64, v64, v80
    v_add_f32 v65, v65, v81
    v_add_f32 v66, v66, v82
    v_add_f32 v67, v67, v83
    v_add_f32 v68, v68, v84
    v_add_f32 v69, v69, v85
    v_add_f32 v70, v70, v86
    v_add_f32 v71, v71, v87
    v_add_f32 v64, v64, v48
    v_add_f32 v65, v65, v49
    v_add_f32 v66, v66, v50
    v_add_f32 v67, v67, v51
    v_add_f32 v68, v68, v52
    v_add_f32 v69, v69, v53
    v_add_f32 v70, v70, v54
    v_add_f32 v71, v71, v55
    s_add_u32 s78, s44, 32768
    v_cvt_pk_bf16_f32 v80, v64, v65
    v_cvt_pk_bf16_f32 v81, v66, v67
    v_cvt_pk_bf16_f32 v82, v68, v69
    v_cvt_pk_bf16_f32 v83, v70, v71
    buffer_store_dwordx4 v[80:83], v17, s[24:27], s78 offen
L_end:
    s_endpgm
L_tagretry:
    s_mov_b32 s71, 0
L_tagretry_l:
    buffer_load_dword v7, v6, s[92:95], 0 offen sc1
    s_add_u32 s71, s71, 1
    s_waitcnt vmcnt(0)
    v_readfirstlane_b32 s70, v7
    s_cmp_gt_u32 s71, 65536
    s_cbranch_scc1 L_tagok
    s_cmp_eq_u32 s70, 0
    s_cbranch_scc1 L_tagretry_l
    s_branch L_tagok
L_retry_2:
    s_mov_b32 s71, 0
L_retry_2_l:
    buffer_load_dword v8, v5, s[28:31], s84 offen sc1
    s_add_u32 s71, s71, 1
    s_waitcnt vmcnt(0)
    v_cmp_ne_u32 vcc, s70, v8
    s_cmp_gt_u32 s71, 65536
    s_cbranch_scc1 L_back_3
    s_cbranch_vccnz L_retry_2_l
    s_branch L_back_3
L_exact_4:
    v_mfma_f32_32x32x16_bf16 v[104:119], a[32:35], v[64:67], v[224:239]
    s_nop 11
    v_max3_f32 v200, v104, v105, v106
    v_max3_f32 v201, v107, v108, v109
    v_max3_f32 v200, v110, v111, v200
    v_max3_f32 v201, v112, v113, v201
    v_max3_f32 v200, v114, v115, v200
    v_max3_f32 v201, v116, v117, v201
    v_max3_f32 v200, v118, v119, v200
    v_mfma_f32_32x32x16_bf16 v[104:119], a[28:31], v[64:67], 0
    s_nop 11
    v_max3_f32 v200, v104, v105, v200
    v_max3_f32 v201, v106, v107, v201
    v_max3_f32 v200, v108, v109, v200
    v_max3_f32 v201, v110, v111, v201
    v_max3_f32 v200, v112, v113, v200
    v_max3_f32 v201, v114, v115, v201
    v_max3_f32 v200, v116, v117, v200
    v_max3_f32 v201, v118, v119, v201
    v_mfma_f32_32x32x16_bf16 v[104:119], a[24:27], v[64:67], 0
    s_nop 11
    v_max3_f32 v200, v104, v105, v200
    v_max3_f32 v201, v106, v107, v201
    v_max3_f32 v200, v108, v109, v200
    v_max3_f32 v201, v110, v111, v201
    v_max3_f32 v200, v112, v113, v200
    v_max3_f32 v201, v114, v115, v201
    v_max3_f32 v200, v116, v117, v200
    v_max3_f32 v201, v118, v119, v201
    v_mfma_f32_32x32x16_bf16 v[104:119], a[20:23], v[64:67], 0
    s_nop 11
    v_max3_f32 v200, v104, v105, v200
    v_max3_f32 v201, v106, v107, v201
    v_max3_f32 v200, v108, v109, v200
    v_max3_f32 v201, v110, v111, v201
    v_max3_f32 v200, v112, v113, v200
    v_max3_f32 v201, v114, v115, v201
    v_max3_f32 v200, v116, v117, v200
    v_max3_f32 v201, v118, v119, v201
    v_mfma_f32_32x32x16_bf16 v[104:119], a[16:19], v[64:67], 0
    s_nop 11
    v_max3_f32 v200, v104, v105, v200
    v_max3_f32 v201, v106, v107, v201
    v_max3_f32 v200, v108, v109, v200
    v_max3_f32 v201, v110, v111, v201
    v_max3_f32 v200, v112, v113, v200
    v_max3_f32 v201, v114, v115, v201
    v_max3_f32 v200, v116, v117, v200
    v_max3_f32 v201, v118, v119, v201
    v_mfma_f32_32x32x16_bf16 v[104:119], a[12:15], v[64:67], 0
    s_nop 11
    v_max3_f32 v200, v104, v105, v200
    v_max3_f32 v201, v106, v107, v201
    v_max3_f32 v200, v108, v109, v200
    v_max3_f32 v201, v110, v111, v201
    v_max3_f32 v200, v112, v113, v200
    v_max3_f32 v201, v114, v115, v201
    v_max3_f32 v200, v116, v117, v200
    v_max3_f32 v201, v118, v119, v201
    v_mfma_f32_32x32x16_bf16 v[104:119], a[8:11], v[64:67], 0
    s_nop 11
    v_max3_f32 v200, v104, v105, v200
    v_max3_f32 v201, v106, v107, v201
    v_max3_f32 v200, v108, v109, v200
    v_max3_f32 v201, v110, v111, v201
    v_max3_f32 v200, v112, v113, v200
    v_max3_f32 v201, v114, v115, v201
    v_max3_f32 v200, v116, v117, v200
    v_max3_f32 v201, v118, v119, v201
    v_mfma_f32_32x32x16_bf16 v[104:119], a[4:7], v[64:67], 0
    s_nop 11
    v_max3_f32 v200, v104, v105, v200
    v_max3_f32 v201, v106, v107, v201
    v_max3_f32 v200, v108, v109, v200
    v_max3_f32 v201, v110, v111, v201
    v_max3_f32 v200, v112, v113, v200
    v_max3_f32 v201, v114, v115, v201
    v_max3_f32 v200, v116, v117, v200
    v_max3_f32 v201, v118, v119, v201
    v_mfma_f32_32x32x16_bf16 v[104:119], a[0:3], v[64:67], v[240:255]
    s_nop 11
    v_max3_f32 v200, v104, v105, v200
    v_max3_f32 v201, v106, v107, v201
    v_max3_f32 v200, v108, v109, v200
    v_max3_f32 v201, v110, v111, v201
    v_max3_f32 v200, v112, v113, v200
    v_max3_f32 v201, v114, v115, v201
    v_max3_f32 v200, v116, v117, v200
    v_max3_f32 v201, v118, v119, v201
    v_max_f32 v200, v200, v201
    v_mov_b32 v201, v200
    s_nop 1
    v_permlane32_swap_b32 v200, v201
    v_max_f32 v200, v200, v201
    v_cvt_pk_bf16_f32 v216, -v200, 0
    s_nop 1
    v_mfma_f32_32x32x16_bf16 v[120:135], v[212:215], v[216:219], 0
    v_mfma_f32_32x32x16_bf16 v[104:119], v[212:215], v[216:219], v[224:239]
    v_mfma_f32_32x32x16_bf16 v[104:119], a[32:35], v[64:67], v[104:119]
    s_nop 11
    v_exp_f32 v104, v104
    v_exp_f32 v105, v105
    v_exp_f32 v106, v106
    v_exp_f32 v107, v107
    v_exp_f32 v108, v108
    v_exp_f32 v109, v109
    v_exp_f32 v110, v110
    v_exp_f32 v111, v111
    v_exp_f32 v112, v112
    v_exp_f32 v113, v113
    v_exp_f32 v114, v114
    v_exp_f32 v115, v115
    v_exp_f32 v116, v116
    v_exp_f32 v117, v117
    v_exp_f32 v118, v118
    v_exp_f32 v119, v119
    v_cvt_pk_bf16_f32 v192, v104, v105
    v_cvt_pk_bf16_f32 v193, v106, v107
    v_cvt_pk_bf16_f32 v194, v108, v109
    v_cvt_pk_bf16_f32 v195, v110, v111
    v_cvt_pk_bf16_f32 v196, v112, v113
    v_cvt_pk_bf16_f32 v197, v114, v115
    v_cvt_pk_bf16_f32 v198, v116, v117
    v_cvt_pk_bf16_f32 v199, v118, v119
    v_mfma_f32_32x32x16_bf16 v[160:175], a[104:107], v[192:195], 0
    s_nop 0
    v_mfma_f32_32x32x16_bf16 v[160:175], a[108:111], v[196:199], v[160:175]
    v_mfma_f32_32x32x16_bf16 v[104:119], a[28:31], v[64:67], v[120:135]
    s_nop 11
    v_exp_f32 v104, v104
    v_exp_f32 v105, v105
    v_exp_f32 v106, v106
    v_exp_f32 v107, v107
    v_exp_f32 v108, v108
    v_exp_f32 v109, v109
    v_exp_f32 v110, v110
    v_exp_f32 v111, v111
    v_exp_f32 v112, v112
    v_exp_f32 v113, v113
    v_exp_f32 v114, v114
    v_exp_f32 v115, v115
    v_exp_f32 v116, v116
    v_exp_f32 v117, v117
    v_exp_f32 v118, v118
    v_exp_f32 v119, v119
    v_cvt_pk_bf16_f32 v192, v104, v105
    v_cvt_pk_bf16_f32 v193, v106, v107
    v_cvt_pk_bf16_f32 v194, v108, v109
    v_cvt_pk_bf16_f32 v195, v110, v111
    v_cvt_pk_bf16_f32 v196, v112, v113
    v_cvt_pk_bf16_f32 v197, v114, v115
    v_cvt_pk_bf16_f32 v198, v116, v117
    v_cvt_pk_bf16_f32 v199, v118, v119
    v_mfma_f32_32x32x16_bf16 v[160:175], a[96:99], v[192:195], v[160:175]
    s_nop 0
    v_mfma_f32_32x32x16_bf16 v[160:175], a[100:103], v[196:199], v[160:175]
    v_mfma_f32_32x32x16_bf16 v[104:119], a[24:27], v[64:67], v[120:135]
    s_nop 11
    v_exp_f32 v104, v104
    v_exp_f32 v105, v105
    v_exp_f32 v106, v106
    v_exp_f32 v107, v107
    v_exp_f32 v108, v108
    v_exp_f32 v109, v109
    v_exp_f32 v110, v110
    v_exp_f32 v111, v111
    v_exp_f32 v112, v112
    v_exp_f32 v113, v113
    v_exp_f32 v114, v114
    v_exp_f32 v115, v115
    v_exp_f32 v116, v116
    v_exp_f32 v117, v117
    v_exp_f32 v118, v118
    v_exp_f32 v119, v119
    v_cvt_pk_bf16_f32 v192, v104, v105
    v_cvt_pk_bf16_f32 v193, v106, v107
    v_cvt_pk_bf16_f32 v194, v108, v109
    v_cvt_pk_bf16_f32 v195, v110, v111
    v_cvt_pk_bf16_f32 v196, v112, v113
    v_cvt_pk_bf16_f32 v197, v114, v115
    v_cvt_pk_bf16_f32 v198, v116, v117
    v_cvt_pk_bf16_f32 v199, v118, v119
    v_mfma_f32_32x32x16_bf16 v[160:175], a[88:91], v[192:195], v[160:175]
    s_nop 0
    v_mfma_f32_32x32x16_bf16 v[160:175], a[92:95], v[196:199], v[160:175]
    v_mfma_f32_32x32x16_bf16 v[104:119], a[20:23], v[64:67], v[120:135]
    s_nop 11
    v_exp_f32 v104, v104
    v_exp_f32 v105, v105
    v_exp_f32 v106, v106
    v_exp_f32 v107, v107
    v_exp_f32 v108, v108
    v_exp_f32 v109, v109
    v_exp_f32 v110, v110
    v_exp_f32 v111, v111
    v_exp_f32 v112, v112
    v_exp_f32 v113, v113
    v_exp_f32 v114, v114
    v_exp_f32 v115, v115
    v_exp_f32 v116, v116
    v_exp_f32 v117, v117
    v_exp_f32 v118, v118
    v_exp_f32 v119, v119
    v_cvt_pk_bf16_f32 v192, v104, v105
    v_cvt_pk_bf16_f32 v193, v106, v107
    v_cvt_pk_bf16_f32 v194, v108, v109
    v_cvt_pk_bf16_f32 v195, v110, v111
    v_cvt_pk_bf16_f32 v196, v112, v113
    v_cvt_pk_bf16_f32 v197, v114, v115
    v_cvt_pk_bf16_f32 v198, v116, v117
    v_cvt_pk_bf16_f32 v199, v118, v119
    v_mfma_f32_32x32x16_bf16 v[160:175], a[80:83], v[192:195], v[160:175]
    s_nop 0
    v_mfma_f32_32x32x16_bf16 v[160:175], a[84:87], v[196:199], v[160:175]
    v_mfma_f32_32x32x16_bf16 v[104:119], a[16:19], v[64:67], v[120:135]
    s_nop 11
    v_exp_f32 v104, v104
    v_exp_f32 v105, v105
    v_exp_f32 v106, v106
    v_exp_f32 v107, v107
    v_exp_f32 v108, v108
    v_exp_f32 v109, v109
    v_exp_f32 v110, v110
    v_exp_f32 v111, v111
    v_exp_f32 v112, v112
    v_exp_f32 v113, v113
    v_exp_f32 v114, v114
    v_exp_f32 v115, v115
    v_exp_f32 v116, v116
    v_exp_f32 v117, v117
    v_exp_f32 v118, v118
    v_exp_f32 v119, v119
    v_cvt_pk_bf16_f32 v192, v104, v105
    v_cvt_pk_bf16_f32 v193, v106, v107
    v_cvt_pk_bf16_f32 v194, v108, v109
    v_cvt_pk_bf16_f32 v195, v110, v111
    v_cvt_pk_bf16_f32 v196, v112, v113
    v_cvt_pk_bf16_f32 v197, v114, v115
    v_cvt_pk_bf16_f32 v198, v116, v117
    v_cvt_pk_bf16_f32 v199, v118, v119
    v_mfma_f32_32x32x16_bf16 v[160:175], a[72:75], v[192:195], v[160:175]
    s_nop 0
    v_mfma_f32_32x32x16_bf16 v[160:175], a[76:79], v[196:199], v[160:175]
    v_mfma_f32_32x32x16_bf16 v[104:119], a[12:15], v[64:67], v[120:135]
    s_nop 11
    v_exp_f32 v104, v104
    v_exp_f32 v105, v105
    v_exp_f32 v106, v106
    v_exp_f32 v107, v107
    v_exp_f32 v108, v108
    v_exp_f32 v109, v109
    v_exp_f32 v110, v110
    v_exp_f32 v111, v111
    v_exp_f32 v112, v112
    v_exp_f32 v113, v113
    v_exp_f32 v114, v114
    v_exp_f32 v115, v115
    v_exp_f32 v116, v116
    v_exp_f32 v117, v117
    v_exp_f32 v118, v118
    v_exp_f32 v119, v119
    v_cvt_pk_bf16_f32 v192, v104, v105
    v_cvt_pk_bf16_f32 v193, v106, v107
    v_cvt_pk_bf16_f32 v194, v108, v109
    v_cvt_pk_bf16_f32 v195, v110, v111
    v_cvt_pk_bf16_f32 v196, v112, v113
    v_cvt_pk_bf16_f32 v197, v114, v115
    v_cvt_pk_bf16_f32 v198, v116, v117
    v_cvt_pk_bf16_f32 v199, v118, v119
    v_mfma_f32_32x32x16_bf16 v[160:175], a[64:67], v[192:195], v[160:175]
    s_nop 0
    v_mfma_f32_32x32x16_bf16 v[160:175], a[68:71], v[196:199], v[160:175]
    v_mfma_f32_32x32x16_bf16 v[104:119], a[8:11], v[64:67], v[120:135]
    s_nop 11
    v_exp_f32 v104, v104
    v_exp_f32 v105, v105
    v_exp_f32 v106, v106
    v_exp_f32 v107, v107
    v_exp_f32 v108, v108
    v_exp_f32 v109, v109
    v_exp_f32 v110, v110
    v_exp_f32 v111, v111
    v_exp_f32 v112, v112
    v_exp_f32 v113, v113
    v_exp_f32 v114, v114
    v_exp_f32 v115, v115
    v_exp_f32 v116, v116
    v_exp_f32 v117, v117
    v_exp_f32 v118, v118
    v_exp_f32 v119, v119
    v_cvt_pk_bf16_f32 v192, v104, v105
    v_cvt_pk_bf16_f32 v193, v106, v107
    v_cvt_pk_bf16_f32 v194, v108, v109
    v_cvt_pk_bf16_f32 v195, v110, v111
    v_cvt_pk_bf16_f32 v196, v112, v113
    v_cvt_pk_bf16_f32 v197, v114, v115
    v_cvt_pk_bf16_f32 v198, v116, v117
    v_cvt_pk_bf16_f32 v199, v118, v119
    v_mfma_f32_32x32x16_bf16 v[160:175], a[56:59], v[192:195], v[160:175]
    s_nop 0
    v_mfma_f32_32x32x16_bf16 v[160:175], a[60:63], v[196:199], v[160:175]
    v_mfma_f32_32x32x16_bf16 v[104:119], a[4:7], v[64:67], v[120:135]
    s_nop 11
    v_exp_f32 v104, v104
    v_exp_f32 v105, v105
    v_exp_f32 v106, v106
    v_exp_f32 v107, v107
    v_exp_f32 v108, v108
    v_exp_f32 v109, v109
    v_exp_f32 v110, v110
    v_exp_f32 v111, v111
    v_exp_f32 v112, v112
    v_exp_f32 v113, v113
    v_exp_f32 v114, v114
    v_exp_f32 v115, v115
    v_exp_f32 v116, v116
    v_exp_f32 v117, v117
    v_exp_f32 v118, v118
    v_exp_f32 v119, v119
    v_cvt_pk_bf16_f32 v192, v104, v105
    v_cvt_pk_bf16_f32 v193, v106, v107
    v_cvt_pk_bf16_f32 v194, v108, v109
    v_cvt_pk_bf16_f32 v195, v110, v111
    v_cvt_pk_bf16_f32 v196, v112, v113
    v_cvt_pk_bf16_f32 v197, v114, v115
    v_cvt_pk_bf16_f32 v198, v116, v117
    v_cvt_pk_bf16_f32 v199, v118, v119
    v_mfma_f32_32x32x16_bf16 v[160:175], a[48:51], v[192:195], v[160:175]
    s_nop 0
    v_mfma_f32_32x32x16_bf16 v[160:175], a[52:55], v[196:199], v[160:175]
    v_mfma_f32_32x32x16_bf16 v[104:119], v[212:215], v[216:219], v[240:255]
    v_mfma_f32_32x32x16_bf16 v[104:119], a[0:3], v[64:67], v[104:119]
    s_nop 11
    v_exp_f32 v104, v104
    v_exp_f32 v105, v105
    v_exp_f32 v106, v106
    v_exp_f32 v107, v107
    v_exp_f32 v108, v108
    v_exp_f32 v109, v109
    v_exp_f32 v110, v110
    v_exp_f32 v111, v111
    v_exp_f32 v112, v112
    v_exp_f32 v113, v113
    v_exp_f32 v114, v114
    v_exp_f32 v115, v115
    v_exp_f32 v116, v116
    v_exp_f32 v117, v117
    v_exp_f32 v118, v118
    v_exp_f32 v119, v119
    v_cvt_pk_bf16_f32 v192, v104, v105
    v_cvt_pk_bf16_f32 v193, v106, v107
    v_cvt_pk_bf16_f32 v194, v108, v109
    v_cvt_pk_bf16_f32 v195, v110, v111
    v_cvt_pk_bf16_f32 v196, v112, v113
    v_cvt_pk_bf16_f32 v197, v114, v115
    v_cvt_pk_bf16_f32 v198, v116, v117
    v_cvt_pk_bf16_f32 v199, v118, v119
    v_mfma_f32_32x32x16_bf16 v[160:175], a[40:43], v[192:195], v[160:175]
    s_nop 0
    v_mfma_f32_32x32x16_bf16 v[160:175], a[44:47], v[196:199], v[160:175]
    s_nop 15
    s_branch L_exact_4_back
L_exact_6:
    v_mfma_f32_32x32x16_bf16 v[104:119], a[36:39], v[68:71], v[224:239]
    s_nop 11
    v_max3_f32 v202, v104, v105, v106
    v_max3_f32 v203, v107, v108, v109
    v_max3_f32 v202, v110, v111, v202
    v_max3_f32 v203, v112, v113, v203
    v_max3_f32 v202, v114, v115, v202
    v_max3_f32 v203, v116, v117, v203
    v_max3_f32 v202, v118, v119, v202
    v_mfma_f32_32x32x16_bf16 v[104:119], a[32:35], v[68:71], 0
    s_nop 11
    v_max3_f32 v202, v104, v105, v202
    v_max3_f32 v203, v106, v107, v203
    v_max3_f32 v202, v108, v109, v202
    v_max3_f32 v203, v110, v111, v203
    v_max3_f32 v202, v112, v113, v202
    v_max3_f32 v203, v114, v115, v203
    v_max3_f32 v202, v116, v117, v202
    v_max3_f32 v203, v118, v119, v203
    v_mfma_f32_32x32x16_bf16 v[104:119], a[28:31], v[68:71], 0
    s_nop 11
    v_max3_f32 v202, v104, v105, v202
    v_max3_f32 v203, v106, v107, v203
    v_max3_f32 v202, v108, v109, v202
    v_max3_f32 v203, v110, v111, v203
    v_max3_f32 v202, v112, v113, v202
    v_max3_f32 v203, v114, v115, v203
    v_max3_f32 v202, v116, v117, v202
    v_max3_f32 v203, v118, v119, v203
    v_mfma_f32_32x32x16_bf16 v[104:119], a[24:27], v[68:71], 0
    s_nop 11
    v_max3_f32 v202, v104, v105, v202
    v_max3_f32 v203, v106, v107, v203
    v_max3_f32 v202, v108, v109, v202
    v_max3_f32 v203, v110, v111, v203
    v_max3_f32 v202, v112, v113, v202
    v_max3_f32 v203, v114, v115, v203
    v_max3_f32 v202, v116, v117, v202
    v_max3_f32 v203, v118, v119, v203
    v_mfma_f32_32x32x16_bf16 v[104:119], a[20:23], v[68:71], 0
    s_nop 11
    v_max3_f32 v202, v104, v105, v202
    v_max3_f32 v203, v106, v107, v203
    v_max3_f32 v202, v108, v109, v202
    v_max3_f32 v203, v110, v111, v203
    v_max3_f32 v202, v112, v113, v202
    v_max3_f32 v203, v114, v115, v203
    v_max3_f32 v202, v116, v117, v202
    v_max3_f32 v203, v118, v119, v203
    v_mfma_f32_32x32x16_bf16 v[104:119], a[16:19], v[68:71], 0
    s_nop 11
    v_max3_f32 v202, v104, v105, v202
    v_max3_f32 v203, v106, v107, v203
    v_max3_f32 v202, v108, v109, v202
    v_max3_f32 v203, v110, v111, v203
    v_max3_f32 v202, v112, v113, v202
    v_max3_f32 v203, v114, v115, v203
    v_max3_f32 v202, v116, v117, v202
    v_max3_f32 v203, v118, v119, v203
    v_mfma_f32_32x32x16_bf16 v[104:119], a[12:15], v[68:71], 0
    s_nop 11
    v_max3_f32 v202, v104, v105, v202
    v_max3_f32 v203, v106, v107, v203
    v_max3_f32 v202, v108, v109, v202
    v_max3_f32 v203, v110, v111, v203
    v_max3_f32 v202, v112, v113, v202
    v_max3_f32 v203, v114, v115, v203
    v_max3_f32 v202, v116, v117, v202
    v_max3_f32 v203, v118, v119, v203
    v_mfma_f32_32x32x16_bf16 v[104:119], a[8:11], v[68:71], 0
    s_nop 11
    v_max3_f32 v202, v104, v105, v202
    v_max3_f32 v203, v106, v107, v203
    v_max3_f32 v202, v108, v109, v202
    v_max3_f32 v203, v110, v111, v203
    v_max3_f32 v202, v112, v113, v202
    v_max3_f32 v203, v114, v115, v203
    v_max3_f32 v202, v116, v117, v202
    v_max3_f32 v203, v118, v119, v203
    v_mfma_f32_32x32x16_bf16 v[104:119], a[4:7], v[68:71], v[240:255]
    s_nop 11
    v_max3_f32 v202, v104, v105, v202
    v_max3_f32 v203, v106, v107, v203
    v_max3_f32 v202, v108, v109, v202
    v_max3_f32 v203, v110, v111, v203
    v_max3_f32 v202, v112, v113, v202
    v_max3_f32 v203, v114, v115, v203
    v_max3_f32 v202, v116, v117, v202
    v_max3_f32 v203, v118, v119, v203
    v_max_f32 v202, v202, v203
    v_mov_b32 v203, v202
    s_nop 1
    v_permlane32_swap_b32 v202, v203
    v_max_f32 v202, v202, v203
    v_cvt_pk_bf16_f32 v220, -v202, 0
    s_nop 1
    v_mfma_f32_32x32x16_bf16 v[136:151], v[212:215], v[220:223], 0
    v_mfma_f32_32x32x16_bf16 v[104:119], v[212:215], v[220:223], v[224:239]
    v_mfma_f32_32x32x16_bf16 v[104:119], a[36:39], v[68:71], v[104:119]
    s_nop 11
    v_exp_f32 v104, v104
    v_exp_f32 v105, v105
    v_exp_f32 v106, v106
    v_exp_f32 v107, v107
    v_exp_f32 v108, v108
    v_exp_f32 v109, v109
    v_exp_f32 v110, v110
    v_exp_f32 v111, v111
    v_exp_f32 v112, v112
    v_exp_f32 v113, v113
    v_exp_f32 v114, v114
    v_exp_f32 v115, v115
    v_exp_f32 v116, v116
    v_exp_f32 v117, v117
    v_exp_f32 v118, v118
    v_exp_f32 v119, v119
    v_cvt_pk_bf16_f32 v192, v104, v105
    v_cvt_pk_bf16_f32 v193, v106, v107
    v_cvt_pk_bf16_f32 v194, v108, v109
    v_cvt_pk_bf16_f32 v195, v110, v111
    v_cvt_pk_bf16_f32 v196, v112, v113
    v_cvt_pk_bf16_f32 v197, v114, v115
    v_cvt_pk_bf16_f32 v198, v116, v117
    v_cvt_pk_bf16_f32 v199, v118, v119
    v_mfma_f32_32x32x16_bf16 v[176:191], a[112:115], v[192:195], 0
    s_nop 0
    v_mfma_f32_32x32x16_bf16 v[176:191], a[116:119], v[196:199], v[176:191]
    v_mfma_f32_32x32x16_bf16 v[104:119], a[32:35], v[68:71], v[136:151]
    s_nop 11
    v_exp_f32 v104, v104
    v_exp_f32 v105, v105
    v_exp_f32 v106, v106
    v_exp_f32 v107, v107
    v_exp_f32 v108, v108
    v_exp_f32 v109, v109
    v_exp_f32 v110, v110
    v_exp_f32 v111, v111
    v_exp_f32 v112, v112
    v_exp_f32 v113, v113
    v_exp_f32 v114, v114
    v_exp_f32 v115, v115
    v_exp_f32 v116, v116
    v_exp_f32 v117, v117
    v_exp_f32 v118, v118
    v_exp_f32 v119, v119
    v_cvt_pk_bf16_f32 v192, v104, v105
    v_cvt_pk_bf16_f32 v193, v106, v107
    v_cvt_pk_bf16_f32 v194, v108, v109
    v_cvt_pk_bf16_f32 v195, v110, v111
    v_cvt_pk_bf16_f32 v196, v112, v113
    v_cvt_pk_bf16_f32 v197, v114, v115
    v_cvt_pk_bf16_f32 v198, v116, v117
    v_cvt_pk_bf16_f32 v199, v118, v119
    v_mfma_f32_32x32x16_bf16 v[176:191], a[104:107], v[192:195], v[176:191]
    s_nop 0
    v_mfma_f32_32x32x16_bf16 v[176:191], a[108:111], v[196:199], v[176:191]
    v_mfma_f32_32x32x16_bf16 v[104:119], a[28:31], v[68:71], v[136:151]
    s_nop 11
    v_exp_f32 v104, v104
    v_exp_f32 v105, v105
    v_exp_f32 v106, v106
    v_exp_f32 v107, v107
    v_exp_f32 v108, v108
    v_exp_f32 v109, v109
    v_exp_f32 v110, v110
    v_exp_f32 v111, v111
    v_exp_f32 v112, v112
    v_exp_f32 v113, v113
    v_exp_f32 v114, v114
    v_exp_f32 v115, v115
    v_exp_f32 v116, v116
    v_exp_f32 v117, v117
    v_exp_f32 v118, v118
    v_exp_f32 v119, v119
    v_cvt_pk_bf16_f32 v192, v104, v105
    v_cvt_pk_bf16_f32 v193, v106, v107
    v_cvt_pk_bf16_f32 v194, v108, v109
    v_cvt_pk_bf16_f32 v195, v110, v111
    v_cvt_pk_bf16_f32 v196, v112, v113
    v_cvt_pk_bf16_f32 v197, v114, v115
    v_cvt_pk_bf16_f32 v198, v116, v117
    v_cvt_pk_bf16_f32 v199, v118, v119
    v_mfma_f32_32x32x16_bf16 v[176:191], a[96:99], v[192:195], v[176:191]
    s_nop 0
    v_mfma_f32_32x32x16_bf16 v[176:191], a[100:103], v[196:199], v[176:191]
    v_mfma_f32_32x32x16_bf16 v[104:119], a[24:27], v[68:71], v[136:151]
    s_nop 11
    v_exp_f32 v104, v104
    v_exp_f32 v105, v105
    v_exp_f32 v106, v106
    v_exp_f32 v107, v107
    v_exp_f32 v108, v108
    v_exp_f32 v109, v109
    v_exp_f32 v110, v110
    v_exp_f32 v111, v111
    v_exp_f32 v112, v112
    v_exp_f32 v113, v113
    v_exp_f32 v114, v114
    v_exp_f32 v115, v115
    v_exp_f32 v116, v116
    v_exp_f32 v117, v117
    v_exp_f32 v118, v118
    v_exp_f32 v119, v119
    v_cvt_pk_bf16_f32 v192, v104, v105
    v_cvt_pk_bf16_f32 v193, v106, v107
    v_cvt_pk_bf16_f32 v194, v108, v109
    v_cvt_pk_bf16_f32 v195, v110, v111
    v_cvt_pk_bf16_f32 v196, v112, v113
    v_cvt_pk_bf16_f32 v197, v114, v115
    v_cvt_pk_bf16_f32 v198, v116, v117
    v_cvt_pk_bf16_f32 v199, v118, v119
    v_mfma_f32_32x32x16_bf16 v[176:191], a[88:91], v[192:195], v[176:191]
    s_nop 0
    v_mfma_f32_32x32x16_bf16 v[176:191], a[92:95], v[196:199], v[176:191]
    v_mfma_f32_32x32x16_bf16 v[104:119], a[20:23], v[68:71], v[136:151]
    s_nop 11
    v_exp_f32 v104, v104
    v_exp_f32 v105, v105
    v_exp_f32 v106, v106
    v_exp_f32 v107, v107
    v_exp_f32 v108, v108
    v_exp_f32 v109, v109
    v_exp_f32 v110, v110
    v_exp_f32 v111, v111
    v_exp_f32 v112, v112
    v_exp_f32 v113, v113
    v_exp_f32 v114, v114
    v_exp_f32 v115, v115
    v_exp_f32 v116, v116
    v_exp_f32 v117, v117
    v_exp_f32 v118, v118
    v_exp_f32 v119, v119
    v_cvt_pk_bf16_f32 v192, v104, v105
    v_cvt_pk_bf16_f32 v193, v106, v107
    v_cvt_pk_bf16_f32 v194, v108, v109
    v_cvt_pk_bf16_f32 v195, v110, v111
    v_cvt_pk_bf16_f32 v196, v112, v113
    v_cvt_pk_bf16_f32 v197, v114, v115
    v_cvt_pk_bf16_f32 v198, v116, v117
    v_cvt_pk_bf16_f32 v199, v118, v119
    v_mfma_f32_32x32x16_bf16 v[176:191], a[80:83], v[192:195], v[176:191]
    s_nop 0
    v_mfma_f32_32x32x16_bf16 v[176:191], a[84:87], v[196:199], v[176:191]
    v_mfma_f32_32x32x16_bf16 v[104:119], a[16:19], v[68:71], v[136:151]
    s_nop 11
    v_exp_f32 v104, v104
    v_exp_f32 v105, v105
    v_exp_f32 v106, v106
    v_exp_f32 v107, v107
    v_exp_f32 v108, v108
    v_exp_f32 v109, v109
    v_exp_f32 v110, v110
    v_exp_f32 v111, v111
    v_exp_f32 v112, v112
    v_exp_f32 v113, v113
    v_exp_f32 v114, v114
    v_exp_f32 v115, v115
    v_exp_f32 v116, v116
    v_exp_f32 v117, v117
    v_exp_f32 v118, v118
    v_exp_f32 v119, v119
    v_cvt_pk_bf16_f32 v192, v104, v105
    v_cvt_pk_bf16_f32 v193, v106, v107
    v_cvt_pk_bf16_f32 v194, v108, v109
    v_cvt_pk_bf16_f32 v195, v110, v111
    v_cvt_pk_bf16_f32 v196, v112, v113
    v_cvt_pk_bf16_f32 v197, v114, v115
    v_cvt_pk_bf16_f32 v198, v116, v117
    v_cvt_pk_bf16_f32 v199, v118, v119
    v_mfma_f32_32x32x16_bf16 v[176:191], a[72:75], v[192:195], v[176:191]
    s_nop 0
    v_mfma_f32_32x32x16_bf16 v[176:191], a[76:79], v[196:199], v[176:191]
    v_mfma_f32_32x32x16_bf16 v[104:119], a[12:15], v[68:71], v[136:151]
    s_nop 11
    v_exp_f32 v104, v104
    v_exp_f32 v105, v105
    v_exp_f32 v106, v106
    v_exp_f32 v107, v107
    v_exp_f32 v108, v108
    v_exp_f32 v109, v109
    v_exp_f32 v110, v110
    v_exp_f32 v111, v111
    v_exp_f32 v112, v112
    v_exp_f32 v113, v113
    v_exp_f32 v114, v114
    v_exp_f32 v115, v115
    v_exp_f32 v116, v116
    v_exp_f32 v117, v117
    v_exp_f32 v118, v118
    v_exp_f32 v119, v119
    v_cvt_pk_bf16_f32 v192, v104, v105
    v_cvt_pk_bf16_f32 v193, v106, v107
    v_cvt_pk_bf16_f32 v194, v108, v109
    v_cvt_pk_bf16_f32 v195, v110, v111
    v_cvt_pk_bf16_f32 v196, v112, v113
    v_cvt_pk_bf16_f32 v197, v114, v115
    v_cvt_pk_bf16_f32 v198, v116, v117
    v_cvt_pk_bf16_f32 v199, v118, v119
    v_mfma_f32_32x32x16_bf16 v[176:191], a[64:67], v[192:195], v[176:191]
    s_nop 0
    v_mfma_f32_32x32x16_bf16 v[176:191], a[68:71], v[196:199], v[176:191]
    v_mfma_f32_32x32x16_bf16 v[104:119], a[8:11], v[68:71], v[136:151]
    s_nop 11
    v_exp_f32 v104, v104
    v_exp_f32 v105, v105
    v_exp_f32 v106, v106
    v_exp_f32 v107, v107
    v_exp_f32 v108, v108
    v_exp_f32 v109, v109
    v_exp_f32 v110, v110
    v_exp_f32 v111, v111
    v_exp_f32 v112, v112
    v_exp_f32 v113, v113
    v_exp_f32 v114, v114
    v_exp_f32 v115, v115
    v_exp_f32 v116, v116
    v_exp_f32 v117, v117
    v_exp_f32 v118, v118
    v_exp_f32 v119, v119
    v_cvt_pk_bf16_f32 v192, v104, v105
    v_cvt_pk_bf16_f32 v193, v106, v107
    v_cvt_pk_bf16_f32 v194, v108, v109
    v_cvt_pk_bf16_f32 v195, v110, v111
    v_cvt_pk_bf16_f32 v196, v112, v113
    v_cvt_pk_bf16_f32 v197, v114, v115
    v_cvt_pk_bf16_f32 v198, v116, v117
    v_cvt_pk_bf16_f32 v199, v118, v119
    v_mfma_f32_32x32x16_bf16 v[176:191], a[56:59], v[192:195], v[176:191]
    s_nop 0
    v_mfma_f32_32x32x16_bf16 v[176:191], a[60:63], v[196:199], v[176:191]
    v_mfma_f32_32x32x16_bf16 v[104:119], v[212:215], v[220:223], v[240:255]
    v_mfma_f32_32x32x16_bf16 v[104:119], a[4:7], v[68:71], v[104:119]
    s_nop 11
    v_exp_f32 v104, v104
    v_exp_f32 v105, v105
    v_exp_f32 v106, v106
    v_exp_f32 v107, v107
    v_exp_f32 v108, v108
    v_exp_f32 v109, v109
    v_exp_f32 v110, v110
    v_exp_f32 v111, v111
    v_exp_f32 v112, v112
    v_exp_f32 v113, v113
    v_exp_f32 v114, v114
    v_exp_f32 v115, v115
    v_exp_f32 v116, v116
    v_exp_f32 v117, v117
    v_exp_f32 v118, v118
    v_exp_f32 v119, v119
    v_cvt_pk_bf16_f32 v192, v104, v105
    v_cvt_pk_bf16_f32 v193, v106, v107
    v_cvt_pk_bf16_f32 v194, v108, v109
    v_cvt_pk_bf16_f32 v195, v110, v111
    v_cvt_pk_bf16_f32 v196, v112, v113
    v_cvt_pk_bf16_f32 v197, v114, v115
    v_cvt_pk_bf16_f32 v198, v116, v117
    v_cvt_pk_bf16_f32 v199, v118, v119
    v_mfma_f32_32x32x16_bf16 v[176:191], a[48:51], v[192:195], v[176:191]
    s_nop 0
    v_mfma_f32_32x32x16_bf16 v[176:191], a[52:55], v[196:199], v[176:191]
    s_nop 15
    s_branch L_exact_6_back
L_exact_7:
    v_mfma_f32_32x32x16_bf16 v[104:119], a[32:35], v[64:67], v[224:239]
    s_nop 11
    v_max3_f32 v200, v104, v105, v106
    v_max3_f32 v201, v107, v108, v109
    v_max3_f32 v200, v110, v111, v200
    v_max3_f32 v201, v112, v113, v201
    v_max3_f32 v200, v114, v115, v200
    v_max3_f32 v201, v116, v117, v201
    v_max3_f32 v200, v118, v119, v200
    v_max_f32 v200, v200, v201
    v_mov_b32 v201, v200
    s_nop 1
    v_permlane32_swap_b32 v200, v201
    v_max_f32 v200, v200, v201
    v_cvt_pk_bf16_f32 v216, -v200, 0
    s_nop 1
    v_mfma_f32_32x32x16_bf16 v[120:135], v[212:215], v[216:219], 0
    v_mfma_f32_32x32x16_bf16 v[104:119], v[212:215], v[216:219], v[224:239]
    v_mfma_f32_32x32x16_bf16 v[104:119], a[32:35], v[64:67], v[104:119]
    s_nop 11
    v_exp_f32 v104, v104
    v_exp_f32 v105, v105
    v_exp_f32 v106, v106
    v_exp_f32 v107, v107
    v_exp_f32 v108, v108
    v_exp_f32 v109, v109
    v_exp_f32 v110, v110
    v_exp_f32 v111, v111
    v_exp_f32 v112, v112
    v_exp_f32 v113, v113
    v_exp_f32 v114, v114
    v_exp_f32 v115, v115
    v_exp_f32 v116, v116
    v_exp_f32 v117, v117
    v_exp_f32 v118, v118
    v_exp_f32 v119, v119
    v_cvt_pk_bf16_f32 v192, v104, v105
    v_cvt_pk_bf16_f32 v193, v106, v107
    v_cvt_pk_bf16_f32 v194, v108, v109
    v_cvt_pk_bf16_f32 v195, v110, v111
    v_cvt_pk_bf16_f32 v196, v112, v113
    v_cvt_pk_bf16_f32 v197, v114, v115
    v_cvt_pk_bf16_f32 v198, v116, v117
    v_cvt_pk_bf16_f32 v199, v118, v119
    v_mfma_f32_32x32x16_bf16 v[160:175], a[104:107], v[192:195], 0
    s_nop 0
    v_mfma_f32_32x32x16_bf16 v[160:175], a[108:111], v[196:199], v[160:175]
    s_nop 15
    s_branch L_exact_7_back
L_exact_9:
    v_mfma_f32_32x32x16_bf16 v[104:119], a[36:39], v[68:71], v[224:239]
    s_nop 11
    v_max3_f32 v202, v104, v105, v106
    v_max3_f32 v203, v107, v108, v109
    v_max3_f32 v202, v110, v111, v202
    v_max3_f32 v203, v112, v113, v203
    v_max3_f32 v202, v114, v115, v202
    v_max3_f32 v203, v116, v117, v203
    v_max3_f32 v202, v118, v119, v202
    v_mfma_f32_32x32x16_bf16 v[104:119], a[32:35], v[68:71], 0
    s_nop 11
    v_max3_f32 v202, v104, v105, v202
    v_max3_f32 v203, v106, v107, v203
    v_max3_f32 v202, v108, v109, v202
    v_max3_f32 v203, v110, v111, v203
    v_max3_f32 v202, v112, v113, v202
    v_max3_f32 v203, v114, v115, v203
    v_max3_f32 v202, v116, v117, v202
    v_max3_f32 v203, v118, v119, v203
    v_max_f32 v202, v202, v203
    v_mov_b32 v203, v202
    s_nop 1
    v_permlane32_swap_b32 v202, v203
    v_max_f32 v202, v202, v203
    v_cvt_pk_bf16_f32 v220, -v202, 0
    s_nop 1
    v_mfma_f32_32x32x16_bf16 v[136:151], v[212:215], v[220:223], 0
    v_mfma_f32_32x32x16_bf16 v[104:119], v[212:215], v[220:223], v[224:239]
    v_mfma_f32_32x32x16_bf16 v[104:119], a[36:39], v[68:71], v[104:119]
    s_nop 11
    v_exp_f32 v104, v104
    v_exp_f32 v105, v105
    v_exp_f32 v106, v106
    v_exp_f32 v107, v107
    v_exp_f32 v108, v108
    v_exp_f32 v109, v109
    v_exp_f32 v110, v110
    v_exp_f32 v111, v111
    v_exp_f32 v112, v112
    v_exp_f32 v113, v113
    v_exp_f32 v114, v114
    v_exp_f32 v115, v115
    v_exp_f32 v116, v116
    v_exp_f32 v117, v117
    v_exp_f32 v118, v118
    v_exp_f32 v119, v119
    v_cvt_pk_bf16_f32 v192, v104, v105
    v_cvt_pk_bf16_f32 v193, v106, v107
    v_cvt_pk_bf16_f32 v194, v108, v109
    v_cvt_pk_bf16_f32 v195, v110, v111
    v_cvt_pk_bf16_f32 v196, v112, v113
    v_cvt_pk_bf16_f32 v197, v114, v115
    v_cvt_pk_bf16_f32 v198, v116, v117
    v_cvt_pk_bf16_f32 v199, v118, v119
    v_mfma_f32_32x32x16_bf16 v[176:191], a[112:115], v[192:195], 0
    s_nop 0
    v_mfma_f32_32x32x16_bf16 v[176:191], a[116:119], v[196:199], v[176:191]
    v_mfma_f32_32x32x16_bf16 v[104:119], a[32:35], v[68:71], v[136:151]
    s_nop 11
    v_exp_f32 v104, v104
    v_exp_f32 v105, v105
    v_exp_f32 v106, v106
    v_exp_f32 v107, v107
    v_exp_f32 v108, v108
    v_exp_f32 v109, v109
    v_exp_f32 v110, v110
    v_exp_f32 v111, v111
    v_exp_f32 v112, v112
    v_exp_f32 v113, v113
    v_exp_f32 v114, v114
    v_exp_f32 v115, v115
    v_exp_f32 v116, v116
    v_exp_f32 v117, v117
    v_exp_f32 v118, v118
    v_exp_f32 v119, v119
    v_cvt_pk_bf16_f32 v192, v104, v105
    v_cvt_pk_bf16_f32 v193, v106, v107
    v_cvt_pk_bf16_f32 v194, v108, v109
    v_cvt_pk_bf16_f32 v195, v110, v111
    v_cvt_pk_bf16_f32 v196, v112, v113
    v_cvt_pk_bf16_f32 v197, v114, v115
    v_cvt_pk_bf16_f32 v198, v116, v117
    v_cvt_pk_bf16_f32 v199, v118, v119
    v_mfma_f32_32x32x16_bf16 v[176:191], a[104:107], v[192:195], v[176:191]
    s_nop 0
    v_mfma_f32_32x32x16_bf16 v[176:191], a[108:111], v[196:199], v[176:191]
    s_nop 15
    s_branch L_exact_9_back
L_exact_10:
    v_mfma_f32_32x32x16_bf16 v[104:119], a[32:35], v[64:67], v[224:239]
    s_nop 11
    v_max3_f32 v200, v104, v105, v106
    v_max3_f32 v201, v107, v108, v109
    v_max3_f32 v200, v110, v111, v200
    v_max3_f32 v201, v112, v113, v201
    v_max3_f32 v200, v114, v115, v200
    v_max3_f32 v201, v116, v117, v201
    v_max3_f32 v200, v118, v119, v200
    v_mfma_f32_32x32x16_bf16 v[104:119], a[28:31], v[64:67], 0
    s_nop 11
    v_max3_f32 v200, v104, v105, v200
    v_max3_f32 v201, v106, v107, v201
    v_max3_f32 v200, v108, v109, v200
    v_max3_f32 v201, v110, v111, v201
    v_max3_f32 v200, v112, v113, v200
    v_max3_f32 v201, v114, v115, v201
    v_max3_f32 v200, v116, v117, v200
    v_max3_f32 v201, v118, v119, v201
    v_mfma_f32_32x32x16_bf16 v[104:119], a[24:27], v[64:67], 0
    s_nop 11
    v_max3_f32 v200, v104, v105, v200
    v_max3_f32 v201, v106, v107, v201
    v_max3_f32 v200, v108, v109, v200
    v_max3_f32 v201, v110, v111, v201
    v_max3_f32 v200, v112, v113, v200
    v_max3_f32 v201, v114, v115, v201
    v_max3_f32 v200, v116, v117, v200
    v_max3_f32 v201, v118, v119, v201
    v_max_f32 v200, v200, v201
    v_mov_b32 v201, v200
    s_nop 1
    v_permlane32_swap_b32 v200, v201
    v_max_f32 v200, v200, v201
    v_cvt_pk_bf16_f32 v216, -v200, 0
    s_nop 1
    v_mfma_f32_32x32x16_bf16 v[120:135], v[212:215], v[216:219], 0
    v_mfma_f32_32x32x16_bf16 v[104:119], v[212:215], v[216:219], v[224:239]
    v_mfma_f32_32x32x16_bf16 v[104:119], a[32:35], v[64:67], v[104:119]
    s_nop 11
    v_exp_f32 v104, v104
    v_exp_f32 v105, v105
    v_exp_f32 v106, v106
    v_exp_f32 v107, v107
    v_exp_f32 v108, v108
    v_exp_f32 v109, v109
    v_exp_f32 v110, v110
    v_exp_f32 v111, v111
    v_exp_f32 v112, v112
    v_exp_f32 v113, v113
    v_exp_f32 v114, v114
    v_exp_f32 v115, v115
    v_exp_f32 v116, v116
    v_exp_f32 v117, v117
    v_exp_f32 v118, v118
    v_exp_f32 v119, v119
    v_cvt_pk_bf16_f32 v192, v104, v105
    v_cvt_pk_bf16_f32 v193, v106, v107
    v_cvt_pk_bf16_f32 v194, v108, v109
    v_cvt_pk_bf16_f32 v195, v110, v111
    v_cvt_pk_bf16_f32 v196, v112, v113
    v_cvt_pk_bf16_f32 v197, v114, v115
    v_cvt_pk_bf16_f32 v198, v116, v117
    v_cvt_pk_bf16_f32 v199, v118, v119
    v_mfma_f32_32x32x16_bf16 v[160:175], a[104:107], v[192:195], 0
    s_nop 0
    v_mfma_f32_32x32x16_bf16 v[160:175], a[108:111], v[196:199], v[160:175]
    v_mfma_f32_32x32x16_bf16 v[104:119], a[28:31], v[64:67], v[120:135]
    s_nop 11
    v_exp_f32 v104, v104
    v_exp_f32 v105, v105
    v_exp_f32 v106, v106
    v_exp_f32 v107, v107
    v_exp_f32 v108, v108
    v_exp_f32 v109, v109
    v_exp_f32 v110, v110
    v_exp_f32 v111, v111
    v_exp_f32 v112, v112
    v_exp_f32 v113, v113
    v_exp_f32 v114, v114
    v_exp_f32 v115, v115
    v_exp_f32 v116, v116
    v_exp_f32 v117, v117
    v_exp_f32 v118, v118
    v_exp_f32 v119, v119
    v_cvt_pk_bf16_f32 v192, v104, v105
    v_cvt_pk_bf16_f32 v193, v106, v107
    v_cvt_pk_bf16_f32 v194, v108, v109
    v_cvt_pk_bf16_f32 v195, v110, v111
    v_cvt_pk_bf16_f32 v196, v112, v113
    v_cvt_pk_bf16_f32 v197, v114, v115
    v_cvt_pk_bf16_f32 v198, v116, v117
    v_cvt_pk_bf16_f32 v199, v118, v119
    v_mfma_f32_32x32x16_bf16 v[160:175], a[96:99], v[192:195], v[160:175]
    s_nop 0
    v_mfma_f32_32x32x16_bf16 v[160:175], a[100:103], v[196:199], v[160:175]
    v_mfma_f32_32x32x16_bf16 v[104:119], a[24:27], v[64:67], v[120:135]
    s_nop 11
    v_exp_f32 v104, v104
    v_exp_f32 v105, v105
    v_exp_f32 v106, v106
    v_exp_f32 v107, v107
    v_exp_f32 v108, v108
    v_exp_f32 v109, v109
    v_exp_f32 v110, v110
    v_exp_f32 v111, v111
    v_exp_f32 v112, v112
    v_exp_f32 v113, v113
    v_exp_f32 v114, v114
    v_exp_f32 v115, v115
    v_exp_f32 v116, v116
    v_exp_f32 v117, v117
    v_exp_f32 v118, v118
    v_exp_f32 v119, v119
    v_cvt_pk_bf16_f32 v192, v104, v105
    v_cvt_pk_bf16_f32 v193, v106, v107
    v_cvt_pk_bf16_f32 v194, v108, v109
    v_cvt_pk_bf16_f32 v195, v110, v111
    v_cvt_pk_bf16_f32 v196, v112, v113
    v_cvt_pk_bf16_f32 v197, v114, v115
    v_cvt_pk_bf16_f32 v198, v116, v117
    v_cvt_pk_bf16_f32 v199, v118, v119
    v_mfma_f32_32x32x16_bf16 v[160:175], a[88:91], v[192:195], v[160:175]
    s_nop 0
    v_mfma_f32_32x32x16_bf16 v[160:175], a[92:95], v[196:199], v[160:175]
    s_nop 15
    s_branch L_exact_10_back
L_exact_12:
    v_mfma_f32_32x32x16_bf16 v[104:119], a[36:39], v[68:71], v[224:239]
    s_nop 11
    v_max3_f32 v202, v104, v105, v106
    v_max3_f32 v203, v107, v108, v109
    v_max3_f32 v202, v110, v111, v202
    v_max3_f32 v203, v112, v113, v203
    v_max3_f32 v202, v114, v115, v202
    v_max3_f32 v203, v116, v117, v203
    v_max3_f32 v202, v118, v119, v202
    v_mfma_f32_32x32x16_bf16 v[104:119], a[32:35], v[68:71], 0
    s_nop 11
    v_max3_f32 v202, v104, v105, v202
    v_max3_f32 v203, v106, v107, v203
    v_max3_f32 v202, v108, v109, v202
    v_max3_f32 v203, v110, v111, v203
    v_max3_f32 v202, v112, v113, v202
    v_max3_f32 v203, v114, v115, v203
    v_max3_f32 v202, v116, v117, v202
    v_max3_f32 v203, v118, v119, v203
    v_mfma_f32_32x32x16_bf16 v[104:119], a[28:31], v[68:71], 0
    s_nop 11
    v_max3_f32 v202, v104, v105, v202
    v_max3_f32 v203, v106, v107, v203
    v_max3_f32 v202, v108, v109, v202
    v_max3_f32 v203, v110, v111, v203
    v_max3_f32 v202, v112, v113, v202
    v_max3_f32 v203, v114, v115, v203
    v_max3_f32 v202, v116, v117, v202
    v_max3_f32 v203, v118, v119, v203
    v_mfma_f32_32x32x16_bf16 v[104:119], a[24:27], v[68:71], 0
    s_nop 11
    v_max3_f32 v202, v104, v105, v202
    v_max3_f32 v203, v106, v107, v203
    v_max3_f32 v202, v108, v109, v202
    v_max3_f32 v203, v110, v111, v203
    v_max3_f32 v202, v112, v113, v202
    v_max3_f32 v203, v114, v115, v203
    v_max3_f32 v202, v116, v117, v202
    v_max3_f32 v203, v118, v119, v203
    v_max_f32 v202, v202, v203
    v_mov_b32 v203, v202
    s_nop 1
    v_permlane32_swap_b32 v202, v203
    v_max_f32 v202, v202, v203
    v_cvt_pk_bf16_f32 v220, -v202, 0
    s_nop 1
    v_mfma_f32_32x32x16_bf16 v[136:151], v[212:215], v[220:223], 0
    v_mfma_f32_32x32x16_bf16 v[104:119], v[212:215], v[220:223], v[224:239]
    v_mfma_f32_32x32x16_bf16 v[104:119], a[36:39], v[68:71], v[104:119]
    s_nop 11
    v_exp_f32 v104, v104
    v_exp_f32 v105, v105
    v_exp_f32 v106, v106
    v_exp_f32 v107, v107
    v_exp_f32 v108, v108
    v_exp_f32 v109, v109
    v_exp_f32 v110, v110
    v_exp_f32 v111, v111
    v_exp_f32 v112, v112
    v_exp_f32 v113, v113
    v_exp_f32 v114, v114
    v_exp_f32 v115, v115
    v_exp_f32 v116, v116
    v_exp_f32 v117, v117
    v_exp_f32 v118, v118
    v_exp_f32 v119, v119
    v_cvt_pk_bf16_f32 v192, v104, v105
    v_cvt_pk_bf16_f32 v193, v106, v107
    v_cvt_pk_bf16_f32 v194, v108, v109
    v_cvt_pk_bf16_f32 v195, v110, v111
    v_cvt_pk_bf16_f32 v196, v112, v113
    v_cvt_pk_bf16_f32 v197, v114, v115
    v_cvt_pk_bf16_f32 v198, v116, v117
    v_cvt_pk_bf16_f32 v199, v118, v119
    v_mfma_f32_32x32x16_bf16 v[176:191], a[112:115], v[192:195], 0
    s_nop 0
    v_mfma_f32_32x32x16_bf16 v[176:191], a[116:119], v[196:199], v[176:191]
    v_mfma_f32_32x32x16_bf16 v[104:119], a[32:35], v[68:71], v[136:151]
    s_nop 11
    v_exp_f32 v104, v104
    v_exp_f32 v105, v105
    v_exp_f32 v106, v106
    v_exp_f32 v107, v107
    v_exp_f32 v108, v108
    v_exp_f32 v109, v109
    v_exp_f32 v110, v110
    v_exp_f32 v111, v111
    v_exp_f32 v112, v112
    v_exp_f32 v113, v113
    v_exp_f32 v114, v114
    v_exp_f32 v115, v115
    v_exp_f32 v116, v116
    v_exp_f32 v117, v117
    v_exp_f32 v118, v118
    v_exp_f32 v119, v119
    v_cvt_pk_bf16_f32 v192, v104, v105
    v_cvt_pk_bf16_f32 v193, v106, v107
    v_cvt_pk_bf16_f32 v194, v108, v109
    v_cvt_pk_bf16_f32 v195, v110, v111
    v_cvt_pk_bf16_f32 v196, v112, v113
    v_cvt_pk_bf16_f32 v197, v114, v115
    v_cvt_pk_bf16_f32 v198, v116, v117
    v_cvt_pk_bf16_f32 v199, v118, v119
    v_mfma_f32_32x32x16_bf16 v[176:191], a[104:107], v[192:195], v[176:191]
    s_nop 0
    v_mfma_f32_32x32x16_bf16 v[176:191], a[108:111], v[196:199], v[176:191]
    v_mfma_f32_32x32x16_bf16 v[104:119], a[28:31], v[68:71], v[136:151]
    s_nop 11
    v_exp_f32 v104, v104
    v_exp_f32 v105, v105
    v_exp_f32 v106, v106
    v_exp_f32 v107, v107
    v_exp_f32 v108, v108
    v_exp_f32 v109, v109
    v_exp_f32 v110, v110
    v_exp_f32 v111, v111
    v_exp_f32 v112, v112
    v_exp_f32 v113, v113
    v_exp_f32 v114, v114
    v_exp_f32 v115, v115
    v_exp_f32 v116, v116
    v_exp_f32 v117, v117
    v_exp_f32 v118, v118
    v_exp_f32 v119, v119
    v_cvt_pk_bf16_f32 v192, v104, v105
    v_cvt_pk_bf16_f32 v193, v106, v107
    v_cvt_pk_bf16_f32 v194, v108, v109
    v_cvt_pk_bf16_f32 v195, v110, v111
    v_cvt_pk_bf16_f32 v196, v112, v113
    v_cvt_pk_bf16_f32 v197, v114, v115
    v_cvt_pk_bf16_f32 v198, v116, v117
    v_cvt_pk_bf16_f32 v199, v118, v119
    v_mfma_f32_32x32x16_bf16 v[176:191], a[96:99], v[192:195], v[176:191]
    s_nop 0
    v_mfma_f32_32x32x16_bf16 v[176:191], a[100:103], v[196:199], v[176:191]
    v_mfma_f32_32x32x16_bf16 v[104:119], a[24:27], v[68:71], v[136:151]
    s_nop 11
    v_exp_f32 v104, v104
    v_exp_f32 v105, v105
    v_exp_f32 v106, v106
    v_exp_f32 v107, v107
    v_exp_f32 v108, v108
    v_exp_f32 v109, v109
    v_exp_f32 v110, v110
    v_exp_f32 v111, v111
    v_exp_f32 v112, v112
    v_exp_f32 v113, v113
    v_exp_f32 v114, v114
    v_exp_f32 v115, v115
    v_exp_f32 v116, v116
    v_exp_f32 v117, v117
    v_exp_f32 v118, v118
    v_exp_f32 v119, v119
    v_cvt_pk_bf16_f32 v192, v104, v105
    v_cvt_pk_bf16_f32 v193, v106, v107
    v_cvt_pk_bf16_f32 v194, v108, v109
    v_cvt_pk_bf16_f32 v195, v110, v111
    v_cvt_pk_bf16_f32 v196, v112, v113
    v_cvt_pk_bf16_f32 v197, v114, v115
    v_cvt_pk_bf16_f32 v198, v116, v117
    v_cvt_pk_bf16_f32 v199, v118, v119
    v_mfma_f32_32x32x16_bf16 v[176:191], a[88:91], v[192:195], v[176:191]
    s_nop 0
    v_mfma_f32_32x32x16_bf16 v[176:191], a[92:95], v[196:199], v[176:191]
    s_nop 15
    s_branch L_exact_12_back
L_exact_13:
    v_mfma_f32_32x32x16_bf16 v[104:119], a[32:35], v[64:67], v[224:239]
    s_nop 11
    v_max3_f32 v200, v104, v105, v106
    v_max3_f32 v201, v107, v108, v109
    v_max3_f32 v200, v110, v111, v200
    v_max3_f32 v201, v112, v113, v201
    v_max3_f32 v200, v114, v115, v200
    v_max3_f32 v201, v116, v117, v201
    v_max3_f32 v200, v118, v119, v200
    v_mfma_f32_32x32x16_bf16 v[104:119], a[28:31], v[64:67], 0
    s_nop 11
    v_max3_f32 v200, v104, v105, v200
    v_max3_f32 v201, v106, v107, v201
    v_max3_f32 v200, v108, v109, v200
    v_max3_f32 v201, v110, v111, v201
    v_max3_f32 v200, v112, v113, v200
    v_max3_f32 v201, v114, v115, v201
    v_max3_f32 v200, v116, v117, v200
    v_max3_f32 v201, v118, v119, v201
    v_mfma_f32_32x32x16_bf16 v[104:119], a[24:27], v[64:67], 0
    s_nop 11
    v_max3_f32 v200, v104, v105, v200
    v_max3_f32 v201, v106, v107, v201
    v_max3_f32 v200, v108, v109, v200
    v_max3_f32 v201, v110, v111, v201
    v_max3_f32 v200, v112, v113, v200
    v_max3_f32 v201, v114, v115, v201
    v_max3_f32 v200, v116, v117, v200
    v_max3_f32 v201, v118, v119, v201
    v_mfma_f32_32x32x16_bf16 v[104:119], a[20:23], v[64:67], 0
    s_nop 11
    v_max3_f32 v200, v104, v105, v200
    v_max3_f32 v201, v106, v107, v201
    v_max3_f32 v200, v108, v109, v200
    v_max3_f32 v201, v110, v111, v201
    v_max3_f32 v200, v112, v113, v200
    v_max3_f32 v201, v114, v115, v201
    v_max3_f32 v200, v116, v117, v200
    v_max3_f32 v201, v118, v119, v201
    v_mfma_f32_32x32x16_bf16 v[104:119], a[16:19], v[64:67], 0
    s_nop 11
    v_max3_f32 v200, v104, v105, v200
    v_max3_f32 v201, v106, v107, v201
    v_max3_f32 v200, v108, v109, v200
    v_max3_f32 v201, v110, v111, v201
    v_max3_f32 v200, v112, v113, v200
    v_max3_f32 v201, v114, v115, v201
    v_max3_f32 v200, v116, v117, v200
    v_max3_f32 v201, v118, v119, v201
    v_max_f32 v200, v200, v201
    v_mov_b32 v201, v200
    s_nop 1
    v_permlane32_swap_b32 v200, v201
    v_max_f32 v200, v200, v201
    v_cvt_pk_bf16_f32 v216, -v200, 0
    s_nop 1
    v_mfma_f32_32x32x16_bf16 v[120:135], v[212:215], v[216:219], 0
    v_mfma_f32_32x32x16_bf16 v[104:119], v[212:215], v[216:219], v[224:239]
    v_mfma_f32_32x32x16_bf16 v[104:119], a[32:35], v[64:67], v[104:119]
    s_nop 11
    v_exp_f32 v104, v104
    v_exp_f32 v105, v105
    v_exp_f32 v106, v106
    v_exp_f32 v107, v107
    v_exp_f32 v108, v108
    v_exp_f32 v109, v109
    v_exp_f32 v110, v110
    v_exp_f32 v111, v111
    v_exp_f32 v112, v112
    v_exp_f32 v113, v113
    v_exp_f32 v114, v114
    v_exp_f32 v115, v115
    v_exp_f32 v116, v116
    v_exp_f32 v117, v117
    v_exp_f32 v118, v118
    v_exp_f32 v119, v119
    v_cvt_pk_bf16_f32 v192, v104, v105
    v_cvt_pk_bf16_f32 v193, v106, v107
    v_cvt_pk_bf16_f32 v194, v108, v109
    v_cvt_pk_bf16_f32 v195, v110, v111
    v_cvt_pk_bf16_f32 v196, v112, v113
    v_cvt_pk_bf16_f32 v197, v114, v115
    v_cvt_pk_bf16_f32 v198, v116, v117
    v_cvt_pk_bf16_f32 v199, v118, v119
    v_mfma_f32_32x32x16_bf16 v[160:175], a[104:107], v[192:195], 0
    s_nop 0
    v_mfma_f32_32x32x16_bf16 v[160:175], a[108:111], v[196:199], v[160:175]
    v_mfma_f32_32x32x16_bf16 v[104:119], a[28:31], v[64:67], v[120:135]
    s_nop 11
    v_exp_f32 v104, v104
    v_exp_f32 v105, v105
    v_exp_f32 v106, v106
    v_exp_f32 v107, v107
    v_exp_f32 v108, v108
    v_exp_f32 v109, v109
    v_exp_f32 v110, v110
    v_exp_f32 v111, v111
    v_exp_f32 v112, v112
    v_exp_f32 v113, v113
    v_exp_f32 v114, v114
    v_exp_f32 v115, v115
    v_exp_f32 v116, v116
    v_exp_f32 v117, v117
    v_exp_f32 v118, v118
    v_exp_f32 v119, v119
    v_cvt_pk_bf16_f32 v192, v104, v105
    v_cvt_pk_bf16_f32 v193, v106, v107
    v_cvt_pk_bf16_f32 v194, v108, v109
    v_cvt_pk_bf16_f32 v195, v110, v111
    v_cvt_pk_bf16_f32 v196, v112, v113
    v_cvt_pk_bf16_f32 v197, v114, v115
    v_cvt_pk_bf16_f32 v198, v116, v117
    v_cvt_pk_bf16_f32 v199, v118, v119
    v_mfma_f32_32x32x16_bf16 v[160:175], a[96:99], v[192:195], v[160:175]
    s_nop 0
    v_mfma_f32_32x32x16_bf16 v[160:175], a[100:103], v[196:199], v[160:175]
    v_mfma_f32_32x32x16_bf16 v[104:119], a[24:27], v[64:67], v[120:135]
    s_nop 11
    v_exp_f32 v104, v104
    v_exp_f32 v105, v105
    v_exp_f32 v106, v106
    v_exp_f32 v107, v107
    v_exp_f32 v108, v108
    v_exp_f32 v109, v109
    v_exp_f32 v110, v110
    v_exp_f32 v111, v111
    v_exp_f32 v112, v112
    v_exp_f32 v113, v113
    v_exp_f32 v114, v114
    v_exp_f32 v115, v115
    v_exp_f32 v116, v116
    v_exp_f32 v117, v117
    v_exp_f32 v118, v118
    v_exp_f32 v119, v119
    v_cvt_pk_bf16_f32 v192, v104, v105
    v_cvt_pk_bf16_f32 v193, v106, v107
    v_cvt_pk_bf16_f32 v194, v108, v109
    v_cvt_pk_bf16_f32 v195, v110, v111
    v_cvt_pk_bf16_f32 v196, v112, v113
    v_cvt_pk_bf16_f32 v197, v114, v115
    v_cvt_pk_bf16_f32 v198, v116, v117
    v_cvt_pk_bf16_f32 v199, v118, v119
    v_mfma_f32_32x32x16_bf16 v[160:175], a[88:91], v[192:195], v[160:175]
    s_nop 0
    v_mfma_f32_32x32x16_bf16 v[160:175], a[92:95], v[196:199], v[160:175]
    v_mfma_f32_32x32x16_bf16 v[104:119], a[20:23], v[64:67], v[120:135]
    s_nop 11
    v_exp_f32 v104, v104
    v_exp_f32 v105, v105
    v_exp_f32 v106, v106
    v_exp_f32 v107, v107
    v_exp_f32 v108, v108
    v_exp_f32 v109, v109
    v_exp_f32 v110, v110
    v_exp_f32 v111, v111
    v_exp_f32 v112, v112
    v_exp_f32 v113, v113
    v_exp_f32 v114, v114
    v_exp_f32 v115, v115
    v_exp_f32 v116, v116
    v_exp_f32 v117, v117
    v_exp_f32 v118, v118
    v_exp_f32 v119, v119
    v_cvt_pk_bf16_f32 v192, v104, v105
    v_cvt_pk_bf16_f32 v193, v106, v107
    v_cvt_pk_bf16_f32 v194, v108, v109
    v_cvt_pk_bf16_f32 v195, v110, v111
    v_cvt_pk_bf16_f32 v196, v112, v113
    v_cvt_pk_bf16_f32 v197, v114, v115
    v_cvt_pk_bf16_f32 v198, v116, v117
    v_cvt_pk_bf16_f32 v199, v118, v119
    v_mfma_f32_32x32x16_bf16 v[160:175], a[80:83], v[192:195], v[160:175]
    s_nop 0
    v_mfma_f32_32x32x16_bf16 v[160:175], a[84:87], v[196:199], v[160:175]
    v_mfma_f32_32x32x16_bf16 v[104:119], a[16:19], v[64:67], v[120:135]
    s_nop 11
    v_exp_f32 v104, v104
    v_exp_f32 v105, v105
    v_exp_f32 v106, v106
    v_exp_f32 v107, v107
    v_exp_f32 v108, v108
    v_exp_f32 v109, v109
    v_exp_f32 v110, v110
    v_exp_f32 v111, v111
    v_exp_f32 v112, v112
    v_exp_f32 v113, v113
    v_exp_f32 v114, v114
    v_exp_f32 v115, v115
    v_exp_f32 v116, v116
    v_exp_f32 v117, v117
    v_exp_f32 v118, v118
    v_exp_f32 v119, v119
    v_cvt_pk_bf16_f32 v192, v104, v105
    v_cvt_pk_bf16_f32 v193, v106, v107
    v_cvt_pk_bf16_f32 v194, v108, v109
    v_cvt_pk_bf16_f32 v195, v110, v111
    v_cvt_pk_bf16_f32 v196, v112, v113
    v_cvt_pk_bf16_f32 v197, v114, v115
    v_cvt_pk_bf16_f32 v198, v116, v117
    v_cvt_pk_bf16_f32 v199, v118, v119
    v_mfma_f32_32x32x16_bf16 v[160:175], a[72:75], v[192:195], v[160:175]
    s_nop 0
    v_mfma_f32_32x32x16_bf16 v[160:175], a[76:79], v[196:199], v[160:175]
    s_nop 15
    s_branch L_exact_13_back
L_exact_15:
    v_mfma_f32_32x32x16_bf16 v[104:119], a[36:39], v[68:71], v[224:239]
    s_nop 11
    v_max3_f32 v202, v104, v105, v106
    v_max3_f32 v203, v107, v108, v109
    v_max3_f32 v202, v110, v111, v202
    v_max3_f32 v203, v112, v113, v203
    v_max3_f32 v202, v114, v115, v202
    v_max3_f32 v203, v116, v117, v203
    v_max3_f32 v202, v118, v119, v202
    v_mfma_f32_32x32x16_bf16 v[104:119], a[32:35], v[68:71], 0
    s_nop 11
    v_max3_f32 v202, v104, v105, v202
    v_max3_f32 v203, v106, v107, v203
    v_max3_f32 v202, v108, v109, v202
    v_max3_f32 v203, v110, v111, v203
    v_max3_f32 v202, v112, v113, v202
    v_max3_f32 v203, v114, v115, v203
    v_max3_f32 v202, v116, v117, v202
    v_max3_f32 v203, v118, v119, v203
    v_mfma_f32_32x32x16_bf16 v[104:119], a[28:31], v[68:71], 0
    s_nop 11
    v_max3_f32 v202, v104, v105, v202
    v_max3_f32 v203, v106, v107, v203
    v_max3_f32 v202, v108, v109, v202
    v_max3_f32 v203, v110, v111, v203
    v_max3_f32 v202, v112, v113, v202
    v_max3_f32 v203, v114, v115, v203
    v_max3_f32 v202, v116, v117, v202
    v_max3_f32 v203, v118, v119, v203
    v_mfma_f32_32x32x16_bf16 v[104:119], a[24:27], v[68:71], 0
    s_nop 11
    v_max3_f32 v202, v104, v105, v202
    v_max3_f32 v203, v106, v107, v203
    v_max3_f32 v202, v108, v109, v202
    v_max3_f32 v203, v110, v111, v203
    v_max3_f32 v202, v112, v113, v202
    v_max3_f32 v203, v114, v115, v203
    v_max3_f32 v202, v116, v117, v202
    v_max3_f32 v203, v118, v119, v203
    v_mfma_f32_32x32x16_bf16 v[104:119], a[20:23], v[68:71], 0
    s_nop 11
    v_max3_f32 v202, v104, v105, v202
    v_max3_f32 v203, v106, v107, v203
    v_max3_f32 v202, v108, v109, v202
    v_max3_f32 v203, v110, v111, v203
    v_max3_f32 v202, v112, v113, v202
    v_max3_f32 v203, v114, v115, v203
    v_max3_f32 v202, v116, v117, v202
    v_max3_f32 v203, v118, v119, v203
    v_mfma_f32_32x32x16_bf16 v[104:119], a[16:19], v[68:71], 0
    s_nop 11
    v_max3_f32 v202, v104, v105, v202
    v_max3_f32 v203, v106, v107, v203
    v_max3_f32 v202, v108, v109, v202
    v_max3_f32 v203, v110, v111, v203
    v_max3_f32 v202, v112, v113, v202
    v_max3_f32 v203, v114, v115, v203
    v_max3_f32 v202, v116, v117, v202
    v_max3_f32 v203, v118, v119, v203
    v_max_f32 v202, v202, v203
    v_mov_b32 v203, v202
    s_nop 1
    v_permlane32_swap_b32 v202, v203
    v_max_f32 v202, v202, v203
    v_cvt_pk_bf16_f32 v220, -v202, 0
    s_nop 1
    v_mfma_f32_32x32x16_bf16 v[136:151], v[212:215], v[220:223], 0
    v_mfma_f32_32x32x16_bf16 v[104:119], v[212:215], v[220:223], v[224:239]
    v_mfma_f32_32x32x16_bf16 v[104:119], a[36:39], v[68:71], v[104:119]
    s_nop 11
    v_exp_f32 v104, v104
    v_exp_f32 v105, v105
    v_exp_f32 v106, v106
    v_exp_f32 v107, v107
    v_exp_f32 v108, v108
    v_exp_f32 v109, v109
    v_exp_f32 v110, v110
    v_exp_f32 v111, v111
    v_exp_f32 v112, v112
    v_exp_f32 v113, v113
    v_exp_f32 v114, v114
    v_exp_f32 v115, v115
    v_exp_f32 v116, v116
    v_exp_f32 v117, v117
    v_exp_f32 v118, v118
    v_exp_f32 v119, v119
    v_cvt_pk_bf16_f32 v192, v104, v105
    v_cvt_pk_bf16_f32 v193, v106, v107
    v_cvt_pk_bf16_f32 v194, v108, v109
    v_cvt_pk_bf16_f32 v195, v110, v111
    v_cvt_pk_bf16_f32 v196, v112, v113
    v_cvt_pk_bf16_f32 v197, v114, v115
    v_cvt_pk_bf16_f32 v198, v116, v117
    v_cvt_pk_bf16_f32 v199, v118, v119
    v_mfma_f32_32x32x16_bf16 v[176:191], a[112:115], v[192:195], 0
    s_nop 0
    v_mfma_f32_32x32x16_bf16 v[176:191], a[116:119], v[196:199], v[176:191]
    v_mfma_f32_32x32x16_bf16 v[104:119], a[32:35], v[68:71], v[136:151]
    s_nop 11
    v_exp_f32 v104, v104
    v_exp_f32 v105, v105
    v_exp_f32 v106, v106
    v_exp_f32 v107, v107
    v_exp_f32 v108, v108
    v_exp_f32 v109, v109
    v_exp_f32 v110, v110
    v_exp_f32 v111, v111
    v_exp_f32 v112, v112
    v_exp_f32 v113, v113
    v_exp_f32 v114, v114
    v_exp_f32 v115, v115
    v_exp_f32 v116, v116
    v_exp_f32 v117, v117
    v_exp_f32 v118, v118
    v_exp_f32 v119, v119
    v_cvt_pk_bf16_f32 v192, v104, v105
    v_cvt_pk_bf16_f32 v193, v106, v107
    v_cvt_pk_bf16_f32 v194, v108, v109
    v_cvt_pk_bf16_f32 v195, v110, v111
    v_cvt_pk_bf16_f32 v196, v112, v113
    v_cvt_pk_bf16_f32 v197, v114, v115
    v_cvt_pk_bf16_f32 v198, v116, v117
    v_cvt_pk_bf16_f32 v199, v118, v119
    v_mfma_f32_32x32x16_bf16 v[176:191], a[104:107], v[192:195], v[176:191]
    s_nop 0
    v_mfma_f32_32x32x16_bf16 v[176:191], a[108:111], v[196:199], v[176:191]
    v_mfma_f32_32x32x16_bf16 v[104:119], a[28:31], v[68:71], v[136:151]
    s_nop 11
    v_exp_f32 v104, v104
    v_exp_f32 v105, v105
    v_exp_f32 v106, v106
    v_exp_f32 v107, v107
    v_exp_f32 v108, v108
    v_exp_f32 v109, v109
    v_exp_f32 v110, v110
    v_exp_f32 v111, v111
    v_exp_f32 v112, v112
    v_exp_f32 v113, v113
    v_exp_f32 v114, v114
    v_exp_f32 v115, v115
    v_exp_f32 v116, v116
    v_exp_f32 v117, v117
    v_exp_f32 v118, v118
    v_exp_f32 v119, v119
    v_cvt_pk_bf16_f32 v192, v104, v105
    v_cvt_pk_bf16_f32 v193, v106, v107
    v_cvt_pk_bf16_f32 v194, v108, v109
    v_cvt_pk_bf16_f32 v195, v110, v111
    v_cvt_pk_bf16_f32 v196, v112, v113
    v_cvt_pk_bf16_f32 v197, v114, v115
    v_cvt_pk_bf16_f32 v198, v116, v117
    v_cvt_pk_bf16_f32 v199, v118, v119
    v_mfma_f32_32x32x16_bf16 v[176:191], a[96:99], v[192:195], v[176:191]
    s_nop 0
    v_mfma_f32_32x32x16_bf16 v[176:191], a[100:103], v[196:199], v[176:191]
    v_mfma_f32_32x32x16_bf16 v[104:119], a[24:27], v[68:71], v[136:151]
    s_nop 11
    v_exp_f32 v104, v104
    v_exp_f32 v105, v105
    v_exp_f32 v106, v106
    v_exp_f32 v107, v107
    v_exp_f32 v108, v108
    v_exp_f32 v109, v109
    v_exp_f32 v110, v110
    v_exp_f32 v111, v111
    v_exp_f32 v112, v112
    v_exp_f32 v113, v113
    v_exp_f32 v114, v114
    v_exp_f32 v115, v115
    v_exp_f32 v116, v116
    v_exp_f32 v117, v117
    v_exp_f32 v118, v118
    v_exp_f32 v119, v119
    v_cvt_pk_bf16_f32 v192, v104, v105
    v_cvt_pk_bf16_f32 v193, v106, v107
    v_cvt_pk_bf16_f32 v194, v108, v109
    v_cvt_pk_bf16_f32 v195, v110, v111
    v_cvt_pk_bf16_f32 v196, v112, v113
    v_cvt_pk_bf16_f32 v197, v114, v115
    v_cvt_pk_bf16_f32 v198, v116, v117
    v_cvt_pk_bf16_f32 v199, v118, v119
    v_mfma_f32_32x32x16_bf16 v[176:191], a[88:91], v[192:195], v[176:191]
    s_nop 0
    v_mfma_f32_32x32x16_bf16 v[176:191], a[92:95], v[196:199], v[176:191]
    v_mfma_f32_32x32x16_bf16 v[104:119], a[20:23], v[68:71], v[136:151]
    s_nop 11
    v_exp_f32 v104, v104
    v_exp_f32 v105, v105
    v_exp_f32 v106, v106
    v_exp_f32 v107, v107
    v_exp_f32 v108, v108
    v_exp_f32 v109, v109
    v_exp_f32 v110, v110
    v_exp_f32 v111, v111
    v_exp_f32 v112, v112
    v_exp_f32 v113, v113
    v_exp_f32 v114, v114
    v_exp_f32 v115, v115
    v_exp_f32 v116, v116
    v_exp_f32 v117, v117
    v_exp_f32 v118, v118
    v_exp_f32 v119, v119
    v_cvt_pk_bf16_f32 v192, v104, v105
    v_cvt_pk_bf16_f32 v193, v106, v107
    v_cvt_pk_bf16_f32 v194, v108, v109
    v_cvt_pk_bf16_f32 v195, v110, v111
    v_cvt_pk_bf16_f32 v196, v112, v113
    v_cvt_pk_bf16_f32 v197, v114, v115
    v_cvt_pk_bf16_f32 v198, v116, v117
    v_cvt_pk_bf16_f32 v199, v118, v119
    v_mfma_f32_32x32x16_bf16 v[176:191], a[80:83], v[192:195], v[176:191]
    s_nop 0
    v_mfma_f32_32x32x16_bf16 v[176:191], a[84:87], v[196:199], v[176:191]
    v_mfma_f32_32x32x16_bf16 v[104:119], a[16:19], v[68:71], v[136:151]
    s_nop 11
    v_exp_f32 v104, v104
    v_exp_f32 v105, v105
    v_exp_f32 v106, v106
    v_exp_f32 v107, v107
    v_exp_f32 v108, v108
    v_exp_f32 v109, v109
    v_exp_f32 v110, v110
    v_exp_f32 v111, v111
    v_exp_f32 v112, v112
    v_exp_f32 v113, v113
    v_exp_f32 v114, v114
    v_exp_f32 v115, v115
    v_exp_f32 v116, v116
    v_exp_f32 v117, v117
    v_exp_f32 v118, v118
    v_exp_f32 v119, v119
    v_cvt_pk_bf16_f32 v192, v104, v105
    v_cvt_pk_bf16_f32 v193, v106, v107
    v_cvt_pk_bf16_f32 v194, v108, v109
    v_cvt_pk_bf16_f32 v195, v110, v111
    v_cvt_pk_bf16_f32 v196, v112, v113
    v_cvt_pk_bf16_f32 v197, v114, v115
    v_cvt_pk_bf16_f32 v198, v116, v117
    v_cvt_pk_bf16_f32 v199, v118, v119
    v_mfma_f32_32x32x16_bf16 v[176:191], a[72:75], v[192:195], v[176:191]
    s_nop 0
    v_mfma_f32_32x32x16_bf16 v[176:191], a[76:79], v[196:199], v[176:191]
    s_nop 15
    s_branch L_exact_15_back
L_exact_16:
    v_mfma_f32_32x32x16_bf16 v[104:119], a[32:35], v[64:67], v[224:239]
    s_nop 11
    v_max3_f32 v200, v104, v105, v106
    v_max3_f32 v201, v107, v108, v109
    v_max3_f32 v200, v110, v111, v200
    v_max3_f32 v201, v112, v113, v201
    v_max3_f32 v200, v114, v115, v200
    v_max3_f32 v201, v116, v117, v201
    v_max3_f32 v200, v118, v119, v200
    v_mfma_f32_32x32x16_bf16 v[104:119], a[28:31], v[64:67], 0
    s_nop 11
    v_max3_f32 v200, v104, v105, v200
    v_max3_f32 v201, v106, v107, v201
    v_max3_f32 v200, v108, v109, v200
    v_max3_f32 v201, v110, v111, v201
    v_max3_f32 v200, v112, v113, v200
    v_max3_f32 v201, v114, v115, v201
    v_max3_f32 v200, v116, v117, v200
    v_max3_f32 v201, v118, v119, v201
    v_mfma_f32_32x32x16_bf16 v[104:119], a[24:27], v[64:67], 0
    s_nop 11
    v_max3_f32 v200, v104, v105, v200
    v_max3_f32 v201, v106, v107, v201
    v_max3_f32 v200, v108, v109, v200
    v_max3_f32 v201, v110, v111, v201
    v_max3_f32 v200, v112, v113, v200
    v_max3_f32 v201, v114, v115, v201
    v_max3_f32 v200, v116, v117, v200
    v_max3_f32 v201, v118, v119, v201
    v_mfma_f32_32x32x16_bf16 v[104:119], a[20:23], v[64:67], 0
    s_nop 11
    v_max3_f32 v200, v104, v105, v200
    v_max3_f32 v201, v106, v107, v201
    v_max3_f32 v200, v108, v109, v200
    v_max3_f32 v201, v110, v111, v201
    v_max3_f32 v200, v112, v113, v200
    v_max3_f32 v201, v114, v115, v201
    v_max3_f32 v200, v116, v117, v200
    v_max3_f32 v201, v118, v119, v201
    v_mfma_f32_32x32x16_bf16 v[104:119], a[16:19], v[64:67], 0
    s_nop 11
    v_max3_f32 v200, v104, v105, v200
    v_max3_f32 v201, v106, v107, v201
    v_max3_f32 v200, v108, v109, v200
    v_max3_f32 v201, v110, v111, v201
    v_max3_f32 v200, v112, v113, v200
    v_max3_f32 v201, v114, v115, v201
    v_max3_f32 v200, v116, v117, v200
    v_max3_f32 v201, v118, v119, v201
    v_mfma_f32_32x32x16_bf16 v[104:119], a[12:15], v[64:67], 0
    s_nop 11
    v_max3_f32 v200, v104, v105, v200
    v_max3_f32 v201, v106, v107, v201
    v_max3_f32 v200, v108, v109, v200
    v_max3_f32 v201, v110, v111, v201
    v_max3_f32 v200, v112, v113, v200
    v_max3_f32 v201, v114, v115, v201
    v_max3_f32 v200, v116, v117, v200
    v_max3_f32 v201, v118, v119, v201
    v_mfma_f32_32x32x16_bf16 v[104:119], a[8:11], v[64:67], 0
    s_nop 11
    v_max3_f32 v200, v104, v105, v200
    v_max3_f32 v201, v106, v107, v201
    v_max3_f32 v200, v108, v109, v200
    v_max3_f32 v201, v110, v111, v201
    v_max3_f32 v200, v112, v113, v200
    v_max3_f32 v201, v114, v115, v201
    v_max3_f32 v200, v116, v117, v200
    v_max3_f32 v201, v118, v119, v201
    v_max_f32 v200, v200, v201
    v_mov_b32 v201, v200
    s_nop 1
    v_permlane32_swap_b32 v200, v201
    v_max_f32 v200, v200, v201
    v_cvt_pk_bf16_f32 v216, -v200, 0
    s_nop 1
    v_mfma_f32_32x32x16_bf16 v[120:135], v[212:215], v[216:219], 0
    v_mfma_f32_32x32x16_bf16 v[104:119], v[212:215], v[216:219], v[224:239]
    v_mfma_f32_32x32x16_bf16 v[104:119], a[32:35], v[64:67], v[104:119]
    s_nop 11
    v_exp_f32 v104, v104
    v_exp_f32 v105, v105
    v_exp_f32 v106, v106
    v_exp_f32 v107, v107
    v_exp_f32 v108, v108
    v_exp_f32 v109, v109
    v_exp_f32 v110, v110
    v_exp_f32 v111, v111
    v_exp_f32 v112, v112
    v_exp_f32 v113, v113
    v_exp_f32 v114, v114
    v_exp_f32 v115, v115
    v_exp_f32 v116, v116
    v_exp_f32 v117, v117
    v_exp_f32 v118, v118
    v_exp_f32 v119, v119
    v_cvt_pk_bf16_f32 v192, v104, v105
    v_cvt_pk_bf16_f32 v193, v106, v107
    v_cvt_pk_bf16_f32 v194, v108, v109
    v_cvt_pk_bf16_f32 v195, v110, v111
    v_cvt_pk_bf16_f32 v196, v112, v113
    v_cvt_pk_bf16_f32 v197, v114, v115
    v_cvt_pk_bf16_f32 v198, v116, v117
    v_cvt_pk_bf16_f32 v199, v118, v119
    v_mfma_f32_32x32x16_bf16 v[160:175], a[104:107], v[192:195], 0
    s_nop 0
    v_mfma_f32_32x32x16_bf16 v[160:175], a[108:111], v[196:199], v[160:175]
    v_mfma_f32_32x32x16_bf16 v[104:119], a[28:31], v[64:67], v[120:135]
    s_nop 11
    v_exp_f32 v104, v104
    v_exp_f32 v105, v105
    v_exp_f32 v106, v106
    v_exp_f32 v107, v107
    v_exp_f32 v108, v108
    v_exp_f32 v109, v109
    v_exp_f32 v110, v110
    v_exp_f32 v111, v111
    v_exp_f32 v112, v112
    v_exp_f32 v113, v113
    v_exp_f32 v114, v114
    v_exp_f32 v115, v115
    v_exp_f32 v116, v116
    v_exp_f32 v117, v117
    v_exp_f32 v118, v118
    v_exp_f32 v119, v119
    v_cvt_pk_bf16_f32 v192, v104, v105
    v_cvt_pk_bf16_f32 v193, v106, v107
    v_cvt_pk_bf16_f32 v194, v108, v109
    v_cvt_pk_bf16_f32 v195, v110, v111
    v_cvt_pk_bf16_f32 v196, v112, v113
    v_cvt_pk_bf16_f32 v197, v114, v115
    v_cvt_pk_bf16_f32 v198, v116, v117
    v_cvt_pk_bf16_f32 v199, v118, v119
    v_mfma_f32_32x32x16_bf16 v[160:175], a[96:99], v[192:195], v[160:175]
    s_nop 0
    v_mfma_f32_32x32x16_bf16 v[160:175], a[100:103], v[196:199], v[160:175]
    v_mfma_f32_32x32x16_bf16 v[104:119], a[24:27], v[64:67], v[120:135]
    s_nop 11
    v_exp_f32 v104, v104
    v_exp_f32 v105, v105
    v_exp_f32 v106, v106
    v_exp_f32 v107, v107
    v_exp_f32 v108, v108
    v_exp_f32 v109, v109
    v_exp_f32 v110, v110
    v_exp_f32 v111, v111
    v_exp_f32 v112, v112
    v_exp_f32 v113, v113
    v_exp_f32 v114, v114
    v_exp_f32 v115, v115
    v_exp_f32 v116, v116
    v_exp_f32 v117, v117
    v_exp_f32 v118, v118
    v_exp_f32 v119, v119
    v_cvt_pk_bf16_f32 v192, v104, v105
    v_cvt_pk_bf16_f32 v193, v106, v107
    v_cvt_pk_bf16_f32 v194, v108, v109
    v_cvt_pk_bf16_f32 v195, v110, v111
    v_cvt_pk_bf16_f32 v196, v112, v113
    v_cvt_pk_bf16_f32 v197, v114, v115
    v_cvt_pk_bf16_f32 v198, v116, v117
    v_cvt_pk_bf16_f32 v199, v118, v119
    v_mfma_f32_32x32x16_bf16 v[160:175], a[88:91], v[192:195], v[160:175]
    s_nop 0
    v_mfma_f32_32x32x16_bf16 v[160:175], a[92:95], v[196:199], v[160:175]
    v_mfma_f32_32x32x16_bf16 v[104:119], a[20:23], v[64:67], v[120:135]
    s_nop 11
    v_exp_f32 v104, v104
    v_exp_f32 v105, v105
    v_exp_f32 v106, v106
    v_exp_f32 v107, v107
    v_exp_f32 v108, v108
    v_exp_f32 v109, v109
    v_exp_f32 v110, v110
    v_exp_f32 v111, v111
    v_exp_f32 v112, v112
    v_exp_f32 v113, v113
    v_exp_f32 v114, v114
    v_exp_f32 v115, v115
    v_exp_f32 v116, v116
    v_exp_f32 v117, v117
    v_exp_f32 v118, v118
    v_exp_f32 v119, v119
    v_cvt_pk_bf16_f32 v192, v104, v105
    v_cvt_pk_bf16_f32 v193, v106, v107
    v_cvt_pk_bf16_f32 v194, v108, v109
    v_cvt_pk_bf16_f32 v195, v110, v111
    v_cvt_pk_bf16_f32 v196, v112, v113
    v_cvt_pk_bf16_f32 v197, v114, v115
    v_cvt_pk_bf16_f32 v198, v116, v117
    v_cvt_pk_bf16_f32 v199, v118, v119
    v_mfma_f32_32x32x16_bf16 v[160:175], a[80:83], v[192:195], v[160:175]
    s_nop 0
    v_mfma_f32_32x32x16_bf16 v[160:175], a[84:87], v[196:199], v[160:175]
    v_mfma_f32_32x32x16_bf16 v[104:119], a[16:19], v[64:67], v[120:135]
    s_nop 11
    v_exp_f32 v104, v104
    v_exp_f32 v105, v105
    v_exp_f32 v106, v106
    v_exp_f32 v107, v107
    v_exp_f32 v108, v108
    v_exp_f32 v109, v109
    v_exp_f32 v110, v110
    v_exp_f32 v111, v111
    v_exp_f32 v112, v112
    v_exp_f32 v113, v113
    v_exp_f32 v114, v114
    v_exp_f32 v115, v115
    v_exp_f32 v116, v116
    v_exp_f32 v117, v117
    v_exp_f32 v118, v118
    v_exp_f32 v119, v119
    v_cvt_pk_bf16_f32 v192, v104, v105
    v_cvt_pk_bf16_f32 v193, v106, v107
    v_cvt_pk_bf16_f32 v194, v108, v109
    v_cvt_pk_bf16_f32 v195, v110, v111
    v_cvt_pk_bf16_f32 v196, v112, v113
    v_cvt_pk_bf16_f32 v197, v114, v115
    v_cvt_pk_bf16_f32 v198, v116, v117
    v_cvt_pk_bf16_f32 v199, v118, v119
    v_mfma_f32_32x32x16_bf16 v[160:175], a[72:75], v[192:195], v[160:175]
    s_nop 0
    v_mfma_f32_32x32x16_bf16 v[160:175], a[76:79], v[196:199], v[160:175]
    v_mfma_f32_32x32x16_bf16 v[104:119], a[12:15], v[64:67], v[120:135]
    s_nop 11
    v_exp_f32 v104, v104
    v_exp_f32 v105, v105
    v_exp_f32 v106, v106
    v_exp_f32 v107, v107
    v_exp_f32 v108, v108
    v_exp_f32 v109, v109
    v_exp_f32 v110, v110
    v_exp_f32 v111, v111
    v_exp_f32 v112, v112
    v_exp_f32 v113, v113
    v_exp_f32 v114, v114
    v_exp_f32 v115, v115
    v_exp_f32 v116, v116
    v_exp_f32 v117, v117
    v_exp_f32 v118, v118
    v_exp_f32 v119, v119
    v_cvt_pk_bf16_f32 v192, v104, v105
    v_cvt_pk_bf16_f32 v193, v106, v107
    v_cvt_pk_bf16_f32 v194, v108, v109
    v_cvt_pk_bf16_f32 v195, v110, v111
    v_cvt_pk_bf16_f32 v196, v112, v113
    v_cvt_pk_bf16_f32 v197, v114, v115
    v_cvt_pk_bf16_f32 v198, v116, v117
    v_cvt_pk_bf16_f32 v199, v118, v119
    v_mfma_f32_32x32x16_bf16 v[160:175], a[64:67], v[192:195], v[160:175]
    s_nop 0
    v_mfma_f32_32x32x16_bf16 v[160:175], a[68:71], v[196:199], v[160:175]
    v_mfma_f32_32x32x16_bf16 v[104:119], a[8:11], v[64:67], v[120:135]
    s_nop 11
    v_exp_f32 v104, v104
    v_exp_f32 v105, v105
    v_exp_f32 v106, v106
    v_exp_f32 v107, v107
    v_exp_f32 v108, v108
    v_exp_f32 v109, v109
    v_exp_f32 v110, v110
    v_exp_f32 v111, v111
    v_exp_f32 v112, v112
    v_exp_f32 v113, v113
    v_exp_f32 v114, v114
    v_exp_f32 v115, v115
    v_exp_f32 v116, v116
    v_exp_f32 v117, v117
    v_exp_f32 v118, v118
    v_exp_f32 v119, v119
    v_cvt_pk_bf16_f32 v192, v104, v105
    v_cvt_pk_bf16_f32 v193, v106, v107
    v_cvt_pk_bf16_f32 v194, v108, v109
    v_cvt_pk_bf16_f32 v195, v110, v111
    v_cvt_pk_bf16_f32 v196, v112, v113
    v_cvt_pk_bf16_f32 v197, v114, v115
    v_cvt_pk_bf16_f32 v198, v116, v117
    v_cvt_pk_bf16_f32 v199, v118, v119
    v_mfma_f32_32x32x16_bf16 v[160:175], a[56:59], v[192:195], v[160:175]
    s_nop 0
    v_mfma_f32_32x32x16_bf16 v[160:175], a[60:63], v[196:199], v[160:175]
    s_nop 15
    s_branch L_exact_16_back
L_exact_18:
    v_mfma_f32_32x32x16_bf16 v[104:119], a[36:39], v[68:71], v[224:239]
    s_nop 11
    v_max3_f32 v202, v104, v105, v106
    v_max3_f32 v203, v107, v108, v109
    v_max3_f32 v202, v110, v111, v202
    v_max3_f32 v203, v112, v113, v203
    v_max3_f32 v202, v114, v115, v202
    v_max3_f32 v203, v116, v117, v203
    v_max3_f32 v202, v118, v119, v202
    v_mfma_f32_32x32x16_bf16 v[104:119], a[32:35], v[68:71], 0
    s_nop 11
    v_max3_f32 v202, v104, v105, v202
    v_max3_f32 v203, v106, v107, v203
    v_max3_f32 v202, v108, v109, v202
    v_max3_f32 v203, v110, v111, v203
    v_max3_f32 v202, v112, v113, v202
    v_max3_f32 v203, v114, v115, v203
    v_max3_f32 v202, v116, v117, v202
    v_max3_f32 v203, v118, v119, v203
    v_mfma_f32_32x32x16_bf16 v[104:119], a[28:31], v[68:71], 0
    s_nop 11
    v_max3_f32 v202, v104, v105, v202
    v_max3_f32 v203, v106, v107, v203
    v_max3_f32 v202, v108, v109, v202
    v_max3_f32 v203, v110, v111, v203
    v_max3_f32 v202, v112, v113, v202
    v_max3_f32 v203, v114, v115, v203
    v_max3_f32 v202, v116, v117, v202
    v_max3_f32 v203, v118, v119, v203
    v_mfma_f32_32x32x16_bf16 v[104:119], a[24:27], v[68:71], 0
    s_nop 11
    v_max3_f32 v202, v104, v105, v202
    v_max3_f32 v203, v106, v107, v203
    v_max3_f32 v202, v108, v109, v202
    v_max3_f32 v203, v110, v111, v203
    v_max3_f32 v202, v112, v113, v202
    v_max3_f32 v203, v114, v115, v203
    v_max3_f32 v202, v116, v117, v202
    v_max3_f32 v203, v118, v119, v203
    v_mfma_f32_32x32x16_bf16 v[104:119], a[20:23], v[68:71], 0
    s_nop 11
    v_max3_f32 v202, v104, v105, v202
    v_max3_f32 v203, v106, v107, v203
    v_max3_f32 v202, v108, v109, v202
    v_max3_f32 v203, v110, v111, v203
    v_max3_f32 v202, v112, v113, v202
    v_max3_f32 v203, v114, v115, v203
    v_max3_f32 v202, v116, v117, v202
    v_max3_f32 v203, v118, v119, v203
    v_mfma_f32_32x32x16_bf16 v[104:119], a[16:19], v[68:71], 0
    s_nop 11
    v_max3_f32 v202, v104, v105, v202
    v_max3_f32 v203, v106, v107, v203
    v_max3_f32 v202, v108, v109, v202
    v_max3_f32 v203, v110, v111, v203
    v_max3_f32 v202, v112, v113, v202
    v_max3_f32 v203, v114, v115, v203
    v_max3_f32 v202, v116, v117, v202
    v_max3_f32 v203, v118, v119, v203
    v_mfma_f32_32x32x16_bf16 v[104:119], a[12:15], v[68:71], 0
    s_nop 11
    v_max3_f32 v202, v104, v105, v202
    v_max3_f32 v203, v106, v107, v203
    v_max3_f32 v202, v108, v109, v202
    v_max3_f32 v203, v110, v111, v203
    v_max3_f32 v202, v112, v113, v202
    v_max3_f32 v203, v114, v115, v203
    v_max3_f32 v202, v116, v117, v202
    v_max3_f32 v203, v118, v119, v203
    v_mfma_f32_32x32x16_bf16 v[104:119], a[8:11], v[68:71], 0
    s_nop 11
    v_max3_f32 v202, v104, v105, v202
    v_max3_f32 v203, v106, v107, v203
    v_max3_f32 v202, v108, v109, v202
    v_max3_f32 v203, v110, v111, v203
    v_max3_f32 v202, v112, v113, v202
    v_max3_f32 v203, v114, v115, v203
    v_max3_f32 v202, v116, v117, v202
    v_max3_f32 v203, v118, v119, v203
    v_max_f32 v202, v202, v203
    v_mov_b32 v203, v202
    s_nop 1
    v_permlane32_swap_b32 v202, v203
    v_max_f32 v202, v202, v203
    v_cvt_pk_bf16_f32 v220, -v202, 0
    s_nop 1
    v_mfma_f32_32x32x16_bf16 v[136:151], v[212:215], v[220:223], 0
    v_mfma_f32_32x32x16_bf16 v[104:119], v[212:215], v[220:223], v[224:239]
    v_mfma_f32_32x32x16_bf16 v[104:119], a[36:39], v[68:71], v[104:119]
    s_nop 11
    v_exp_f32 v104, v104
    v_exp_f32 v105, v105
    v_exp_f32 v106, v106
    v_exp_f32 v107, v107
    v_exp_f32 v108, v108
    v_exp_f32 v109, v109
    v_exp_f32 v110, v110
    v_exp_f32 v111, v111
    v_exp_f32 v112, v112
    v_exp_f32 v113, v113
    v_exp_f32 v114, v114
    v_exp_f32 v115, v115
    v_exp_f32 v116, v116
    v_exp_f32 v117, v117
    v_exp_f32 v118, v118
    v_exp_f32 v119, v119
    v_cvt_pk_bf16_f32 v192, v104, v105
    v_cvt_pk_bf16_f32 v193, v106, v107
    v_cvt_pk_bf16_f32 v194, v108, v109
    v_cvt_pk_bf16_f32 v195, v110, v111
    v_cvt_pk_bf16_f32 v196, v112, v113
    v_cvt_pk_bf16_f32 v197, v114, v115
    v_cvt_pk_bf16_f32 v198, v116, v117
    v_cvt_pk_bf16_f32 v199, v118, v119
    v_mfma_f32_32x32x16_bf16 v[176:191], a[112:115], v[192:195], 0
    s_nop 0
    v_mfma_f32_32x32x16_bf16 v[176:191], a[116:119], v[196:199], v[176:191]
    v_mfma_f32_32x32x16_bf16 v[104:119], a[32:35], v[68:71], v[136:151]
    s_nop 11
    v_exp_f32 v104, v104
    v_exp_f32 v105, v105
    v_exp_f32 v106, v106
    v_exp_f32 v107, v107
    v_exp_f32 v108, v108
    v_exp_f32 v109, v109
    v_exp_f32 v110, v110
    v_exp_f32 v111, v111
    v_exp_f32 v112, v112
    v_exp_f32 v113, v113
    v_exp_f32 v114, v114
    v_exp_f32 v115, v115
    v_exp_f32 v116, v116
    v_exp_f32 v117, v117
    v_exp_f32 v118, v118
    v_exp_f32 v119, v119
    v_cvt_pk_bf16_f32 v192, v104, v105
    v_cvt_pk_bf16_f32 v193, v106, v107
    v_cvt_pk_bf16_f32 v194, v108, v109
    v_cvt_pk_bf16_f32 v195, v110, v111
    v_cvt_pk_bf16_f32 v196, v112, v113
    v_cvt_pk_bf16_f32 v197, v114, v115
    v_cvt_pk_bf16_f32 v198, v116, v117
    v_cvt_pk_bf16_f32 v199, v118, v119
    v_mfma_f32_32x32x16_bf16 v[176:191], a[104:107], v[192:195], v[176:191]
    s_nop 0
    v_mfma_f32_32x32x16_bf16 v[176:191], a[108:111], v[196:199], v[176:191]
    v_mfma_f32_32x32x16_bf16 v[104:119], a[28:31], v[68:71], v[136:151]
    s_nop 11
    v_exp_f32 v104, v104
    v_exp_f32 v105, v105
    v_exp_f32 v106, v106
    v_exp_f32 v107, v107
    v_exp_f32 v108, v108
    v_exp_f32 v109, v109
    v_exp_f32 v110, v110
    v_exp_f32 v111, v111
    v_exp_f32 v112, v112
    v_exp_f32 v113, v113
    v_exp_f32 v114, v114
    v_exp_f32 v115, v115
    v_exp_f32 v116, v116
    v_exp_f32 v117, v117
    v_exp_f32 v118, v118
    v_exp_f32 v119, v119
    v_cvt_pk_bf16_f32 v192, v104, v105
    v_cvt_pk_bf16_f32 v193, v106, v107
    v_cvt_pk_bf16_f32 v194, v108, v109
    v_cvt_pk_bf16_f32 v195, v110, v111
    v_cvt_pk_bf16_f32 v196, v112, v113
    v_cvt_pk_bf16_f32 v197, v114, v115
    v_cvt_pk_bf16_f32 v198, v116, v117
    v_cvt_pk_bf16_f32 v199, v118, v119
    v_mfma_f32_32x32x16_bf16 v[176:191], a[96:99], v[192:195], v[176:191]
    s_nop 0
    v_mfma_f32_32x32x16_bf16 v[176:191], a[100:103], v[196:199], v[176:191]
    v_mfma_f32_32x32x16_bf16 v[104:119], a[24:27], v[68:71], v[136:151]
    s_nop 11
    v_exp_f32 v104, v104
    v_exp_f32 v105, v105
    v_exp_f32 v106, v106
    v_exp_f32 v107, v107
    v_exp_f32 v108, v108
    v_exp_f32 v109, v109
    v_exp_f32 v110, v110
    v_exp_f32 v111, v111
    v_exp_f32 v112, v112
    v_exp_f32 v113, v113
    v_exp_f32 v114, v114
    v_exp_f32 v115, v115
    v_exp_f32 v116, v116
    v_exp_f32 v117, v117
    v_exp_f32 v118, v118
    v_exp_f32 v119, v119
    v_cvt_pk_bf16_f32 v192, v104, v105
    v_cvt_pk_bf16_f32 v193, v106, v107
    v_cvt_pk_bf16_f32 v194, v108, v109
    v_cvt_pk_bf16_f32 v195, v110, v111
    v_cvt_pk_bf16_f32 v196, v112, v113
    v_cvt_pk_bf16_f32 v197, v114, v115
    v_cvt_pk_bf16_f32 v198, v116, v117
    v_cvt_pk_bf16_f32 v199, v118, v119
    v_mfma_f32_32x32x16_bf16 v[176:191], a[88:91], v[192:195], v[176:191]
    s_nop 0
    v_mfma_f32_32x32x16_bf16 v[176:191], a[92:95], v[196:199], v[176:191]
    v_mfma_f32_32x32x16_bf16 v[104:119], a[20:23], v[68:71], v[136:151]
    s_nop 11
    v_exp_f32 v104, v104
    v_exp_f32 v105, v105
    v_exp_f32 v106, v106
    v_exp_f32 v107, v107
    v_exp_f32 v108, v108
    v_exp_f32 v109, v109
    v_exp_f32 v110, v110
    v_exp_f32 v111, v111
    v_exp_f32 v112, v112
    v_exp_f32 v113, v113
    v_exp_f32 v114, v114
    v_exp_f32 v115, v115
    v_exp_f32 v116, v116
    v_exp_f32 v117, v117
    v_exp_f32 v118, v118
    v_exp_f32 v119, v119
    v_cvt_pk_bf16_f32 v192, v104, v105
    v_cvt_pk_bf16_f32 v193, v106, v107
    v_cvt_pk_bf16_f32 v194, v108, v109
    v_cvt_pk_bf16_f32 v195, v110, v111
    v_cvt_pk_bf16_f32 v196, v112, v113
    v_cvt_pk_bf16_f32 v197, v114, v115
    v_cvt_pk_bf16_f32 v198, v116, v117
    v_cvt_pk_bf16_f32 v199, v118, v119
    v_mfma_f32_32x32x16_bf16 v[176:191], a[80:83], v[192:195], v[176:191]
    s_nop 0
    v_mfma_f32_32x32x16_bf16 v[176:191], a[84:87], v[196:199], v[176:191]
    v_mfma_f32_32x32x16_bf16 v[104:119], a[16:19], v[68:71], v[136:151]
    s_nop 11
    v_exp_f32 v104, v104
    v_exp_f32 v105, v105
    v_exp_f32 v106, v106
    v_exp_f32 v107, v107
    v_exp_f32 v108, v108
    v_exp_f32 v109, v109
    v_exp_f32 v110, v110
    v_exp_f32 v111, v111
    v_exp_f32 v112, v112
    v_exp_f32 v113, v113
    v_exp_f32 v114, v114
    v_exp_f32 v115, v115
    v_exp_f32 v116, v116
    v_exp_f32 v117, v117
    v_exp_f32 v118, v118
    v_exp_f32 v119, v119
    v_cvt_pk_bf16_f32 v192, v104, v105
    v_cvt_pk_bf16_f32 v193, v106, v107
    v_cvt_pk_bf16_f32 v194, v108, v109
    v_cvt_pk_bf16_f32 v195, v110, v111
    v_cvt_pk_bf16_f32 v196, v112, v113
    v_cvt_pk_bf16_f32 v197, v114, v115
    v_cvt_pk_bf16_f32 v198, v116, v117
    v_cvt_pk_bf16_f32 v199, v118, v119
    v_mfma_f32_32x32x16_bf16 v[176:191], a[72:75], v[192:195], v[176:191]
    s_nop 0
    v_mfma_f32_32x32x16_bf16 v[176:191], a[76:79], v[196:199], v[176:191]
    v_mfma_f32_32x32x16_bf16 v[104:119], a[12:15], v[68:71], v[136:151]
    s_nop 11
    v_exp_f32 v104, v104
    v_exp_f32 v105, v105
    v_exp_f32 v106, v106
    v_exp_f32 v107, v107
    v_exp_f32 v108, v108
    v_exp_f32 v109, v109
    v_exp_f32 v110, v110
    v_exp_f32 v111, v111
    v_exp_f32 v112, v112
    v_exp_f32 v113, v113
    v_exp_f32 v114, v114
    v_exp_f32 v115, v115
    v_exp_f32 v116, v116
    v_exp_f32 v117, v117
    v_exp_f32 v118, v118
    v_exp_f32 v119, v119
    v_cvt_pk_bf16_f32 v192, v104, v105
    v_cvt_pk_bf16_f32 v193, v106, v107
    v_cvt_pk_bf16_f32 v194, v108, v109
    v_cvt_pk_bf16_f32 v195, v110, v111
    v_cvt_pk_bf16_f32 v196, v112, v113
    v_cvt_pk_bf16_f32 v197, v114, v115
    v_cvt_pk_bf16_f32 v198, v116, v117
    v_cvt_pk_bf16_f32 v199, v118, v119
    v_mfma_f32_32x32x16_bf16 v[176:191], a[64:67], v[192:195], v[176:191]
    s_nop 0
    v_mfma_f32_32x32x16_bf16 v[176:191], a[68:71], v[196:199], v[176:191]
    v_mfma_f32_32x32x16_bf16 v[104:119], a[8:11], v[68:71], v[136:151]
    s_nop 11
    v_exp_f32 v104, v104
    v_exp_f32 v105, v105
    v_exp_f32 v106, v106
    v_exp_f32 v107, v107
    v_exp_f32 v108, v108
    v_exp_f32 v109, v109
    v_exp_f32 v110, v110
    v_exp_f32 v111, v111
    v_exp_f32 v112, v112
    v_exp_f32 v113, v113
    v_exp_f32 v114, v114
    v_exp_f32 v115, v115
    v_exp_f32 v116, v116
    v_exp_f32 v117, v117
    v_exp_f32 v118, v118
    v_exp_f32 v119, v119
    v_cvt_pk_bf16_f32 v192, v104, v105
    v_cvt_pk_bf16_f32 v193, v106, v107
    v_cvt_pk_bf16_f32 v194, v108, v109
    v_cvt_pk_bf16_f32 v195, v110, v111
    v_cvt_pk_bf16_f32 v196, v112, v113
    v_cvt_pk_bf16_f32 v197, v114, v115
    v_cvt_pk_bf16_f32 v198, v116, v117
    v_cvt_pk_bf16_f32 v199, v118, v119
    v_mfma_f32_32x32x16_bf16 v[176:191], a[56:59], v[192:195], v[176:191]
    s_nop 0
    v_mfma_f32_32x32x16_bf16 v[176:191], a[60:63], v[196:199], v[176:191]
    s_nop 15
    s_branch L_exact_18_back
L_att_small:
    s_cmp_eq_u32 s63, 0
    s_cbranch_scc1 L_att_t0
    s_cmp_eq_u32 s63, 1
    s_cbranch_scc1 L_att_t1
    s_cmp_eq_u32 s63, 2
    s_cbranch_scc1 L_att_t2
    s_branch L_att_t3
L_att_t0:
    buffer_load_dwordx4 a[36:39], v207, s[28:31], s94 offen sc1
    s_mov_b32 exec_lo, 0xffff
    s_mov_b32 exec_hi, 0xffff
    buffer_load_dwordx4 a[112:115], v206, s[28:31], s94 offen offset:0 sc1
    buffer_load_dwordx4 a[116:119], v206, s[28:31], s94 offen offset:512 sc1
    s_mov_b64 exec, -1
    s_waitcnt vmcnt(17)
    v_mfma_f32_32x32x16_bf16 v[104:119], a[32:35], v[64:67], v[224:239]
    s_add_u32 m0, s54, 32768
    s_add_u32 s78, s55, 0
    buffer_load_dwordx4 v208, s[16:19], s78 offen offset:0 lds
    buffer_load_dwordx4 v209, s[16:19], s78 offen offset:1024 lds
    s_nop 7
    v_max3_f32 v200, v104, v105, v106
    v_max3_f32 v201, v107, v108, v109
    v_max3_f32 v200, v110, v111, v200
    v_max3_f32 v201, v112, v113, v201
    v_max3_f32 v200, v114, v115, v200
    v_max3_f32 v201, v116, v117, v201
    v_max3_f32 v200, v118, v119, v200
    v_max_f32 v200, v200, v201
    v_mov_b32 v201, v200
    s_nop 1
    v_permlane32_swap_b32 v200, v201
    v_max_f32 v200, v200, v201
    v_cvt_pk_bf16_f32 v216, -v200, 0
    s_nop 1
    v_mfma_f32_32x32x16_bf16 v[120:135], v[212:215], v[216:219], 0
    s_waitcnt vmcnt(4)
    v_mfma_f32_32x32x16_bf16 v[104:119], a[36:39], v[68:71], v[224:239]
    s_nop 11
    v_max3_f32 v202, v104, v105, v106
    v_max3_f32 v203, v107, v108, v109
    v_max3_f32 v202, v110, v111, v202
    v_max3_f32 v203, v112, v113, v203
    v_max3_f32 v202, v114, v115, v202
    v_max3_f32 v203, v116, v117, v203
    v_max3_f32 v202, v118, v119, v202
    v_max_f32 v202, v202, v203
    v_mov_b32 v203, v202
    s_nop 1
    v_permlane32_swap_b32 v202, v203
    v_max_f32 v202, v202, v203
    v_cvt_pk_bf16_f32 v220, -v202, 0
    s_nop 1
    v_mfma_f32_32x32x16_bf16 v[136:151], v[212:215], v[220:223], 0
    v_mfma_f32_32x32x16_bf16 v[72:87], v[212:215], v[216:219], v[224:239]
    v_mfma_f32_32x32x16_bf16 v[72:87], a[32:35], v[64:67], v[72:87]
    s_nop 11
    v_exp_f32 v72, v72
    v_exp_f32 v73, v73
    v_exp_f32 v74, v74
    v_exp_f32 v75, v75
    v_exp_f32 v76, v76
    v_cvt_pk_bf16_f32 v152, v72, v73
    v_mfma_f32_32x32x16_bf16 v[88:103], v[212:215], v[220:223], v[224:239]
    v_exp_f32 v77, v77
    v_cvt_pk_bf16_f32 v153, v74, v75
    v_exp_f32 v78, v78
    v_exp_f32 v79, v79
    v_mfma_f32_32x32x16_bf16 v[88:103], a[36:39], v[68:71], v[88:103]
    v_exp_f32 v80, v80
    v_cvt_pk_bf16_f32 v154, v76, v77
    v_exp_f32 v81, v81
    v_cvt_pk_bf16_f32 v155, v78, v79
    v_exp_f32 v82, v82
    v_exp_f32 v83, v83
    v_mfma_f32_32x32x16_bf16 v[160:175], a[104:107], v[152:155], 0
    s_add_u32 m0, s54, 34816
    s_add_u32 s78, s55, 28672
    buffer_load_dwordx4 v208, s[16:19], s78 offen offset:0 lds
    buffer_load_dwordx4 v209, s[16:19], s78 offen offset:1024 lds
    v_exp_f32 v84, v84
    v_cvt_pk_bf16_f32 v156, v80, v81
    v_exp_f32 v85, v85
    v_cvt_pk_bf16_f32 v157, v82, v83
    v_exp_f32 v86, v86
    v_exp_f32 v87, v87
    v_cvt_pk_bf16_f32 v158, v84, v85
    s_add_u32 m0, s54, 36864
    s_add_u32 s78, s55, 57344
    buffer_load_dwordx4 v208, s[16:19], s78 offen offset:0 lds
    buffer_load_dwordx4 v209, s[16:19], s78 offen offset:1024 lds
    v_cvt_pk_bf16_f32 v159, v86, v87
    v_exp_f32 v88, v88
    v_exp_f32 v89, v89
    v_mfma_f32_32x32x16_bf16 v[160:175], a[108:111], v[156:159], v[160:175]
    v_exp_f32 v90, v90
    v_exp_f32 v91, v91
    v_exp_f32 v92, v92
    v_cvt_pk_bf16_f32 v152, v88, v89
    v_mfma_f32_32x32x16_bf16 v[72:87], a[32:35], v[68:71], v[136:151]
    v_exp_f32 v93, v93
    v_cvt_pk_bf16_f32 v153, v90, v91
    v_exp_f32 v94, v94
    v_exp_f32 v95, v95
    v_exp_f32 v96, v96
    v_cvt_pk_bf16_f32 v154, v92, v93
    v_exp_f32 v97, v97
    v_cvt_pk_bf16_f32 v155, v94, v95
    v_exp_f32 v98, v98
    v_exp_f32 v99, v99
    s_waitcnt vmcnt(7)
    v_mfma_f32_32x32x16_bf16 v[176:191], a[112:115], v[152:155], 0
    s_add_u32 m0, s54, 38912
    s_add_u32 s78, s55, 86016
    buffer_load_dwordx4 v208, s[16:19], s78 offen offset:0 lds
    buffer_load_dwordx4 v209, s[16:19], s78 offen offset:1024 lds
    v_exp_f32 v100, v100
    v_cvt_pk_bf16_f32 v156, v96, v97
    v_exp_f32 v101, v101
    v_cvt_pk_bf16_f32 v157, v98, v99
    v_exp_f32 v102, v102
    v_exp_f32 v103, v103
    v_cmp_nge_f32 vcc, 0x53800000, v168
    s_nop 0
    s_cbranch_vccnz L_exact_7
L_exact_7_back:
    v_rcp_f32 v204, v168
    s_nop 0
    v_mul_f32 v160, v204, v160
    v_mul_f32 v161, v204, v161
    v_mul_f32 v162, v204, v162
    v_mul_f32 v163, v204, v163
    v_mul_f32 v164, v204, v164
    v_mul_f32 v165, v204, v165
    v_mul_f32 v166, v204, v166
    v_mul_f32 v167, v204, v167
    v_cvt_pk_bf16_f32 v192, v160, v161
    v_cvt_pk_bf16_f32 v193, v162, v163
    v_cvt_pk_bf16_f32 v194, v164, v165
    v_cvt_pk_bf16_f32 v195, v166, v167
    buffer_store_dwordx4 v[192:195], v1, s[28:31], s57 offen sc1
    v_cvt_pk_bf16_f32 v158, v100, v101
    s_add_u32 m0, s54, 0
    s_add_u32 s78, s40, 0
    buffer_load_dwordx4 v11, s[20:23], s78 offen offset:0 lds
    buffer_load_dwordx4 v12, s[20:23], s78 offen offset:1024 lds
    v_cvt_pk_bf16_f32 v159, v102, v103
    v_exp_f32 v72, v72
    v_exp_f32 v73, v73
    s_waitcnt vmcnt(11)
    v_mfma_f32_32x32x16_bf16 v[176:191], a[116:119], v[156:159], v[176:191]
    v_exp_f32 v74, v74
    v_exp_f32 v75, v75
    v_exp_f32 v76, v76
    v_cvt_pk_bf16_f32 v152, v72, v73
    v_exp_f32 v77, v77
    v_cvt_pk_bf16_f32 v153, v74, v75
    v_exp_f32 v78, v78
    v_exp_f32 v79, v79
    v_exp_f32 v80, v80
    v_cvt_pk_bf16_f32 v154, v76, v77
    v_exp_f32 v81, v81
    v_cvt_pk_bf16_f32 v155, v78, v79
    v_exp_f32 v82, v82
    v_exp_f32 v83, v83
    v_mfma_f32_32x32x16_bf16 v[176:191], a[104:107], v[152:155], v[176:191]
    s_add_u32 m0, s54, 2048
    s_add_u32 s78, s40, 16384
    buffer_load_dwordx4 v11, s[20:23], s78 offen offset:0 lds
    buffer_load_dwordx4 v12, s[20:23], s78 offen offset:1024 lds
    v_exp_f32 v84, v84
    v_cvt_pk_bf16_f32 v156, v80, v81
    v_exp_f32 v85, v85
    v_cvt_pk_bf16_f32 v157, v82, v83
    v_exp_f32 v86, v86
    v_exp_f32 v87, v87
    v_cvt_pk_bf16_f32 v158, v84, v85
    s_add_u32 m0, s54, 4096
    s_add_u32 s78, s40, 32768
    buffer_load_dwordx4 v11, s[20:23], s78 offen offset:0 lds
    buffer_load_dwordx4 v12, s[20:23], s78 offen offset:1024 lds
    v_cvt_pk_bf16_f32 v159, v86, v87
    s_waitcnt vmcnt(6)
    s_barrier
    s_cmp_lg_u32 s62, 0
    s_cbranch_scc1 L_nofl_8
    s_lshl_b32 s82, s58, 5
    s_add_u32 s82, s82, 16777216
    s_mov_b64 exec, 1
    buffer_store_dword v7, v6, s[28:31], s82 offen sc1
    s_mov_b64 exec, -1
L_nofl_8:
    v_and_b32 v5, -13, v9
    v_lshlrev_b32 v5, 5, v5
    s_lshl_b32 s84, s59, 5
    s_add_u32 s84, s84, 16777216
    buffer_load_dword v8, v5, s[28:31], s84 offen sc1
    s_nop 1
    v_mfma_f32_32x32x16_bf16 v[176:191], a[108:111], v[156:159], v[176:191]
    s_nop 11
    v_cmp_nge_f32 vcc, 0x53800000, v184
    s_nop 0
    s_cbranch_vccnz L_exact_9
L_exact_9_back:
    v_rcp_f32 v204, v184
    s_add_u32 s79, s57, 32768
    v_mul_f32 v176, v204, v176
    v_mul_f32 v177, v204, v177
    v_mul_f32 v178, v204, v178
    v_mul_f32 v179, v204, v179
    v_mul_f32 v180, v204, v180
    v_mul_f32 v181, v204, v181
    v_mul_f32 v182, v204, v182
    v_mul_f32 v183, v204, v183
    v_cvt_pk_bf16_f32 v196, v176, v177
    v_cvt_pk_bf16_f32 v197, v178, v179
    v_cvt_pk_bf16_f32 v198, v180, v181
    v_cvt_pk_bf16_f32 v199, v182, v183
    buffer_store_dwordx4 v[196:199], v1, s[28:31], s79 offen sc1
    s_add_u32 m0, s54, 65536
    s_add_u32 s78, s55, 458752
    buffer_load_dwordx4 v208, s[16:19], s78 offen offset:0 lds
    buffer_load_dwordx4 v209, s[16:19], s78 offen offset:1024 lds
    s_add_u32 m0, s54, 67584
    s_add_u32 s78, s55, 487424
    buffer_load_dwordx4 v208, s[16:19], s78 offen offset:0 lds
    buffer_load_dwordx4 v209, s[16:19], s78 offen offset:1024 lds
    s_add_u32 m0, s54, 69632
    s_add_u32 s78, s55, 516096
    buffer_load_dwordx4 v208, s[16:19], s78 offen offset:0 lds
    buffer_load_dwordx4 v209, s[16:19], s78 offen offset:1024 lds
    s_add_u32 m0, s54, 71680
    s_add_u32 s78, s55, 544768
    buffer_load_dwordx4 v208, s[16:19], s78 offen offset:0 lds
    buffer_load_dwordx4 v209, s[16:19], s78 offen offset:1024 lds
    s_waitcnt vmcnt(10)
    ds_read_b64_tr_b16 a[184:185], v15 offset:0
    ds_read_b64_tr_b16 a[186:187], v15 offset:1024
    ds_read_b64_tr_b16 a[188:189], v16 offset:0
    ds_read_b64_tr_b16 a[190:191], v16 offset:1024
    ds_read_b64_tr_b16 a[192:193], v15 offset:2048
    ds_read_b64_tr_b16 a[194:195], v15 offset:3072
    ds_read_b64_tr_b16 a[196:197], v16 offset:2048
    ds_read_b64_tr_b16 a[198:199], v16 offset:3072
    ds_read_b64_tr_b16 a[200:201], v15 offset:4096
    ds_read_b64_tr_b16 a[202:203], v15 offset:5120
    ds_read_b64_tr_b16 a[204:205], v16 offset:4096
    ds_read_b64_tr_b16 a[206:207], v16 offset:5120
    s_add_u32 m0, s54, 98304
    s_add_u32 s78, s55, 917504
    buffer_load_dwordx4 v208, s[16:19], s78 offen offset:0 lds
    buffer_load_dwordx4 v209, s[16:19], s78 offen offset:1024 lds
    s_waitcnt lgkmcnt(0)
    s_add_u32 m0, s54, 0
    s_add_u32 s78, s40, 49152
    buffer_load_dwordx4 v11, s[20:23], s78 offen offset:0 lds
    buffer_load_dwordx4 v12, s[20:23], s78 offen offset:1024 lds
    s_add_u32 m0, s54, 2048
    s_add_u32 s78, s40, 65536
    buffer_load_dwordx4 v11, s[20:23], s78 offen offset:0 lds
    buffer_load_dwordx4 v12, s[20:23], s78 offen offset:1024 lds
    s_add_u32 m0, s54, 4096
    s_add_u32 s78, s40, 81920
    buffer_load_dwordx4 v11, s[20:23], s78 offen offset:0 lds
    buffer_load_dwordx4 v12, s[20:23], s78 offen offset:1024 lds
    s_add_u32 m0, s54, 100352
    s_add_u32 s78, s55, 946176
    buffer_load_dwordx4 v208, s[16:19], s78 offen offset:0 lds
    buffer_load_dwordx4 v209, s[16:19], s78 offen offset:1024 lds
    s_add_u32 m0, s54, 102400
    s_add_u32 s78, s55, 974848
    buffer_load_dwordx4 v208, s[16:19], s78 offen offset:0 lds
    buffer_load_dwordx4 v209, s[16:19], s78 offen offset:1024 lds
    s_add_u32 m0, s54, 104448
    s_add_u32 s78, s55, 1003520
    buffer_load_dwordx4 v208, s[16:19], s78 offen offset:0 lds
    buffer_load_dwordx4 v209, s[16:19], s78 offen offset:1024 lds
    s_waitcnt vmcnt(6)
    ds_read_b64_tr_b16 a[208:209], v15 offset:0
    ds_read_b64_tr_b16 a[210:211], v15 offset:1024
    ds_read_b64_tr_b16 a[212:213], v16 offset:0
    ds_read_b64_tr_b16 a[214:215], v16 offset:1024
    ds_read_b64_tr_b16 a[216:217], v15 offset:2048
    ds_read_b64_tr_b16 a[218:219], v15 offset:3072
    ds_read_b64_tr_b16 a[220:221], v16 offset:2048
    ds_read_b64_tr_b16 a[222:223], v16 offset:3072
    ds_read_b64_tr_b16 a[224:225], v15 offset:4096
    ds_read_b64_tr_b16 a[226:227], v15 offset:5120
    ds_read_b64_tr_b16 a[228:229], v16 offset:4096
    ds_read_b64_tr_b16 a[230:231], v16 offset:5120
    s_add_u32 m0, s54, 131072
    s_add_u32 s78, s55, 1376256
    buffer_load_dwordx4 v208, s[16:19], s78 offen offset:0 lds
    buffer_load_dwordx4 v209, s[16:19], s78 offen offset:1024 lds
    s_waitcnt lgkmcnt(0)
    s_add_u32 m0, s54, 0
    s_add_u32 s78, s40, 98304
    buffer_load_dwordx4 v11, s[20:23], s78 offen offset:0 lds
    buffer_load_dwordx4 v12, s[20:23], s78 offen offset:1024 lds
    s_add_u32 m0, s54, 2048
    s_add_u32 s78, s40, 114688
    buffer_load_dwordx4 v11, s[20:23], s78 offen offset:0 lds
    buffer_load_dwordx4 v12, s[20:23], s78 offen offset:1024 lds
    s_add_u32 m0, s54, 4096
    s_add_u32 s78, s40, 131072
    buffer_load_dwordx4 v11, s[20:23], s78 offen offset:0 lds
    buffer_load_dwordx4 v12, s[20:23], s78 offen offset:1024 lds
    s_add_u32 m0, s54, 133120
    s_add_u32 s78, s55, 1404928
    buffer_load_dwordx4 v208, s[16:19], s78 offen offset:0 lds
    buffer_load_dwordx4 v209, s[16:19], s78 offen offset:1024 lds
    s_add_u32 m0, s54, 135168
    s_add_u32 s78, s55, 1433600
    buffer_load_dwordx4 v208, s[16:19], s78 offen offset:0 lds
    buffer_load_dwordx4 v209, s[16:19], s78 offen offset:1024 lds
    s_add_u32 m0, s54, 137216
    s_add_u32 s78, s55, 1462272
    buffer_load_dwordx4 v208, s[16:19], s78 offen offset:0 lds
    buffer_load_dwordx4 v209, s[16:19], s78 offen offset:1024 lds
    s_waitcnt vmcnt(6)
    ds_read_b64_tr_b16 a[232:233], v15 offset:0
    ds_read_b64_tr_b16 a[234:235], v15 offset:1024
    ds_read_b64_tr_b16 a[236:237], v16 offset:0
    ds_read_b64_tr_b16 a[238:239], v16 offset:1024
    ds_read_b64_tr_b16 a[240:241], v15 offset:2048
    ds_read_b64_tr_b16 a[242:243], v15 offset:3072
    ds_read_b64_tr_b16 a[244:245], v16 offset:2048
    ds_read_b64_tr_b16 a[246:247], v16 offset:3072
    ds_read_b64_tr_b16 a[248:249], v15 offset:4096
    ds_read_b64_tr_b16 a[250:251], v15 offset:5120
    ds_read_b64_tr_b16 a[252:253], v16 offset:4096
    ds_read_b64_tr_b16 a[254:255], v16 offset:5120
    s_waitcnt vmcnt(0)
    s_branch L_att_done
L_att_t1:
    buffer_load_dwordx4 a[36:39], v207, s[28:31], s94 offen sc1
    s_mov_b32 exec_lo, 0xffff
    s_mov_b32 exec_hi, 0xffff
    buffer_load_dwordx4 a[112:115], v206, s[28:31], s94 offen offset:0 sc1
    buffer_load_dwordx4 a[116:119], v206, s[28:31], s94 offen offset:512 sc1
    s_mov_b64 exec, -1
    s_waitcnt vmcnt(17)
    v_mfma_f32_32x32x16_bf16 v[104:119], a[32:35], v[64:67], v[224:239]
    s_add_u32 m0, s54, 32768
    s_add_u32 s78, s55, 0
    buffer_load_dwordx4 v208, s[16:19], s78 offen offset:0 lds
    buffer_load_dwordx4 v209, s[16:19], s78 offen offset:1024 lds
    s_nop 7
    v_max3_f32 v200, v104, v105, v106
    v_max3_f32 v201, v107, v108, v109
    v_max3_f32 v200, v110, v111, v200
    v_max3_f32 v201, v112, v113, v201
    v_max3_f32 v200, v114, v115, v200
    v_max3_f32 v201, v116, v117, v201
    v_max3_f32 v200, v118, v119, v200
    v_max_f32 v200, v200, v201
    v_mov_b32 v201, v200
    s_nop 1
    v_permlane32_swap_b32 v200, v201
    v_max_f32 v200, v200, v201
    v_cvt_pk_bf16_f32 v216, -v200, 0
    s_nop 1
    v_mfma_f32_32x32x16_bf16 v[120:135], v[212:215], v[216:219], 0
    s_waitcnt vmcnt(4)
    v_mfma_f32_32x32x16_bf16 v[104:119], a[36:39], v[68:71], v[224:239]
    s_nop 11
    v_max3_f32 v202, v104, v105, v106
    v_max3_f32 v203, v107, v108, v109
    v_max3_f32 v202, v110, v111, v202
    v_max3_f32 v203, v112, v113, v203
    v_max3_f32 v202, v114, v115, v202
    v_max3_f32 v203, v116, v117, v203
    v_max3_f32 v202, v118, v119, v202
    v_max_f32 v202, v202, v203
    v_mov_b32 v203, v202
    s_nop 1
    v_permlane32_swap_b32 v202, v203
    v_max_f32 v202, v202, v203
    v_cvt_pk_bf16_f32 v220, -v202, 0
    s_nop 1
    v_mfma_f32_32x32x16_bf16 v[136:151], v[212:215], v[220:223], 0
    v_mfma_f32_32x32x16_bf16 v[72:87], v[212:215], v[216:219], v[224:239]
    v_mfma_f32_32x32x16_bf16 v[72:87], a[32:35], v[64:67], v[72:87]
    s_nop 11
    v_exp_f32 v72, v72
    v_exp_f32 v73, v73
    v_exp_f32 v74, v74
    v_exp_f32 v75, v75
    v_exp_f32 v76, v76
    v_cvt_pk_bf16_f32 v152, v72, v73
    v_mfma_f32_32x32x16_bf16 v[88:103], a[28:31], v[64:67], v[120:135]
    v_exp_f32 v77, v77
    v_cvt_pk_bf16_f32 v153, v74, v75
    v_exp_f32 v78, v78
    v_exp_f32 v79, v79
    v_exp_f32 v80, v80
    v_cvt_pk_bf16_f32 v154, v76, v77
    v_exp_f32 v81, v81
    v_cvt_pk_bf16_f32 v155, v78, v79
    v_exp_f32 v82, v82
    v_exp_f32 v83, v83
    v_mfma_f32_32x32x16_bf16 v[160:175], a[104:107], v[152:155], 0
    s_add_u32 m0, s54, 34816
    s_add_u32 s78, s55, 28672
    buffer_load_dwordx4 v208, s[16:19], s78 offen offset:0 lds
    buffer_load_dwordx4 v209, s[16:19], s78 offen offset:1024 lds
    v_exp_f32 v84, v84
    v_cvt_pk_bf16_f32 v156, v80, v81
    v_exp_f32 v85, v85
    v_cvt_pk_bf16_f32 v157, v82, v83
    v_exp_f32 v86, v86
    v_exp_f32 v87, v87
    v_cvt_pk_bf16_f32 v158, v84, v85
    s_add_u32 m0, s54, 36864
    s_add_u32 s78, s55, 57344
    buffer_load_dwordx4 v208, s[16:19], s78 offen offset:0 lds
    buffer_load_dwordx4 v209, s[16:19], s78 offen offset:1024 lds
    v_cvt_pk_bf16_f32 v159, v86, v87
    v_exp_f32 v88, v88
    v_exp_f32 v89, v89
    v_mfma_f32_32x32x16_bf16 v[160:175], a[108:111], v[156:159], v[160:175]
    v_exp_f32 v90, v90
    v_exp_f32 v91, v91
    v_exp_f32 v92, v92
    v_cvt_pk_bf16_f32 v152, v88, v89
    v_mfma_f32_32x32x16_bf16 v[72:87], a[24:27], v[64:67], v[120:135]
    v_exp_f32 v93, v93
    v_cvt_pk_bf16_f32 v153, v90, v91
    v_exp_f32 v94, v94
    v_exp_f32 v95, v95
    v_exp_f32 v96, v96
    v_cvt_pk_bf16_f32 v154, v92, v93
    v_exp_f32 v97, v97
    v_cvt_pk_bf16_f32 v155, v94, v95
    v_exp_f32 v98, v98
    v_exp_f32 v99, v99
    v_mfma_f32_32x32x16_bf16 v[160:175], a[96:99], v[152:155], v[160:175]
    s_add_u32 m0, s54, 38912
    s_add_u32 s78, s55, 86016
    buffer_load_dwordx4 v208, s[16:19], s78 offen offset:0 lds
    buffer_load_dwordx4 v209, s[16:19], s78 offen offset:1024 lds
    v_exp_f32 v100, v100
    v_cvt_pk_bf16_f32 v156, v96, v97
    v_exp_f32 v101, v101
    v_cvt_pk_bf16_f32 v157, v98, v99
    v_exp_f32 v102, v102
    v_exp_f32 v103, v103
    v_cvt_pk_bf16_f32 v158, v100, v101
    s_add_u32 m0, s54, 0
    s_add_u32 s78, s40, 0
    buffer_load_dwordx4 v11, s[20:23], s78 offen offset:0 lds
    buffer_load_dwordx4 v12, s[20:23], s78 offen offset:1024 lds
    v_cvt_pk_bf16_f32 v159, v102, v103
    v_exp_f32 v72, v72
    v_exp_f32 v73, v73
    v_mfma_f32_32x32x16_bf16 v[160:175], a[100:103], v[156:159], v[160:175]
    v_exp_f32 v74, v74
    v_exp_f32 v75, v75
    v_exp_f32 v76, v76
    v_cvt_pk_bf16_f32 v152, v72, v73
    v_mfma_f32_32x32x16_bf16 v[88:103], v[212:215], v[220:223], v[224:239]
    v_exp_f32 v77, v77
    v_cvt_pk_bf16_f32 v153, v74, v75
    v_exp_f32 v78, v78
    v_exp_f32 v79, v79
    v_mfma_f32_32x32x16_bf16 v[88:103], a[36:39], v[68:71], v[88:103]
    v_exp_f32 v80, v80
    v_cvt_pk_bf16_f32 v154, v76, v77
    v_exp_f32 v81, v81
    v_cvt_pk_bf16_f32 v155, v78, v79
    v_exp_f32 v82, v82
    v_exp_f32 v83, v83
    v_mfma_f32_32x32x16_bf16 v[160:175], a[88:91], v[152:155], v[160:175]
    s_add_u32 m0, s54, 2048
    s_add_u32 s78, s40, 16384
    buffer_load_dwordx4 v11, s[20:23], s78 offen offset:0 lds
    buffer_load_dwordx4 v12, s[20:23], s78 offen offset:1024 lds
    v_exp_f32 v84, v84
    v_cvt_pk_bf16_f32 v156, v80, v81
    v_exp_f32 v85, v85
    v_cvt_pk_bf16_f32 v157, v82, v83
    v_exp_f32 v86, v86
    v_exp_f32 v87, v87
    v_cvt_pk_bf16_f32 v158, v84, v85
    s_add_u32 m0, s54, 4096
    s_add_u32 s78, s40, 32768
    buffer_load_dwordx4 v11, s[20:23], s78 offen offset:0 lds
    buffer_load_dwordx4 v12, s[20:23], s78 offen offset:1024 lds
    v_cvt_pk_bf16_f32 v159, v86, v87
    v_exp_f32 v88, v88
    v_exp_f32 v89, v89
    v_mfma_f32_32x32x16_bf16 v[160:175], a[92:95], v[156:159], v[160:175]
    v_exp_f32 v90, v90
    v_exp_f32 v91, v91
    v_exp_f32 v92, v92
    v_cvt_pk_bf16_f32 v152, v88, v89
    v_mfma_f32_32x32x16_bf16 v[72:87], a[32:35], v[68:71], v[136:151]
    v_exp_f32 v93, v93
    v_cvt_pk_bf16_f32 v153, v90, v91
    v_exp_f32 v94, v94
    v_exp_f32 v95, v95
    v_exp_f32 v96, v96
    v_cvt_pk_bf16_f32 v154, v92, v93
    v_exp_f32 v97, v97
    v_cvt_pk_bf16_f32 v155, v94, v95
    v_exp_f32 v98, v98
    v_exp_f32 v99, v99
    s_waitcnt vmcnt(15)
    v_mfma_f32_32x32x16_bf16 v[176:191], a[112:115], v[152:155], 0
    s_add_u32 m0, s54, 65536
    s_add_u32 s78, s55, 458752
    buffer_load_dwordx4 v208, s[16:19], s78 offen offset:0 lds
    buffer_load_dwordx4 v209, s[16:19], s78 offen offset:1024 lds
    v_exp_f32 v100, v100
    v_cvt_pk_bf16_f32 v156, v96, v97
    v_exp_f32 v101, v101
    v_cvt_pk_bf16_f32 v157, v98, v99
    v_exp_f32 v102, v102
    v_exp_f32 v103, v103
    v_cmp_nge_f32 vcc, 0x53800000, v168
    s_nop 0
    s_cbranch_vccnz L_exact_10
L_exact_10_back:
    v_rcp_f32 v204, v168
    s_nop 0
    v_mul_f32 v160, v204, v160
    v_mul_f32 v161, v204, v161
    v_mul_f32 v162, v204, v162
    v_mul_f32 v163, v204, v163
    v_mul_f32 v164, v204, v164
    v_mul_f32 v165, v204, v165
    v_mul_f32 v166, v204, v166
    v_mul_f32 v167, v204, v167
    v_cvt_pk_bf16_f32 v192, v160, v161
    v_cvt_pk_bf16_f32 v193, v162, v163
    v_cvt_pk_bf16_f32 v194, v164, v165
    v_cvt_pk_bf16_f32 v195, v166, v167
    buffer_store_dwordx4 v[192:195], v1, s[28:31], s57 offen sc1
    v_cvt_pk_bf16_f32 v158, v100, v101
    s_add_u32 m0, s54, 67584
    s_add_u32 s78, s55, 487424
    buffer_load_dwordx4 v208, s[16:19], s78 offen offset:0 lds
    buffer_load_dwordx4 v209, s[16:19], s78 offen offset:1024 lds
    v_cvt_pk_bf16_f32 v159, v102, v103
    v_exp_f32 v72, v72
    v_exp_f32 v73, v73
    s_waitcnt vmcnt(19)
    v_mfma_f32_32x32x16_bf16 v[176:191], a[116:119], v[156:159], v[176:191]
    v_exp_f32 v74, v74
    v_exp_f32 v75, v75
    v_exp_f32 v76, v76
    v_cvt_pk_bf16_f32 v152, v72, v73
    v_mfma_f32_32x32x16_bf16 v[88:103], a[28:31], v[68:71], v[136:151]
    v_exp_f32 v77, v77
    v_cvt_pk_bf16_f32 v153, v74, v75
    v_exp_f32 v78, v78
    v_exp_f32 v79, v79
    v_exp_f32 v80, v80
    v_cvt_pk_bf16_f32 v154, v76, v77
    v_exp_f32 v81, v81
    v_cvt_pk_bf16_f32 v155, v78, v79
    v_exp_f32 v82, v82
    v_exp_f32 v83, v83
    v_mfma_f32_32x32x16_bf16 v[176:191], a[104:107], v[152:155], v[176:191]
    s_add_u32 m0, s54, 69632
    s_add_u32 s78, s55, 516096
    buffer_load_dwordx4 v208, s[16:19], s78 offen offset:0 lds
    buffer_load_dwordx4 v209, s[16:19], s78 offen offset:1024 lds
    v_exp_f32 v84, v84
    v_cvt_pk_bf16_f32 v156, v80, v81
    v_exp_f32 v85, v85
    v_cvt_pk_bf16_f32 v157, v82, v83
    v_exp_f32 v86, v86
    v_exp_f32 v87, v87
    v_cvt_pk_bf16_f32 v158, v84, v85
    s_add_u32 m0, s54, 71680
    s_add_u32 s78, s55, 544768
    buffer_load_dwordx4 v208, s[16:19], s78 offen offset:0 lds
    buffer_load_dwordx4 v209, s[16:19], s78 offen offset:1024 lds
    v_cvt_pk_bf16_f32 v159, v86, v87
    v_exp_f32 v88, v88
    v_exp_f32 v89, v89
    v_mfma_f32_32x32x16_bf16 v[176:191], a[108:111], v[156:159], v[176:191]
    v_exp_f32 v90, v90
    v_exp_f32 v91, v91
    v_exp_f32 v92, v92
    v_cvt_pk_bf16_f32 v152, v88, v89
    v_mfma_f32_32x32x16_bf16 v[72:87], a[24:27], v[68:71], v[136:151]
    v_exp_f32 v93, v93
    v_cvt_pk_bf16_f32 v153, v90, v91
    v_exp_f32 v94, v94
    v_exp_f32 v95, v95
    v_exp_f32 v96, v96
    v_cvt_pk_bf16_f32 v154, v92, v93
    v_exp_f32 v97, v97
    v_cvt_pk_bf16_f32 v155, v94, v95
    v_exp_f32 v98, v98
    v_exp_f32 v99, v99
    v_mfma_f32_32x32x16_bf16 v[176:191], a[96:99], v[152:155], v[176:191]
    s_waitcnt vmcnt(9)
    ds_read_b64_tr_b16 a[184:185], v15 offset:0
    ds_read_b64_tr_b16 a[186:187], v15 offset:1024
    ds_read_b64_tr_b16 a[188:189], v16 offset:0
    ds_read_b64_tr_b16 a[190:191], v16 offset:1024
    ds_read_b64_tr_b16 a[192:193], v15 offset:2048
    ds_read_b64_tr_b16 a[194:195], v15 offset:3072
    v_exp_f32 v100, v100
    v_cvt_pk_bf16_f32 v156, v96, v97
    v_exp_f32 v101, v101
    v_cvt_pk_bf16_f32 v157, v98, v99
    v_exp_f32 v102, v102
    v_exp_f32 v103, v103
    v_cvt_pk_bf16_f32 v158, v100, v101
    ds_read_b64_tr_b16 a[196:197], v16 offset:2048
    ds_read_b64_tr_b16 a[198:199], v16 offset:3072
    ds_read_b64_tr_b16 a[200:201], v15 offset:4096
    ds_read_b64_tr_b16 a[202:203], v15 offset:5120
    ds_read_b64_tr_b16 a[204:205], v16 offset:4096
    ds_read_b64_tr_b16 a[206:207], v16 offset:5120
    v_cvt_pk_bf16_f32 v159, v102, v103
    v_exp_f32 v72, v72
    v_exp_f32 v73, v73
    v_mfma_f32_32x32x16_bf16 v[176:191], a[100:103], v[156:159], v[176:191]
    v_exp_f32 v74, v74
    v_exp_f32 v75, v75
    v_exp_f32 v76, v76
    v_cvt_pk_bf16_f32 v152, v72, v73
    v_exp_f32 v77, v77
    v_cvt_pk_bf16_f32 v153, v74, v75
    v_exp_f32 v78, v78
    v_exp_f32 v79, v79
    v_exp_f32 v80, v80
    v_cvt_pk_bf16_f32 v154, v76, v77
    v_exp_f32 v81, v81
    v_cvt_pk_bf16_f32 v155, v78, v79
    v_exp_f32 v82, v82
    v_exp_f32 v83, v83
    v_mfma_f32_32x32x16_bf16 v[176:191], a[88:91], v[152:155], v[176:191]
    s_add_u32 m0, s54, 98304
    s_add_u32 s78, s55, 917504
    buffer_load_dwordx4 v208, s[16:19], s78 offen offset:0 lds
    buffer_load_dwordx4 v209, s[16:19], s78 offen offset:1024 lds
    v_exp_f32 v84, v84
    v_cvt_pk_bf16_f32 v156, v80, v81
    v_exp_f32 v85, v85
    v_cvt_pk_bf16_f32 v157, v82, v83
    v_exp_f32 v86, v86
    v_exp_f32 v87, v87
    v_cvt_pk_bf16_f32 v158, v84, v85
    s_waitcnt lgkmcnt(0)
    s_add_u32 m0, s54, 0
    s_add_u32 s78, s40, 49152
    buffer_load_dwordx4 v11, s[20:23], s78 offen offset:0 lds
    buffer_load_dwordx4 v12, s[20:23], s78 offen offset:1024 lds
    v_cvt_pk_bf16_f32 v159, v86, v87
    s_waitcnt vmcnt(10)
    s_barrier
    s_cmp_lg_u32 s62, 0
    s_cbranch_scc1 L_nofl_11
    s_lshl_b32 s82, s58, 5
    s_add_u32 s82, s82, 16777216
    s_mov_b64 exec, 1
    buffer_store_dword v7, v6, s[28:31], s82 offen sc1
    s_mov_b64 exec, -1
L_nofl_11:
    v_and_b32 v5, -13, v9
    v_lshlrev_b32 v5, 5, v5
    s_lshl_b32 s84, s59, 5
    s_add_u32 s84, s84, 16777216
    buffer_load_dword v8, v5, s[28:31], s84 offen sc1
    s_nop 1
    v_mfma_f32_32x32x16_bf16 v[176:191], a[92:95], v[156:159], v[176:191]
    s_nop 11
    v_cmp_nge_f32 vcc, 0x53800000, v184
    s_nop 0
    s_cbranch_vccnz L_exact_12
L_exact_12_back:
    v_rcp_f32 v204, v184
    s_add_u32 s79, s57, 32768
    v_mul_f32 v176, v204, v176
    v_mul_f32 v177, v204, v177
    v_mul_f32 v178, v204, v178
    v_mul_f32 v179, v204, v179
    v_mul_f32 v180, v204, v180
    v_mul_f32 v181, v204, v181
    v_mul_f32 v182, v204, v182
    v_mul_f32 v183, v204, v183
    v_cvt_pk_bf16_f32 v196, v176, v177
    v_cvt_pk_bf16_f32 v197, v178, v179
    v_cvt_pk_bf16_f32 v198, v180, v181
    v_cvt_pk_bf16_f32 v199, v182, v183
    buffer_store_dwordx4 v[196:199], v1, s[28:31], s79 offen sc1
    s_add_u32 m0, s54, 2048
    s_add_u32 s78, s40, 65536
    buffer_load_dwordx4 v11, s[20:23], s78 offen offset:0 lds
    buffer_load_dwordx4 v12, s[20:23], s78 offen offset:1024 lds
    s_add_u32 m0, s54, 4096
    s_add_u32 s78, s40, 81920
    buffer_load_dwordx4 v11, s[20:23], s78 offen offset:0 lds
    buffer_load_dwordx4 v12, s[20:23], s78 offen offset:1024 lds
    s_add_u32 m0, s54, 100352
    s_add_u32 s78, s55, 946176
    buffer_load_dwordx4 v208, s[16:19], s78 offen offset:0 lds
    buffer_load_dwordx4 v209, s[16:19], s78 offen offset:1024 lds
    s_add_u32 m0, s54, 102400
    s_add_u32 s78, s55, 974848
    buffer_load_dwordx4 v208, s[16:19], s78 offen offset:0 lds
    buffer_load_dwordx4 v209, s[16:19], s78 offen offset:1024 lds
    s_add_u32 m0, s54, 104448
    s_add_u32 s78, s55, 1003520
    buffer_load_dwordx4 v208, s[16:19], s78 offen offset:0 lds
    buffer_load_dwordx4 v209, s[16:19], s78 offen offset:1024 lds
    s_waitcnt vmcnt(6)
    ds_read_b64_tr_b16 a[208:209], v15 offset:0
    ds_read_b64_tr_b16 a[210:211], v15 offset:1024
    ds_read_b64_tr_b16 a[212:213], v16 offset:0
    ds_read_b64_tr_b16 a[214:215], v16 offset:1024
    ds_read_b64_tr_b16 a[216:217], v15 offset:2048
    ds_read_b64_tr_b16 a[218:219], v15 offset:3072
    ds_read_b64_tr_b16 a[220:221], v16 offset:2048
    ds_read_b64_tr_b16 a[222:223], v16 offset:3072
    ds_read_b64_tr_b16 a[224:225], v15 offset:4096
    ds_read_b64_tr_b16 a[226:227], v15 offset:5120
    ds_read_b64_tr_b16 a[228:229], v16 offset:4096
    ds_read_b64_tr_b16 a[230:231], v16 offset:5120
    s_add_u32 m0, s54, 131072
    s_add_u32 s78, s55, 1376256
    buffer_load_dwordx4 v208, s[16:19], s78 offen offset:0 lds
    buffer_load_dwordx4 v209, s[16:19], s78 offen offset:1024 lds
    s_waitcnt lgkmcnt(0)
    s_add_u32 m0, s54, 0
    s_add_u32 s78, s40, 98304
    buffer_load_dwordx4 v11, s[20:23], s78 offen offset:0 lds
    buffer_load_dwordx4 v12, s[20:23], s78 offen offset:1024 lds
    s_add_u32 m0, s54, 2048
    s_add_u32 s78, s40, 114688
    buffer_load_dwordx4 v11, s[20:23], s78 offen offset:0 lds
    buffer_load_dwordx4 v12, s[20:23], s78 offen offset:1024 lds
    s_add_u32 m0, s54, 4096
    s_add_u32 s78, s40, 131072
    buffer_load_dwordx4 v11, s[20:23], s78 offen offset:0 lds
    buffer_load_dwordx4 v12, s[20:23], s78 offen offset:1024 lds
    s_add_u32 m0, s54, 133120
    s_add_u32 s78, s55, 1404928
    buffer_load_dwordx4 v208, s[16:19], s78 offen offset:0 lds
    buffer_load_dwordx4 v209, s[16:19], s78 offen offset:1024 lds
    s_add_u32 m0, s54, 135168
    s_add_u32 s78, s55, 1433600
    buffer_load_dwordx4 v208, s[16:19], s78 offen offset:0 lds
    buffer_load_dwordx4 v209, s[16:19], s78 offen offset:1024 lds
    s_add_u32 m0, s54, 137216
    s_add_u32 s78, s55, 1462272
    buffer_load_dwordx4 v208, s[16:19], s78 offen offset:0 lds
    buffer_load_dwordx4 v209, s[16:19], s78 offen offset:1024 lds
    s_waitcnt vmcnt(6)
    ds_read_b64_tr_b16 a[232:233], v15 offset:0
    ds_read_b64_tr_b16 a[234:235], v15 offset:1024
    ds_read_b64_tr_b16 a[236:237], v16 offset:0
    ds_read_b64_tr_b16 a[238:239], v16 offset:1024
    ds_read_b64_tr_b16 a[240:241], v15 offset:2048
    ds_read_b64_tr_b16 a[242:243], v15 offset:3072
    ds_read_b64_tr_b16 a[244:245], v16 offset:2048
    ds_read_b64_tr_b16 a[246:247], v16 offset:3072
    ds_read_b64_tr_b16 a[248:249], v15 offset:4096
    ds_read_b64_tr_b16 a[250:251], v15 offset:5120
    ds_read_b64_tr_b16 a[252:253], v16 offset:4096
    ds_read_b64_tr_b16 a[254:255], v16 offset:5120
    s_waitcnt vmcnt(0)
    s_branch L_att_done
L_att_t2:
    buffer_load_dwordx4 a[36:39], v207, s[28:31], s94 offen sc1
    s_mov_b32 exec_lo, 0xffff
    s_mov_b32 exec_hi, 0xffff
    buffer_load_dwordx4 a[112:115], v206, s[28:31], s94 offen offset:0 sc1
    buffer_load_dwordx4 a[116:119], v206, s[28:31], s94 offen offset:512 sc1
    s_mov_b64 exec, -1
    s_waitcnt vmcnt(17)
    v_mfma_f32_32x32x16_bf16 v[104:119], a[32:35], v[64:67], v[224:239]
    s_add_u32 m0, s54, 32768
    s_add_u32 s78, s55, 0
    buffer_load_dwordx4 v208, s[16:19], s78 offen offset:0 lds
    buffer_load_dwordx4 v209, s[16:19], s78 offen offset:1024 lds
    s_nop 7
    v_max3_f32 v200, v104, v105, v106
    v_max3_f32 v201, v107, v108, v109
    v_max3_f32 v200, v110, v111, v200
    v_max3_f32 v201, v112, v113, v201
    v_max3_f32 v200, v114, v115, v200
    v_max3_f32 v201, v116, v117, v201
    v_max3_f32 v200, v118, v119, v200
    v_max_f32 v200, v200, v201
    v_mov_b32 v201, v200
    s_nop 1
    v_permlane32_swap_b32 v200, v201
    v_max_f32 v200, v200, v201
    v_cvt_pk_bf16_f32 v216, -v200, 0
    s_nop 1
    v_mfma_f32_32x32x16_bf16 v[120:135], v[212:215], v[216:219], 0
    s_waitcnt vmcnt(4)
    v_mfma_f32_32x32x16_bf16 v[104:119], a[36:39], v[68:71], v[224:239]
    s_nop 11
    v_max3_f32 v202, v104, v105, v106
    v_max3_f32 v203, v107, v108, v109
    v_max3_f32 v202, v110, v111, v202
    v_max3_f32 v203, v112, v113, v203
    v_max3_f32 v202, v114, v115, v202
    v_max3_f32 v203, v116, v117, v203
    v_max3_f32 v202, v118, v119, v202
    v_max_f32 v202, v202, v203
    v_mov_b32 v203, v202
    s_nop 1
    v_permlane32_swap_b32 v202, v203
    v_max_f32 v202, v202, v203
    v_cvt_pk_bf16_f32 v220, -v202, 0
    s_nop 1
    v_mfma_f32_32x32x16_bf16 v[136:151], v[212:215], v[220:223], 0
    v_mfma_f32_32x32x16_bf16 v[72:87], v[212:215], v[216:219], v[224:239]
    v_mfma_f32_32x32x16_bf16 v[72:87], a[32:35], v[64:67], v[72:87]
    s_nop 11
    v_exp_f32 v72, v72
    v_exp_f32 v73, v73
    v_exp_f32 v74, v74
    v_exp_f32 v75, v75
    v_exp_f32 v76, v76
    v_cvt_pk_bf16_f32 v152, v72, v73
    v_mfma_f32_32x32x16_bf16 v[88:103], a[28:31], v[64:67], v[120:135]
    v_exp_f32 v77, v77
    v_cvt_pk_bf16_f32 v153, v74, v75
    v_exp_f32 v78, v78
    v_exp_f32 v79, v79
    v_exp_f32 v80, v80
    v_cvt_pk_bf16_f32 v154, v76, v77
    v_exp_f32 v81, v81
    v_cvt_pk_bf16_f32 v155, v78, v79
    v_exp_f32 v82, v82
    v_exp_f32 v83, v83
    v_mfma_f32_32x32x16_bf16 v[160:175], a[104:107], v[152:155], 0
    s_add_u32 m0, s54, 34816
    s_add_u32 s78, s55, 28672
    buffer_load_dwordx4 v208, s[16:19], s78 offen offset:0 lds
    buffer_load_dwordx4 v209, s[16:19], s78 offen offset:1024 lds
    v_exp_f32 v84, v84
    v_cvt_pk_bf16_f32 v156, v80, v81
    v_exp_f32 v85, v85
    v_cvt_pk_bf16_f32 v157, v82, v83
    v_exp_f32 v86, v86
    v_exp_f32 v87, v87
    v_cvt_pk_bf16_f32 v158, v84, v85
    s_add_u32 m0, s54, 36864
    s_add_u32 s78, s55, 57344
    buffer_load_dwordx4 v208, s[16:19], s78 offen offset:0 lds
    buffer_load_dwordx4 v209, s[16:19], s78 offen offset:1024 lds
    v_cvt_pk_bf16_f32 v159, v86, v87
    v_exp_f32 v88, v88
    v_exp_f32 v89, v89
    v_mfma_f32_32x32x16_bf16 v[160:175], a[108:111], v[156:159], v[160:175]
    v_exp_f32 v90, v90
    v_exp_f32 v91, v91
    v_exp_f32 v92, v92
    v_cvt_pk_bf16_f32 v152, v88, v89
    v_mfma_f32_32x32x16_bf16 v[72:87], a[24:27], v[64:67], v[120:135]
    v_exp_f32 v93, v93
    v_cvt_pk_bf16_f32 v153, v90, v91
    v_exp_f32 v94, v94
    v_exp_f32 v95, v95
    v_exp_f32 v96, v96
    v_cvt_pk_bf16_f32 v154, v92, v93
    v_exp_f32 v97, v97
    v_cvt_pk_bf16_f32 v155, v94, v95
    v_exp_f32 v98, v98
    v_exp_f32 v99, v99
    v_mfma_f32_32x32x16_bf16 v[160:175], a[96:99], v[152:155], v[160:175]
    s_add_u32 m0, s54, 38912
    s_add_u32 s78, s55, 86016
    buffer_load_dwordx4 v208, s[16:19], s78 offen offset:0 lds
    buffer_load_dwordx4 v209, s[16:19], s78 offen offset:1024 lds
    v_exp_f32 v100, v100
    v_cvt_pk_bf16_f32 v156, v96, v97
    v_exp_f32 v101, v101
    v_cvt_pk_bf16_f32 v157, v98, v99
    v_exp_f32 v102, v102
    v_exp_f32 v103, v103
    v_cvt_pk_bf16_f32 v158, v100, v101
    s_add_u32 m0, s54, 0
    s_add_u32 s78, s40, 0
    buffer_load_dwordx4 v11, s[20:23], s78 offen offset:0 lds
    buffer_load_dwordx4 v12, s[20:23], s78 offen offset:1024 lds
    v_cvt_pk_bf16_f32 v159, v102, v103
    v_exp_f32 v72, v72
    v_exp_f32 v73, v73
    v_mfma_f32_32x32x16_bf16 v[160:175], a[100:103], v[156:159], v[160:175]
    v_exp_f32 v74, v74
    v_exp_f32 v75, v75
    v_exp_f32 v76, v76
    v_cvt_pk_bf16_f32 v152, v72, v73
    v_mfma_f32_32x32x16_bf16 v[88:103], a[20:23], v[64:67], v[120:135]
    v_exp_f32 v77, v77
    v_cvt_pk_bf16_f32 v153, v74, v75
    v_exp_f32 v78, v78
    v_exp_f32 v79, v79
    v_exp_f32 v80, v80
    v_cvt_pk_bf16_f32 v154, v76, v77
    v_exp_f32 v81, v81
    v_cvt_pk_bf16_f32 v155, v78, v79
    v_exp_f32 v82, v82
    v_exp_f32 v83, v83
    v_mfma_f32_32x32x16_bf16 v[160:175], a[88:91], v[152:155], v[160:175]
    s_add_u32 m0, s54, 2048
    s_add_u32 s78, s40, 16384
    buffer_load_dwordx4 v11, s[20:23], s78 offen offset:0 lds
    buffer_load_dwordx4 v12, s[20:23], s78 offen offset:1024 lds
    v_exp_f32 v84, v84
    v_cvt_pk_bf16_f32 v156, v80, v81
    v_exp_f32 v85, v85
    v_cvt_pk_bf16_f32 v157, v82, v83
    v_exp_f32 v86, v86
    v_exp_f32 v87, v87
    v_cvt_pk_bf16_f32 v158, v84, v85
    s_add_u32 m0, s54, 4096
    s_add_u32 s78, s40, 32768
    buffer_load_dwordx4 v11, s[20:23], s78 offen offset:0 lds
    buffer_load_dwordx4 v12, s[20:23], s78 offen offset:1024 lds
    v_cvt_pk_bf16_f32 v159, v86, v87
    v_exp_f32 v88, v88
    v_exp_f32 v89, v89
    v_mfma_f32_32x32x16_bf16 v[160:175], a[92:95], v[156:159], v[160:175]
    v_exp_f32 v90, v90
    v_exp_f32 v91, v91
    v_exp_f32 v92, v92
    v_cvt_pk_bf16_f32 v152, v88, v89
    v_mfma_f32_32x32x16_bf16 v[72:87], a[16:19], v[64:67], v[120:135]
    v_exp_f32 v93, v93
    v_cvt_pk_bf16_f32 v153, v90, v91
    v_exp_f32 v94, v94
    v_exp_f32 v95, v95
    v_exp_f32 v96, v96
    v_cvt_pk_bf16_f32 v154, v92, v93
    v_exp_f32 v97, v97
    v_cvt_pk_bf16_f32 v155, v94, v95
    v_exp_f32 v98, v98
    v_exp_f32 v99, v99
    v_mfma_f32_32x32x16_bf16 v[160:175], a[80:83], v[152:155], v[160:175]
    s_add_u32 m0, s54, 65536
    s_add_u32 s78, s55, 458752
    buffer_load_dwordx4 v208, s[16:19], s78 offen offset:0 lds
    buffer_load_dwordx4 v209, s[16:19], s78 offen offset:1024 lds
    v_exp_f32 v100, v100
    v_cvt_pk_bf16_f32 v156, v96, v97
    v_exp_f32 v101, v101
    v_cvt_pk_bf16_f32 v157, v98, v99
    v_exp_f32 v102, v102
    v_exp_f32 v103, v103
    v_cvt_pk_bf16_f32 v158, v100, v101
    s_add_u32 m0, s54, 67584
    s_add_u32 s78, s55, 487424
    buffer_load_dwordx4 v208, s[16:19], s78 offen offset:0 lds
    buffer_load_dwordx4 v209, s[16:19], s78 offen offset:1024 lds
    v_cvt_pk_bf16_f32 v159, v102, v103
    v_exp_f32 v72, v72
    v_exp_f32 v73, v73
    v_mfma_f32_32x32x16_bf16 v[160:175], a[84:87], v[156:159], v[160:175]
    v_exp_f32 v74, v74
    v_exp_f32 v75, v75
    v_exp_f32 v76, v76
    v_cvt_pk_bf16_f32 v152, v72, v73
    v_mfma_f32_32x32x16_bf16 v[88:103], v[212:215], v[220:223], v[224:239]
    v_exp_f32 v77, v77
    v_cvt_pk_bf16_f32 v153, v74, v75
    v_exp_f32 v78, v78
    v_exp_f32 v79, v79
    v_mfma_f32_32x32x16_bf16 v[88:103], a[36:39], v[68:71], v[88:103]
    v_exp_f32 v80, v80
    v_cvt_pk_bf16_f32 v154, v76, v77
    v_exp_f32 v81, v81
    v_cvt_pk_bf16_f32 v155, v78, v79
    v_exp_f32 v82, v82
    v_exp_f32 v83, v83
    v_mfma_f32_32x32x16_bf16 v[160:175], a[72:75], v[152:155], v[160:175]
    s_add_u32 m0, s54, 69632
    s_add_u32 s78, s55, 516096
    buffer_load_dwordx4 v208, s[16:19], s78 offen offset:0 lds
    buffer_load_dwordx4 v209, s[16:19], s78 offen offset:1024 lds
    v_exp_f32 v84, v84
    v_cvt_pk_bf16_f32 v156, v80, v81
    v_exp_f32 v85, v85
    v_cvt_pk_bf16_f32 v157, v82, v83
    v_exp_f32 v86, v86
    v_exp_f32 v87, v87
    v_cvt_pk_bf16_f32 v158, v84, v85
    s_add_u32 m0, s54, 71680
    s_add_u32 s78, s55, 544768
    buffer_load_dwordx4 v208, s[16:19], s78 offen offset:0 lds
    buffer_load_dwordx4 v209, s[16:19], s78 offen offset:1024 lds
    v_cvt_pk_bf16_f32 v159, v86, v87
    v_exp_f32 v88, v88
    v_exp_f32 v89, v89
    v_mfma_f32_32x32x16_bf16 v[160:175], a[76:79], v[156:159], v[160:175]
    v_exp_f32 v90, v90
    v_exp_f32 v91, v91
    v_exp_f32 v92, v92
    v_cvt_pk_bf16_f32 v152, v88, v89
    v_mfma_f32_32x32x16_bf16 v[72:87], a[32:35], v[68:71], v[136:151]
    v_exp_f32 v93, v93
    v_cvt_pk_bf16_f32 v153, v90, v91
    v_exp_f32 v94, v94
    v_exp_f32 v95, v95
    v_exp_f32 v96, v96
    v_cvt_pk_bf16_f32 v154, v92, v93
    v_exp_f32 v97, v97
    v_cvt_pk_bf16_f32 v155, v94, v95
    v_exp_f32 v98, v98
    v_exp_f32 v99, v99
    s_waitcnt vmcnt(23)
    v_mfma_f32_32x32x16_bf16 v[176:191], a[112:115], v[152:155], 0
    s_waitcnt vmcnt(8)
    ds_read_b64_tr_b16 a[184:185], v15 offset:0
    ds_read_b64_tr_b16 a[186:187], v15 offset:1024
    ds_read_b64_tr_b16 a[188:189], v16 offset:0
    ds_read_b64_tr_b16 a[190:191], v16 offset:1024
    ds_read_b64_tr_b16 a[192:193], v15 offset:2048
    ds_read_b64_tr_b16 a[194:195], v15 offset:3072
    v_exp_f32 v100, v100
    v_cvt_pk_bf16_f32 v156, v96, v97
    v_exp_f32 v101, v101
    v_cvt_pk_bf16_f32 v157, v98, v99
    v_exp_f32 v102, v102
    v_exp_f32 v103, v103
    v_cmp_nge_f32 vcc, 0x53800000, v168
    s_nop 0
    s_cbranch_vccnz L_exact_13
L_exact_13_back:
    v_rcp_f32 v204, v168
    s_nop 0
    v_mul_f32 v160, v204, v160
    v_mul_f32 v161, v204, v161
    v_mul_f32 v162, v204, v162
    v_mul_f32 v163, v204, v163
    v_mul_f32 v164, v204, v164
    v_mul_f32 v165, v204, v165
    v_mul_f32 v166, v204, v166
    v_mul_f32 v167, v204, v167
    v_cvt_pk_bf16_f32 v192, v160, v161
    v_cvt_pk_bf16_f32 v193, v162, v163
    v_cvt_pk_bf16_f32 v194, v164, v165
    v_cvt_pk_bf16_f32 v195, v166, v167
    buffer_store_dwordx4 v[192:195], v1, s[28:31], s57 offen sc1
    v_cvt_pk_bf16_f32 v158, v100, v101
    ds_read_b64_tr_b16 a[196:197], v16 offset:2048
    ds_read_b64_tr_b16 a[198:199], v16 offset:3072
    ds_read_b64_tr_b16 a[200:201], v15 offset:4096
    ds_read_b64_tr_b16 a[202:203], v15 offset:5120
    ds_read_b64_tr_b16 a[204:205], v16 offset:4096
    ds_read_b64_tr_b16 a[206:207], v16 offset:5120
    v_cvt_pk_bf16_f32 v159, v102, v103
    v_exp_f32 v72, v72
    v_exp_f32 v73, v73
    v_mfma_f32_32x32x16_bf16 v[176:191], a[116:119], v[156:159], v[176:191]
    v_exp_f32 v74, v74
    v_exp_f32 v75, v75
    v_exp_f32 v76, v76
    v_cvt_pk_bf16_f32 v152, v72, v73
    v_mfma_f32_32x32x16_bf16 v[88:103], a[28:31], v[68:71], v[136:151]
    v_exp_f32 v77, v77
    v_cvt_pk_bf16_f32 v153, v74, v75
    v_exp_f32 v78, v78
    v_exp_f32 v79, v79
    v_exp_f32 v80, v80
    v_cvt_pk_bf16_f32 v154, v76, v77
    v_exp_f32 v81, v81
    v_cvt_pk_bf16_f32 v155, v78, v79
    v_exp_f32 v82, v82
    v_exp_f32 v83, v83
    v_mfma_f32_32x32x16_bf16 v[176:191], a[104:107], v[152:155], v[176:191]
    s_add_u32 m0, s54, 98304
    s_add_u32 s78, s55, 917504
    buffer_load_dwordx4 v208, s[16:19], s78 offen offset:0 lds
    buffer_load_dwordx4 v209, s[16:19], s78 offen offset:1024 lds
    v_exp_f32 v84, v84
    v_cvt_pk_bf16_f32 v156, v80, v81
    v_exp_f32 v85, v85
    v_cvt_pk_bf16_f32 v157, v82, v83
    v_exp_f32 v86, v86
    v_exp_f32 v87, v87
    v_cvt_pk_bf16_f32 v158, v84, v85
    s_waitcnt lgkmcnt(0)
    s_add_u32 m0, s54, 0
    s_add_u32 s78, s40, 49152
    buffer_load_dwordx4 v11, s[20:23], s78 offen offset:0 lds
    buffer_load_dwordx4 v12, s[20:23], s78 offen offset:1024 lds
    v_cvt_pk_bf16_f32 v159, v86, v87
    v_exp_f32 v88, v88
    v_exp_f32 v89, v89
    v_mfma_f32_32x32x16_bf16 v[176:191], a[108:111], v[156:159], v[176:191]
    v_exp_f32 v90, v90
    v_exp_f32 v91, v91
    v_exp_f32 v92, v92
    v_cvt_pk_bf16_f32 v152, v88, v89
    v_mfma_f32_32x32x16_bf16 v[72:87], a[24:27], v[68:71], v[136:151]
    v_exp_f32 v93, v93
    v_cvt_pk_bf16_f32 v153, v90, v91
    v_exp_f32 v94, v94
    v_exp_f32 v95, v95
    v_exp_f32 v96, v96
    v_cvt_pk_bf16_f32 v154, v92, v93
    v_exp_f32 v97, v97
    v_cvt_pk_bf16_f32 v155, v94, v95
    v_exp_f32 v98, v98
    v_exp_f32 v99, v99
    v_mfma_f32_32x32x16_bf16 v[176:191], a[96:99], v[152:155], v[176:191]
    s_add_u32 m0, s54, 2048
    s_add_u32 s78, s40, 65536
    buffer_load_dwordx4 v11, s[20:23], s78 offen offset:0 lds
    buffer_load_dwordx4 v12, s[20:23], s78 offen offset:1024 lds
    v_exp_f32 v100, v100
    v_cvt_pk_bf16_f32 v156, v96, v97
    v_exp_f32 v101, v101
    v_cvt_pk_bf16_f32 v157, v98, v99
    v_exp_f32 v102, v102
    v_exp_f32 v103, v103
    v_cvt_pk_bf16_f32 v158, v100, v101
    s_add_u32 m0, s54, 4096
    s_add_u32 s78, s40, 81920
    buffer_load_dwordx4 v11, s[20:23], s78 offen offset:0 lds
    buffer_load_dwordx4 v12, s[20:23], s78 offen offset:1024 lds
    v_cvt_pk_bf16_f32 v159, v102, v103
    v_exp_f32 v72, v72
    v_exp_f32 v73, v73
    v_mfma_f32_32x32x16_bf16 v[176:191], a[100:103], v[156:159], v[176:191]
    v_exp_f32 v74, v74
    v_exp_f32 v75, v75
    v_exp_f32 v76, v76
    v_cvt_pk_bf16_f32 v152, v72, v73
    v_mfma_f32_32x32x16_bf16 v[88:103], a[20:23], v[68:71], v[136:151]
    v_exp_f32 v77, v77
    v_cvt_pk_bf16_f32 v153, v74, v75
    v_exp_f32 v78, v78
    v_exp_f32 v79, v79
    v_exp_f32 v80, v80
    v_cvt_pk_bf16_f32 v154, v76, v77
    v_exp_f32 v81, v81
    v_cvt_pk_bf16_f32 v155, v78, v79
    v_exp_f32 v82, v82
    v_exp_f32 v83, v83
    v_mfma_f32_32x32x16_bf16 v[176:191], a[88:91], v[152:155], v[176:191]
    s_add_u32 m0, s54, 100352
    s_add_u32 s78, s55, 946176
    buffer_load_dwordx4 v208, s[16:19], s78 offen offset:0 lds
    buffer_load_dwordx4 v209, s[16:19], s78 offen offset:1024 lds
    v_exp_f32 v84, v84
    v_cvt_pk_bf16_f32 v156, v80, v81
    v_exp_f32 v85, v85
    v_cvt_pk_bf16_f32 v157, v82, v83
    v_exp_f32 v86, v86
    v_exp_f32 v87, v87
    v_cvt_pk_bf16_f32 v158, v84, v85
    s_add_u32 m0, s54, 102400
    s_add_u32 s78, s55, 974848
    buffer_load_dwordx4 v208, s[16:19], s78 offen offset:0 lds
    buffer_load_dwordx4 v209, s[16:19], s78 offen offset:1024 lds
    v_cvt_pk_bf16_f32 v159, v86, v87
    v_exp_f32 v88, v88
    v_exp_f32 v89, v89
    v_mfma_f32_32x32x16_bf16 v[176:191], a[92:95], v[156:159], v[176:191]
    v_exp_f32 v90, v90
    v_exp_f32 v91, v91
    v_exp_f32 v92, v92
    v_cvt_pk_bf16_f32 v152, v88, v89
    v_mfma_f32_32x32x16_bf16 v[72:87], a[16:19], v[68:71], v[136:151]
    v_exp_f32 v93, v93
    v_cvt_pk_bf16_f32 v153, v90, v91
    v_exp_f32 v94, v94
    v_exp_f32 v95, v95
    v_exp_f32 v96, v96
    v_cvt_pk_bf16_f32 v154, v92, v93
    v_exp_f32 v97, v97
    v_cvt_pk_bf16_f32 v155, v94, v95
    v_exp_f32 v98, v98
    v_exp_f32 v99, v99
    v_mfma_f32_32x32x16_bf16 v[176:191], a[80:83], v[152:155], v[176:191]
    s_add_u32 m0, s54, 104448
    s_add_u32 s78, s55, 1003520
    buffer_load_dwordx4 v208, s[16:19], s78 offen offset:0 lds
    buffer_load_dwordx4 v209, s[16:19], s78 offen offset:1024 lds
    v_exp_f32 v100, v100
    v_cvt_pk_bf16_f32 v156, v96, v97
    v_exp_f32 v101, v101
    v_cvt_pk_bf16_f32 v157, v98, v99
    v_exp_f32 v102, v102
    v_exp_f32 v103, v103
    v_cvt_pk_bf16_f32 v158, v100, v101
    s_waitcnt vmcnt(6)
    ds_read_b64_tr_b16 a[208:209], v15 offset:0
    ds_read_b64_tr_b16 a[210:211], v15 offset:1024
    ds_read_b64_tr_b16 a[212:213], v16 offset:0
    ds_read_b64_tr_b16 a[214:215], v16 offset:1024
    ds_read_b64_tr_b16 a[216:217], v15 offset:2048
    ds_read_b64_tr_b16 a[218:219], v15 offset:3072
    v_cvt_pk_bf16_f32 v159, v102, v103
    s_barrier
    s_cmp_lg_u32 s62, 0
    s_cbranch_scc1 L_nofl_14
    s_lshl_b32 s82, s58, 5
    s_add_u32 s82, s82, 16777216
    s_mov_b64 exec, 1
    buffer_store_dword v7, v6, s[28:31], s82 offen sc1
    s_mov_b64 exec, -1
L_nofl_14:
    v_exp_f32 v72, v72
    v_exp_f32 v73, v73
    v_mfma_f32_32x32x16_bf16 v[176:191], a[84:87], v[156:159], v[176:191]
    v_exp_f32 v74, v74
    v_exp_f32 v75, v75
    v_exp_f32 v76, v76
    v_cvt_pk_bf16_f32 v152, v72, v73
    v_exp_f32 v77, v77
    v_cvt_pk_bf16_f32 v153, v74, v75
    v_exp_f32 v78, v78
    v_exp_f32 v79, v79
    v_exp_f32 v80, v80
    v_cvt_pk_bf16_f32 v154, v76, v77
    v_exp_f32 v81, v81
    v_cvt_pk_bf16_f32 v155, v78, v79
    v_exp_f32 v82, v82
    v_exp_f32 v83, v83
    v_mfma_f32_32x32x16_bf16 v[176:191], a[72:75], v[152:155], v[176:191]
    ds_read_b64_tr_b16 a[220:221], v16 offset:2048
    ds_read_b64_tr_b16 a[222:223], v16 offset:3072
    ds_read_b64_tr_b16 a[224:225], v15 offset:4096
    ds_read_b64_tr_b16 a[226:227], v15 offset:5120
    ds_read_b64_tr_b16 a[228:229], v16 offset:4096
    ds_read_b64_tr_b16 a[230:231], v16 offset:5120
    v_exp_f32 v84, v84
    v_cvt_pk_bf16_f32 v156, v80, v81
    v_exp_f32 v85, v85
    v_cvt_pk_bf16_f32 v157, v82, v83
    v_exp_f32 v86, v86
    v_exp_f32 v87, v87
    v_cvt_pk_bf16_f32 v158, v84, v85
    s_add_u32 m0, s54, 131072
    s_add_u32 s78, s55, 1376256
    buffer_load_dwordx4 v208, s[16:19], s78 offen offset:0 lds
    buffer_load_dwordx4 v209, s[16:19], s78 offen offset:1024 lds
    v_cvt_pk_bf16_f32 v159, v86, v87
    v_and_b32 v5, -13, v9
    v_lshlrev_b32 v5, 5, v5
    s_lshl_b32 s84, s59, 5
    s_add_u32 s84, s84, 16777216
    buffer_load_dword v8, v5, s[28:31], s84 offen sc1
    s_nop 1
    v_mfma_f32_32x32x16_bf16 v[176:191], a[76:79], v[156:159], v[176:191]
    s_nop 11
    v_cmp_nge_f32 vcc, 0x53800000, v184
    s_nop 0
    s_cbranch_vccnz L_exact_15
L_exact_15_back:
    v_rcp_f32 v204, v184
    s_add_u32 s79, s57, 32768
    v_mul_f32 v176, v204, v176
    v_mul_f32 v177, v204, v177
    v_mul_f32 v178, v204, v178
    v_mul_f32 v179, v204, v179
    v_mul_f32 v180, v204, v180
    v_mul_f32 v181, v204, v181
    v_mul_f32 v182, v204, v182
    v_mul_f32 v183, v204, v183
    v_cvt_pk_bf16_f32 v196, v176, v177
    v_cvt_pk_bf16_f32 v197, v178, v179
    v_cvt_pk_bf16_f32 v198, v180, v181
    v_cvt_pk_bf16_f32 v199, v182, v183
    buffer_store_dwordx4 v[196:199], v1, s[28:31], s79 offen sc1
    s_waitcnt lgkmcnt(0)
    s_add_u32 m0, s54, 0
    s_add_u32 s78, s40, 98304
    buffer_load_dwordx4 v11, s[20:23], s78 offen offset:0 lds
    buffer_load_dwordx4 v12, s[20:23], s78 offen offset:1024 lds
    s_add_u32 m0, s54, 2048
    s_add_u32 s78, s40, 114688
    buffer_load_dwordx4 v11, s[20:23], s78 offen offset:0 lds
    buffer_load_dwordx4 v12, s[20:23], s78 offen offset:1024 lds
    s_add_u32 m0, s54, 4096
    s_add_u32 s78, s40, 131072
    buffer_load_dwordx4 v11, s[20:23], s78 offen offset:0 lds
    buffer_load_dwordx4 v12, s[20:23], s78 offen offset:1024 lds
    s_add_u32 m0, s54, 133120
    s_add_u32 s78, s55, 1404928
    buffer_load_dwordx4 v208, s[16:19], s78 offen offset:0 lds
    buffer_load_dwordx4 v209, s[16:19], s78 offen offset:1024 lds
    s_add_u32 m0, s54, 135168
    s_add_u32 s78, s55, 1433600
    buffer_load_dwordx4 v208, s[16:19], s78 offen offset:0 lds
    buffer_load_dwordx4 v209, s[16:19], s78 offen offset:1024 lds
    s_add_u32 m0, s54, 137216
    s_add_u32 s78, s55, 1462272
    buffer_load_dwordx4 v208, s[16:19], s78 offen offset:0 lds
    buffer_load_dwordx4 v209, s[16:19], s78 offen offset:1024 lds
    s_waitcnt vmcnt(6)
    ds_read_b64_tr_b16 a[232:233], v15 offset:0
    ds_read_b64_tr_b16 a[234:235], v15 offset:1024
    ds_read_b64_tr_b16 a[236:237], v16 offset:0
    ds_read_b64_tr_b16 a[238:239], v16 offset:1024
    ds_read_b64_tr_b16 a[240:241], v15 offset:2048
    ds_read_b64_tr_b16 a[242:243], v15 offset:3072
    ds_read_b64_tr_b16 a[244:245], v16 offset:2048
    ds_read_b64_tr_b16 a[246:247], v16 offset:3072
    ds_read_b64_tr_b16 a[248:249], v15 offset:4096
    ds_read_b64_tr_b16 a[250:251], v15 offset:5120
    ds_read_b64_tr_b16 a[252:253], v16 offset:4096
    ds_read_b64_tr_b16 a[254:255], v16 offset:5120
    s_waitcnt vmcnt(0)
    s_branch L_att_done
L_att_t3:
    buffer_load_dwordx4 a[36:39], v207, s[28:31], s94 offen sc1
    s_mov_b32 exec_lo, 0xffff
    s_mov_b32 exec_hi, 0xffff
    buffer_load_dwordx4 a[112:115], v206, s[28:31], s94 offen offset:0 sc1
    buffer_load_dwordx4 a[116:119], v206, s[28:31], s94 offen offset:512 sc1
    s_mov_b64 exec, -1
    buffer_load_dwordx4 a[12:15], v207, s[28:31], s88 offen sc1
    s_mov_b32 exec_lo, 0xffff
    s_mov_b32 exec_hi, 0xffff
    buffer_load_dwordx4 a[64:67], v206, s[28:31], s88 offen offset:0 sc1
    buffer_load_dwordx4 a[68:71], v206, s[28:31], s88 offen offset:512 sc1
    s_mov_b64 exec, -1
    buffer_load_dwordx4 a[8:11], v207, s[28:31], s87 offen sc1
    s_mov_b32 exec_lo, 0xffff
    s_mov_b32 exec_hi, 0xffff
    buffer_load_dwordx4 a[56:59], v206, s[28:31], s87 offen offset:0 sc1
    buffer_load_dwordx4 a[60:63], v206, s[28:31], s87 offen offset:512 sc1
    s_mov_b64 exec, -1
    s_waitcnt vmcnt(23)
    v_mfma_f32_32x32x16_bf16 v[104:119], a[32:35], v[64:67], v[224:239]
    s_add_u32 m0, s54, 32768
    s_add_u32 s78, s55, 0
    buffer_load_dwordx4 v208, s[16:19], s78 offen offset:0 lds
    buffer_load_dwordx4 v209, s[16:19], s78 offen offset:1024 lds
    s_nop 7
    v_max3_f32 v200, v104, v105, v106
    v_max3_f32 v201, v107, v108, v109
    v_max3_f32 v200, v110, v111, v200
    v_max3_f32 v201, v112, v113, v201
    v_max3_f32 v200, v114, v115, v200
    v_max3_f32 v201, v116, v117, v201
    v_max3_f32 v200, v118, v119, v200
    v_max_f32 v200, v200, v201
    v_mov_b32 v201, v200
    s_nop 1
    v_permlane32_swap_b32 v200, v201
    v_max_f32 v200, v200, v201
    v_cvt_pk_bf16_f32 v216, -v200, 0
    s_nop 1
    v_mfma_f32_32x32x16_bf16 v[120:135], v[212:215], v[216:219], 0
    s_waitcnt vmcnt(10)
    v_mfma_f32_32x32x16_bf16 v[104:119], a[36:39], v[68:71], v[224:239]
    s_nop 11
    v_max3_f32 v202, v104, v105, v106
    v_max3_f32 v203, v107, v108, v109
    v_max3_f32 v202, v110, v111, v202
    v_max3_f32 v203, v112, v113, v203
    v_max3_f32 v202, v114, v115, v202
    v_max3_f32 v203, v116, v117, v203
    v_max3_f32 v202, v118, v119, v202
    v_max_f32 v202, v202, v203
    v_mov_b32 v203, v202
    s_nop 1
    v_permlane32_swap_b32 v202, v203
    v_max_f32 v202, v202, v203
    v_cvt_pk_bf16_f32 v220, -v202, 0
    s_nop 1
    v_mfma_f32_32x32x16_bf16 v[136:151], v[212:215], v[220:223], 0
    v_mfma_f32_32x32x16_bf16 v[72:87], v[212:215], v[216:219], v[224:239]
    v_mfma_f32_32x32x16_bf16 v[72:87], a[32:35], v[64:67], v[72:87]
    s_nop 11
    v_exp_f32 v72, v72
    v_exp_f32 v73, v73
    v_exp_f32 v74, v74
    v_exp_f32 v75, v75
    v_exp_f32 v76, v76
    v_cvt_pk_bf16_f32 v152, v72, v73
    v_mfma_f32_32x32x16_bf16 v[88:103], a[28:31], v[64:67], v[120:135]
    v_exp_f32 v77, v77
    v_cvt_pk_bf16_f32 v153, v74, v75
    v_exp_f32 v78, v78
    v_exp_f32 v79, v79
    v_exp_f32 v80, v80
    v_cvt_pk_bf16_f32 v154, v76, v77
    v_exp_f32 v81, v81
    v_cvt_pk_bf16_f32 v155, v78, v79
    v_exp_f32 v82, v82
    v_exp_f32 v83, v83
    v_mfma_f32_32x32x16_bf16 v[160:175], a[104:107], v[152:155], 0
    s_add_u32 m0, s54, 34816
    s_add_u32 s78, s55, 28672
    buffer_load_dwordx4 v208, s[16:19], s78 offen offset:0 lds
    buffer_load_dwordx4 v209, s[16:19], s78 offen offset:1024 lds
    v_exp_f32 v84, v84
    v_cvt_pk_bf16_f32 v156, v80, v81
    v_exp_f32 v85, v85
    v_cvt_pk_bf16_f32 v157, v82, v83
    v_exp_f32 v86, v86
    v_exp_f32 v87, v87
    v_cvt_pk_bf16_f32 v158, v84, v85
    s_add_u32 m0, s54, 36864
    s_add_u32 s78, s55, 57344
    buffer_load_dwordx4 v208, s[16:19], s78 offen offset:0 lds
    buffer_load_dwordx4 v209, s[16:19], s78 offen offset:1024 lds
    v_cvt_pk_bf16_f32 v159, v86, v87
    v_exp_f32 v88, v88
    v_exp_f32 v89, v89
    v_mfma_f32_32x32x16_bf16 v[160:175], a[108:111], v[156:159], v[160:175]
    v_exp_f32 v90, v90
    v_exp_f32 v91, v91
    v_exp_f32 v92, v92
    v_cvt_pk_bf16_f32 v152, v88, v89
    v_mfma_f32_32x32x16_bf16 v[72:87], a[24:27], v[64:67], v[120:135]
    v_exp_f32 v93, v93
    v_cvt_pk_bf16_f32 v153, v90, v91
    v_exp_f32 v94, v94
    v_exp_f32 v95, v95
    v_exp_f32 v96, v96
    v_cvt_pk_bf16_f32 v154, v92, v93
    v_exp_f32 v97, v97
    v_cvt_pk_bf16_f32 v155, v94, v95
    v_exp_f32 v98, v98
    v_exp_f32 v99, v99
    v_mfma_f32_32x32x16_bf16 v[160:175], a[96:99], v[152:155], v[160:175]
    s_add_u32 m0, s54, 38912
    s_add_u32 s78, s55, 86016
    buffer_load_dwordx4 v208, s[16:19], s78 offen offset:0 lds
    buffer_load_dwordx4 v209, s[16:19], s78 offen offset:1024 lds
    v_exp_f32 v100, v100
    v_cvt_pk_bf16_f32 v156, v96, v97
    v_exp_f32 v101, v101
    v_cvt_pk_bf16_f32 v157, v98, v99
    v_exp_f32 v102, v102
    v_exp_f32 v103, v103
    v_cvt_pk_bf16_f32 v158, v100, v101
    s_add_u32 m0, s54, 0
    s_add_u32 s78, s40, 0
    buffer_load_dwordx4 v11, s[20:23], s78 offen offset:0 lds
    buffer_load_dwordx4 v12, s[20:23], s78 offen offset:1024 lds
    v_cvt_pk_bf16_f32 v159, v102, v103
    v_exp_f32 v72, v72
    v_exp_f32 v73, v73
    v_mfma_f32_32x32x16_bf16 v[160:175], a[100:103], v[156:159], v[160:175]
    v_exp_f32 v74, v74
    v_exp_f32 v75, v75
    v_exp_f32 v76, v76
    v_cvt_pk_bf16_f32 v152, v72, v73
    v_mfma_f32_32x32x16_bf16 v[88:103], a[20:23], v[64:67], v[120:135]
    v_exp_f32 v77, v77
    v_cvt_pk_bf16_f32 v153, v74, v75
    v_exp_f32 v78, v78
    v_exp_f32 v79, v79
    v_exp_f32 v80, v80
    v_cvt_pk_bf16_f32 v154, v76, v77
    v_exp_f32 v81, v81
    v_cvt_pk_bf16_f32 v155, v78, v79
    v_exp_f32 v82, v82
    v_exp_f32 v83, v83
    v_mfma_f32_32x32x16_bf16 v[160:175], a[88:91], v[152:155], v[160:175]
    s_add_u32 m0, s54, 2048
    s_add_u32 s78, s40, 16384
    buffer_load_dwordx4 v11, s[20:23], s78 offen offset:0 lds
    buffer_load_dwordx4 v12, s[20:23], s78 offen offset:1024 lds
    v_exp_f32 v84, v84
    v_cvt_pk_bf16_f32 v156, v80, v81
    v_exp_f32 v85, v85
    v_cvt_pk_bf16_f32 v157, v82, v83
    v_exp_f32 v86, v86
    v_exp_f32 v87, v87
    v_cvt_pk_bf16_f32 v158, v84, v85
    s_add_u32 m0, s54, 4096
    s_add_u32 s78, s40, 32768
    buffer_load_dwordx4 v11, s[20:23], s78 offen offset:0 lds
    buffer_load_dwordx4 v12, s[20:23], s78 offen offset:1024 lds
    v_cvt_pk_bf16_f32 v159, v86, v87
    v_exp_f32 v88, v88
    v_exp_f32 v89, v89
    v_mfma_f32_32x32x16_bf16 v[160:175], a[92:95], v[156:159], v[160:175]
    v_exp_f32 v90, v90
    v_exp_f32 v91, v91
    v_exp_f32 v92, v92
    v_cvt_pk_bf16_f32 v152, v88, v89
    v_mfma_f32_32x32x16_bf16 v[72:87], a[16:19], v[64:67], v[120:135]
    v_exp_f32 v93, v93
    v_cvt_pk_bf16_f32 v153, v90, v91
    v_exp_f32 v94, v94
    v_exp_f32 v95, v95
    v_exp_f32 v96, v96
    v_cvt_pk_bf16_f32 v154, v92, v93
    v_exp_f32 v97, v97
    v_cvt_pk_bf16_f32 v155, v94, v95
    v_exp_f32 v98, v98
    v_exp_f32 v99, v99
    v_mfma_f32_32x32x16_bf16 v[160:175], a[80:83], v[152:155], v[160:175]
    s_add_u32 m0, s54, 65536
    s_add_u32 s78, s55, 458752
    buffer_load_dwordx4 v208, s[16:19], s78 offen offset:0 lds
    buffer_load_dwordx4 v209, s[16:19], s78 offen offset:1024 lds
    v_exp_f32 v100, v100
    v_cvt_pk_bf16_f32 v156, v96, v97
    v_exp_f32 v101, v101
    v_cvt_pk_bf16_f32 v157, v98, v99
    v_exp_f32 v102, v102
    v_exp_f32 v103, v103
    v_cvt_pk_bf16_f32 v158, v100, v101
    s_add_u32 m0, s54, 67584
    s_add_u32 s78, s55, 487424
    buffer_load_dwordx4 v208, s[16:19], s78 offen offset:0 lds
    buffer_load_dwordx4 v209, s[16:19], s78 offen offset:1024 lds
    v_cvt_pk_bf16_f32 v159, v102, v103
    v_exp_f32 v72, v72
    v_exp_f32 v73, v73
    v_mfma_f32_32x32x16_bf16 v[160:175], a[84:87], v[156:159], v[160:175]
    v_exp_f32 v74, v74
    v_exp_f32 v75, v75
    v_exp_f32 v76, v76
    v_cvt_pk_bf16_f32 v152, v72, v73
    s_waitcnt vmcnt(23)
    v_mfma_f32_32x32x16_bf16 v[88:103], a[12:15], v[64:67], v[120:135]
    v_exp_f32 v77, v77
    v_cvt_pk_bf16_f32 v153, v74, v75
    v_exp_f32 v78, v78
    v_exp_f32 v79, v79
    v_exp_f32 v80, v80
    v_cvt_pk_bf16_f32 v154, v76, v77
    v_exp_f32 v81, v81
    v_cvt_pk_bf16_f32 v155, v78, v79
    v_exp_f32 v82, v82
    v_exp_f32 v83, v83
    v_mfma_f32_32x32x16_bf16 v[160:175], a[72:75], v[152:155], v[160:175]
    s_add_u32 m0, s54, 69632
    s_add_u32 s78, s55, 516096
    buffer_load_dwordx4 v208, s[16:19], s78 offen offset:0 lds
    buffer_load_dwordx4 v209, s[16:19], s78 offen offset:1024 lds
    v_exp_f32 v84, v84
    v_cvt_pk_bf16_f32 v156, v80, v81
    v_exp_f32 v85, v85
    v_cvt_pk_bf16_f32 v157, v82, v83
    v_exp_f32 v86, v86
    v_exp_f32 v87, v87
    v_cvt_pk_bf16_f32 v158, v84, v85
    s_add_u32 m0, s54, 71680
    s_add_u32 s78, s55, 544768
    buffer_load_dwordx4 v208, s[16:19], s78 offen offset:0 lds
    buffer_load_dwordx4 v209, s[16:19], s78 offen offset:1024 lds
    v_cvt_pk_bf16_f32 v159, v86, v87
    v_exp_f32 v88, v88
    v_exp_f32 v89, v89
    v_mfma_f32_32x32x16_bf16 v[160:175], a[76:79], v[156:159], v[160:175]
    v_exp_f32 v90, v90
    v_exp_f32 v91, v91
    v_exp_f32 v92, v92
    v_cvt_pk_bf16_f32 v152, v88, v89
    s_waitcnt vmcnt(24)
    v_mfma_f32_32x32x16_bf16 v[72:87], a[8:11], v[64:67], v[120:135]
    v_exp_f32 v93, v93
    v_cvt_pk_bf16_f32 v153, v90, v91
    v_exp_f32 v94, v94
    v_exp_f32 v95, v95
    v_exp_f32 v96, v96
    v_cvt_pk_bf16_f32 v154, v92, v93
    v_exp_f32 v97, v97
    v_cvt_pk_bf16_f32 v155, v94, v95
    v_exp_f32 v98, v98
    v_exp_f32 v99, v99
    v_mfma_f32_32x32x16_bf16 v[160:175], a[64:67], v[152:155], v[160:175]
    s_waitcnt vmcnt(8)
    ds_read_b64_tr_b16 a[184:185], v15 offset:0
    ds_read_b64_tr_b16 a[186:187], v15 offset:1024
    ds_read_b64_tr_b16 a[188:189], v16 offset:0
    ds_read_b64_tr_b16 a[190:191], v16 offset:1024
    ds_read_b64_tr_b16 a[192:193], v15 offset:2048
    ds_read_b64_tr_b16 a[194:195], v15 offset:3072
    v_exp_f32 v100, v100
    v_cvt_pk_bf16_f32 v156, v96, v97
    v_exp_f32 v101, v101
    v_cvt_pk_bf16_f32 v157, v98, v99
    v_exp_f32 v102, v102
    v_exp_f32 v103, v103
    v_cvt_pk_bf16_f32 v158, v100, v101
    ds_read_b64_tr_b16 a[196:197], v16 offset:2048
    ds_read_b64_tr_b16 a[198:199], v16 offset:3072
    ds_read_b64_tr_b16 a[200:201], v15 offset:4096
    ds_read_b64_tr_b16 a[202:203], v15 offset:5120
    ds_read_b64_tr_b16 a[204:205], v16 offset:4096
    ds_read_b64_tr_b16 a[206:207], v16 offset:5120
    v_cvt_pk_bf16_f32 v159, v102, v103
    v_exp_f32 v72, v72
    v_exp_f32 v73, v73
    v_mfma_f32_32x32x16_bf16 v[160:175], a[68:71], v[156:159], v[160:175]
    v_exp_f32 v74, v74
    v_exp_f32 v75, v75
    v_exp_f32 v76, v76
    v_cvt_pk_bf16_f32 v152, v72, v73
    v_mfma_f32_32x32x16_bf16 v[88:103], v[212:215], v[220:223], v[224:239]
    v_exp_f32 v77, v77
    v_cvt_pk_bf16_f32 v153, v74, v75
    v_exp_f32 v78, v78
    v_exp_f32 v79, v79
    v_mfma_f32_32x32x16_bf16 v[88:103], a[36:39], v[68:71], v[88:103]
    v_exp_f32 v80, v80
    v_cvt_pk_bf16_f32 v154, v76, v77
    v_exp_f32 v81, v81
    v_cvt_pk_bf16_f32 v155, v78, v79
    v_exp_f32 v82, v82
    v_exp_f32 v83, v83
    v_mfma_f32_32x32x16_bf16 v[160:175], a[56:59], v[152:155], v[160:175]
    s_add_u32 m0, s54, 98304
    s_add_u32 s78, s55, 917504
    buffer_load_dwordx4 v208, s[16:19], s78 offen offset:0 lds
    buffer_load_dwordx4 v209, s[16:19], s78 offen offset:1024 lds
    v_exp_f32 v84, v84
    v_cvt_pk_bf16_f32 v156, v80, v81
    v_exp_f32 v85, v85
    v_cvt_pk_bf16_f32 v157, v82, v83
    v_exp_f32 v86, v86
    v_exp_f32 v87, v87
    v_cvt_pk_bf16_f32 v158, v84, v85
    s_waitcnt lgkmcnt(0)
    s_add_u32 m0, s54, 0
    s_add_u32 s78, s40, 49152
    buffer_load_dwordx4 v11, s[20:23], s78 offen offset:0 lds
    buffer_load_dwordx4 v12, s[20:23], s78 offen offset:1024 lds
    v_cvt_pk_bf16_f32 v159, v86, v87
    v_exp_f32 v88, v88
    v_exp_f32 v89, v89
    v_mfma_f32_32x32x16_bf16 v[160:175], a[60:63], v[156:159], v[160:175]
    v_exp_f32 v90, v90
    v_exp_f32 v91, v91
    v_exp_f32 v92, v92
    v_cvt_pk_bf16_f32 v152, v88, v89
    v_mfma_f32_32x32x16_bf16 v[72:87], a[32:35], v[68:71], v[136:151]
    v_exp_f32 v93, v93
    v_cvt_pk_bf16_f32 v153, v90, v91
    v_exp_f32 v94, v94
    v_exp_f32 v95, v95
    v_exp_f32 v96, v96
    v_cvt_pk_bf16_f32 v154, v92, v93
    v_exp_f32 v97, v97
    v_cvt_pk_bf16_f32 v155, v94, v95
    v_exp_f32 v98, v98
    v_exp_f32 v99, v99
    v_mfma_f32_32x32x16_bf16 v[176:191], a[112:115], v[152:155], 0
    s_add_u32 m0, s54, 2048
    s_add_u32 s78, s40, 65536
    buffer_load_dwordx4 v11, s[20:23], s78 offen offset:0 lds
    buffer_load_dwordx4 v12, s[20:23], s78 offen offset:1024 lds
    v_exp_f32 v100, v100
    v_cvt_pk_bf16_f32 v156, v96, v97
    v_exp_f32 v101, v101
    v_cvt_pk_bf16_f32 v157, v98, v99
    v_exp_f32 v102, v102
    v_exp_f32 v103, v103
    v_cmp_nge_f32 vcc, 0x53800000, v168
    s_nop 0
    s_cbranch_vccnz L_exact_16
L_exact_16_back:
    v_rcp_f32 v204, v168
    s_nop 0
    v_mul_f32 v160, v204, v160
    v_mul_f32 v161, v204, v161
    v_mul_f32 v162, v204, v162
    v_mul_f32 v163, v204, v163
    v_mul_f32 v164, v204, v164
    v_mul_f32 v165, v204, v165
    v_mul_f32 v166, v204, v166
    v_mul_f32 v167, v204, v167
    v_cvt_pk_bf16_f32 v192, v160, v161
    v_cvt_pk_bf16_f32 v193, v162, v163
    v_cvt_pk_bf16_f32 v194, v164, v165
    v_cvt_pk_bf16_f32 v195, v166, v167
    buffer_store_dwordx4 v[192:195], v1, s[28:31], s57 offen sc1
    v_cvt_pk_bf16_f32 v158, v100, v101
    s_add_u32 m0, s54, 4096
    s_add_u32 s78, s40, 81920
    buffer_load_dwordx4 v11, s[20:23], s78 offen offset:0 lds
    buffer_load_dwordx4 v12, s[20:23], s78 offen offset:1024 lds
    v_cvt_pk_bf16_f32 v159, v102, v103
    v_exp_f32 v72, v72
    v_exp_f32 v73, v73
    v_mfma_f32_32x32x16_bf16 v[176:191], a[116:119], v[156:159], v[176:191]
    v_exp_f32 v74, v74
    v_exp_f32 v75, v75
    v_exp_f32 v76, v76
    v_cvt_pk_bf16_f32 v152, v72, v73
    v_mfma_f32_32x32x16_bf16 v[88:103], a[28:31], v[68:71], v[136:151]
    v_exp_f32 v77, v77
    v_cvt_pk_bf16_f32 v153, v74, v75
    v_exp_f32 v78, v78
    v_exp_f32 v79, v79
    v_exp_f32 v80, v80
    v_cvt_pk_bf16_f32 v154, v76, v77
    v_exp_f32 v81, v81
    v_cvt_pk_bf16_f32 v155, v78, v79
    v_exp_f32 v82, v82
    v_exp_f32 v83, v83
    v_mfma_f32_32x32x16_bf16 v[176:191], a[104:107], v[152:155], v[176:191]
    s_add_u32 m0, s54, 100352
    s_add_u32 s78, s55, 946176
    buffer_load_dwordx4 v208, s[16:19], s78 offen offset:0 lds
    buffer_load_dwordx4 v209, s[16:19], s78 offen offset:1024 lds
    v_exp_f32 v84, v84
    v_cvt_pk_bf16_f32 v156, v80, v81
    v_exp_f32 v85, v85
    v_cvt_pk_bf16_f32 v157, v82, v83
    v_exp_f32 v86, v86
    v_exp_f32 v87, v87
    v_cvt_pk_bf16_f32 v158, v84, v85
    s_add_u32 m0, s54, 102400
    s_add_u32 s78, s55, 974848
    buffer_load_dwordx4 v208, s[16:19], s78 offen offset:0 lds
    buffer_load_dwordx4 v209, s[16:19], s78 offen offset:1024 lds
    v_cvt_pk_bf16_f32 v159, v86, v87
    v_exp_f32 v88, v88
    v_exp_f32 v89, v89
    v_mfma_f32_32x32x16_bf16 v[176:191], a[108:111], v[156:159], v[176:191]
    v_exp_f32 v90, v90
    v_exp_f32 v91, v91
    v_exp_f32 v92, v92
    v_cvt_pk_bf16_f32 v152, v88, v89
    v_mfma_f32_32x32x16_bf16 v[72:87], a[24:27], v[68:71], v[136:151]
    v_exp_f32 v93, v93
    v_cvt_pk_bf16_f32 v153, v90, v91
    v_exp_f32 v94, v94
    v_exp_f32 v95, v95
    v_exp_f32 v96, v96
    v_cvt_pk_bf16_f32 v154, v92, v93
    v_exp_f32 v97, v97
    v_cvt_pk_bf16_f32 v155, v94, v95
    v_exp_f32 v98, v98
    v_exp_f32 v99, v99
    v_mfma_f32_32x32x16_bf16 v[176:191], a[96:99], v[152:155], v[176:191]
    s_add_u32 m0, s54, 104448
    s_add_u32 s78, s55, 1003520
    buffer_load_dwordx4 v208, s[16:19], s78 offen offset:0 lds
    buffer_load_dwordx4 v209, s[16:19], s78 offen offset:1024 lds
    v_exp_f32 v100, v100
    v_cvt_pk_bf16_f32 v156, v96, v97
    v_exp_f32 v101, v101
    v_cvt_pk_bf16_f32 v157, v98, v99
    v_exp_f32 v102, v102
    v_exp_f32 v103, v103
    v_cvt_pk_bf16_f32 v158, v100, v101
    s_waitcnt vmcnt(6)
    ds_read_b64_tr_b16 a[208:209], v15 offset:0
    ds_read_b64_tr_b16 a[210:211], v15 offset:1024
    ds_read_b64_tr_b16 a[212:213], v16 offset:0
    ds_read_b64_tr_b16 a[214:215], v16 offset:1024
    ds_read_b64_tr_b16 a[216:217], v15 offset:2048
    ds_read_b64_tr_b16 a[218:219], v15 offset:3072
    v_cvt_pk_bf16_f32 v159, v102, v103
    v_exp_f32 v72, v72
    v_exp_f32 v73, v73
    v_mfma_f32_32x32x16_bf16 v[176:191], a[100:103], v[156:159], v[176:191]
    v_exp_f32 v74, v74
    v_exp_f32 v75, v75
    v_exp_f32 v76, v76
    v_cvt_pk_bf16_f32 v152, v72, v73
    v_mfma_f32_32x32x16_bf16 v[88:103], a[20:23], v[68:71], v[136:151]
    v_exp_f32 v77, v77
    v_cvt_pk_bf16_f32 v153, v74, v75
    v_exp_f32 v78, v78
    v_exp_f32 v79, v79
    v_exp_f32 v80, v80
    v_cvt_pk_bf16_f32 v154, v76, v77
    v_exp_f32 v81, v81
    v_cvt_pk_bf16_f32 v155, v78, v79
    v_exp_f32 v82, v82
    v_exp_f32 v83, v83
    v_mfma_f32_32x32x16_bf16 v[176:191], a[88:91], v[152:155], v[176:191]
    ds_read_b64_tr_b16 a[220:221], v16 offset:2048
    ds_read_b64_tr_b16 a[222:223], v16 offset:3072
    ds_read_b64_tr_b16 a[224:225], v15 offset:4096
    ds_read_b64_tr_b16 a[226:227], v15 offset:5120
    ds_read_b64_tr_b16 a[228:229], v16 offset:4096
    ds_read_b64_tr_b16 a[230:231], v16 offset:5120
    v_exp_f32 v84, v84
    v_cvt_pk_bf16_f32 v156, v80, v81
    v_exp_f32 v85, v85
    v_cvt_pk_bf16_f32 v157, v82, v83
    v_exp_f32 v86, v86
    v_exp_f32 v87, v87
    v_cvt_pk_bf16_f32 v158, v84, v85
    s_add_u32 m0, s54, 131072
    s_add_u32 s78, s55, 1376256
    buffer_load_dwordx4 v208, s[16:19], s78 offen offset:0 lds
    buffer_load_dwordx4 v209, s[16:19], s78 offen offset:1024 lds
    v_cvt_pk_bf16_f32 v159, v86, v87
    v_exp_f32 v88, v88
    v_exp_f32 v89, v89
    v_mfma_f32_32x32x16_bf16 v[176:191], a[92:95], v[156:159], v[176:191]
    v_exp_f32 v90, v90
    v_exp_f32 v91, v91
    v_exp_f32 v92, v92
    v_cvt_pk_bf16_f32 v152, v88, v89
    v_mfma_f32_32x32x16_bf16 v[72:87], a[16:19], v[68:71], v[136:151]
    v_exp_f32 v93, v93
    v_cvt_pk_bf16_f32 v153, v90, v91
    v_exp_f32 v94, v94
    v_exp_f32 v95, v95
    v_exp_f32 v96, v96
    v_cvt_pk_bf16_f32 v154, v92, v93
    v_exp_f32 v97, v97
    v_cvt_pk_bf16_f32 v155, v94, v95
    v_exp_f32 v98, v98
    v_exp_f32 v99, v99
    v_mfma_f32_32x32x16_bf16 v[176:191], a[80:83], v[152:155], v[176:191]
    s_waitcnt lgkmcnt(0)
    s_add_u32 m0, s54, 0
    s_add_u32 s78, s40, 98304
    buffer_load_dwordx4 v11, s[20:23], s78 offen offset:0 lds
    buffer_load_dwordx4 v12, s[20:23], s78 offen offset:1024 lds
    v_exp_f32 v100, v100
    v_cvt_pk_bf16_f32 v156, v96, v97
    v_exp_f32 v101, v101
    v_cvt_pk_bf16_f32 v157, v98, v99
    v_exp_f32 v102, v102
    v_exp_f32 v103, v103
    v_cvt_pk_bf16_f32 v158, v100, v101
    s_add_u32 m0, s54, 2048
    s_add_u32 s78, s40, 114688
    buffer_load_dwordx4 v11, s[20:23], s78 offen offset:0 lds
    buffer_load_dwordx4 v12, s[20:23], s78 offen offset:1024 lds
    v_cvt_pk_bf16_f32 v159, v102, v103
    s_barrier
    s_cmp_lg_u32 s62, 0
    s_cbranch_scc1 L_nofl_17
    s_lshl_b32 s82, s58, 5
    s_add_u32 s82, s82, 16777216
    s_mov_b64 exec, 1
    buffer_store_dword v7, v6, s[28:31], s82 offen sc1
    s_mov_b64 exec, -1
L_nofl_17:
    v_exp_f32 v72, v72
    v_exp_f32 v73, v73
    v_mfma_f32_32x32x16_bf16 v[176:191], a[84:87], v[156:159], v[176:191]
    v_exp_f32 v74, v74
    v_exp_f32 v75, v75
    v_exp_f32 v76, v76
    v_cvt_pk_bf16_f32 v152, v72, v73
    v_mfma_f32_32x32x16_bf16 v[88:103], a[12:15], v[68:71], v[136:151]
    v_exp_f32 v77, v77
    v_cvt_pk_bf16_f32 v153, v74, v75
    v_exp_f32 v78, v78
    v_exp_f32 v79, v79
    v_exp_f32 v80, v80
    v_cvt_pk_bf16_f32 v154, v76, v77
    v_exp_f32 v81, v81
    v_cvt_pk_bf16_f32 v155, v78, v79
    v_exp_f32 v82, v82
    v_exp_f32 v83, v83
    v_mfma_f32_32x32x16_bf16 v[176:191], a[72:75], v[152:155], v[176:191]
    s_add_u32 m0, s54, 4096
    s_add_u32 s78, s40, 131072
    buffer_load_dwordx4 v11, s[20:23], s78 offen offset:0 lds
    buffer_load_dwordx4 v12, s[20:23], s78 offen offset:1024 lds
    v_exp_f32 v84, v84
    v_cvt_pk_bf16_f32 v156, v80, v81
    v_exp_f32 v85, v85
    v_cvt_pk_bf16_f32 v157, v82, v83
    v_exp_f32 v86, v86
    v_exp_f32 v87, v87
    v_cvt_pk_bf16_f32 v158, v84, v85
    s_add_u32 m0, s54, 133120
    s_add_u32 s78, s55, 1404928
    buffer_load_dwordx4 v208, s[16:19], s78 offen offset:0 lds
    buffer_load_dwordx4 v209, s[16:19], s78 offen offset:1024 lds
    v_cvt_pk_bf16_f32 v159, v86, v87
    v_exp_f32 v88, v88
    v_exp_f32 v89, v89
    v_mfma_f32_32x32x16_bf16 v[176:191], a[76:79], v[156:159], v[176:191]
    v_exp_f32 v90, v90
    v_exp_f32 v91, v91
    v_exp_f32 v92, v92
    v_cvt_pk_bf16_f32 v152, v88, v89
    v_mfma_f32_32x32x16_bf16 v[72:87], a[8:11], v[68:71], v[136:151]
    v_exp_f32 v93, v93
    v_cvt_pk_bf16_f32 v153, v90, v91
    v_exp_f32 v94, v94
    v_exp_f32 v95, v95
    v_exp_f32 v96, v96
    v_cvt_pk_bf16_f32 v154, v92, v93
    v_exp_f32 v97, v97
    v_cvt_pk_bf16_f32 v155, v94, v95
    v_exp_f32 v98, v98
    v_exp_f32 v99, v99
    v_mfma_f32_32x32x16_bf16 v[176:191], a[64:67], v[152:155], v[176:191]
    s_add_u32 m0, s54, 135168
    s_add_u32 s78, s55, 1433600
    buffer_load_dwordx4 v208, s[16:19], s78 offen offset:0 lds
    buffer_load_dwordx4 v209, s[16:19], s78 offen offset:1024 lds
    v_exp_f32 v100, v100
    v_cvt_pk_bf16_f32 v156, v96, v97
    v_exp_f32 v101, v101
    v_cvt_pk_bf16_f32 v157, v98, v99
    v_exp_f32 v102, v102
    v_exp_f32 v103, v103
    v_cvt_pk_bf16_f32 v158, v100, v101
    s_add_u32 m0, s54, 137216
    s_add_u32 s78, s55, 1462272
    buffer_load_dwordx4 v208, s[16:19], s78 offen offset:0 lds
    buffer_load_dwordx4 v209, s[16:19], s78 offen offset:1024 lds
    v_cvt_pk_bf16_f32 v159, v102, v103
    v_exp_f32 v72, v72
    v_exp_f32 v73, v73
    v_mfma_f32_32x32x16_bf16 v[176:191], a[68:71], v[156:159], v[176:191]
    v_exp_f32 v74, v74
    v_exp_f32 v75, v75
    v_exp_f32 v76, v76
    v_cvt_pk_bf16_f32 v152, v72, v73
    v_exp_f32 v77, v77
    v_cvt_pk_bf16_f32 v153, v74, v75
    v_exp_f32 v78, v78
    v_exp_f32 v79, v79
    v_exp_f32 v80, v80
    v_cvt_pk_bf16_f32 v154, v76, v77
    v_exp_f32 v81, v81
    v_cvt_pk_bf16_f32 v155, v78, v79
    v_exp_f32 v82, v82
    v_exp_f32 v83, v83
    v_mfma_f32_32x32x16_bf16 v[176:191], a[56:59], v[152:155], v[176:191]
    v_exp_f32 v84, v84
    v_cvt_pk_bf16_f32 v156, v80, v81
    v_exp_f32 v85, v85
    v_cvt_pk_bf16_f32 v157, v82, v83
    v_exp_f32 v86, v86
    v_exp_f32 v87, v87
    v_cvt_pk_bf16_f32 v158, v84, v85
    v_cvt_pk_bf16_f32 v159, v86, v87
    v_and_b32 v5, -13, v9
    v_lshlrev_b32 v5, 5, v5
    s_lshl_b32 s84, s59, 5
    s_add_u32 s84, s84, 16777216
    buffer_load_dword v8, v5, s[28:31], s84 offen sc1
    s_nop 1
    v_mfma_f32_32x32x16_bf16 v[176:191], a[60:63], v[156:159], v[176:191]
    s_nop 11
    v_cmp_nge_f32 vcc, 0x53800000, v184
    s_nop 0
    s_cbranch_vccnz L_exact_18
L_exact_18_back:
    v_rcp_f32 v204, v184
    s_add_u32 s79, s57, 32768
    v_mul_f32 v176, v204, v176
    v_mul_f32 v177, v204, v177
    v_mul_f32 v178, v204, v178
    v_mul_f32 v179, v204, v179
    v_mul_f32 v180, v204, v180
    v_mul_f32 v181, v204, v181
    v_mul_f32 v182, v204, v182
    v_mul_f32 v183, v204, v183
    v_cvt_pk_bf16_f32 v196, v176, v177
    v_cvt_pk_bf16_f32 v197, v178, v179
    v_cvt_pk_bf16_f32 v198, v180, v181
    v_cvt_pk_bf16_f32 v199, v182, v183
    buffer_store_dwordx4 v[196:199], v1, s[28:31], s79 offen sc1
    s_waitcnt vmcnt(8)
    ds_read_b64_tr_b16 a[232:233], v15 offset:0
    ds_read_b64_tr_b16 a[234:235], v15 offset:1024
    ds_read_b64_tr_b16 a[236:237], v16 offset:0
    ds_read_b64_tr_b16 a[238:239], v16 offset:1024
    ds_read_b64_tr_b16 a[240:241], v15 offset:2048
    ds_read_b64_tr_b16 a[242:243], v15 offset:3072
    ds_read_b64_tr_b16 a[244:245], v16 offset:2048
    ds_read_b64_tr_b16 a[246:247], v16 offset:3072
    ds_read_b64_tr_b16 a[248:249], v15 offset:4096
    ds_read_b64_tr_b16 a[250:251], v15 offset:5120
    ds_read_b64_tr_b16 a[252:253], v16 offset:4096
    ds_read_b64_tr_b16 a[254:255], v16 offset:5120
    s_waitcnt vmcnt(0)
    s_branch L_att_done
L_retry_19:
    s_mov_b32 s71, 0
L_retry_19_l:
    buffer_load_dword v8, v5, s[28:31], s84 offen sc1
    s_add_u32 s71, s71, 1
    s_waitcnt vmcnt(0)
    v_cmp_ne_u32 vcc, s70, v8
    s_cmp_gt_u32 s71, 65536
    s_cbranch_scc1 L_back_20
    s_cbranch_vccnz L_retry_19_l
    s_branch L_back_20
L_retry_22:
    s_mov_b32 s71, 0
L_retry_22_l:
    buffer_load_dword v8, v5, s[28:31], s84 offen sc1
    s_add_u32 s71, s71, 1
    s_waitcnt vmcnt(0)
    v_cmp_ne_u32 vcc, s70, v8
    s_cmp_gt_u32 s71, 65536
    s_cbranch_scc1 L_back_23
    s_cbranch_vccnz L_retry_22_l
    s_branch L_back_23
L_retry_24:
    s_mov_b32 s71, 0
L_retry_24_l:
    buffer_load_dword v8, v5, s[28:31], s84 offen sc1
    s_add_u32 s71, s71, 1
    s_waitcnt vmcnt(0)
    v_cmp_ne_u32 vcc, s70, v8
    s_cmp_gt_u32 s71, 65536
    s_cbranch_scc1 L_back_25
    s_cbranch_vccnz L_retry_24_l
    s_branch L_back_25
L_retry_28:
    s_mov_b32 s71, 0
L_retry_28_l:
    buffer_load_dword v8, v5, s[28:31], s84 offen sc1
    s_add_u32 s71, s71, 1
    s_waitcnt vmcnt(0)
    v_cmp_ne_u32 vcc, s70, v8
    s_cmp_gt_u32 s71, 65536
    s_cbranch_scc1 L_back_29
    s_cbranch_vccnz L_retry_28_l
    s_branch L_back_29
L_retry_32:
    s_mov_b32 s71, 0
L_retry_32_l:
    buffer_load_dword v8, v5, s[28:31], s84 offen sc1
    s_add_u32 s71, s71, 1
    s_waitcnt vmcnt(0)
    v_cmp_ne_u32 vcc, s70, v8
    s_cmp_gt_u32 s71, 65536
    s_cbranch_scc1 L_back_33
    s_cbranch_vccnz L_retry_32_l
    s_branch L_back_33
L_retry_36:
    s_mov_b32 s71, 0
L_retry_36_l:
    buffer_load_dword v8, v5, s[28:31], s84 offen sc1
    s_add_u32 s71, s71, 1
    s_waitcnt vmcnt(0)
    v_cmp_ne_u32 vcc, s70, v8
    s_cmp_gt_u32 s71, 65536
    s_cbranch_scc1 L_back_37
    s_cbranch_vccnz L_retry_36_l
    s_branch L_back_37
L_idle4:
    s_waitcnt vmcnt(10)
    s_add_u32 s79, s43, 4096
    s_barrier
    s_cmp_lg_u32 s62, 0
    s_cbranch_scc1 L_nofl_35
    s_lshl_b32 s82, s79, 5
    s_add_u32 s82, s82, 16777216
    s_mov_b64 exec, 1
    buffer_store_dword v7, v6, s[28:31], s82 offen sc1
    s_mov_b64 exec, -1
L_nofl_35:
    s_add_u32 m0, s54, 0
    s_add_u32 s78, s56, 278528
    buffer_load_dwordx4 v11, s[20:23], s78 offen offset:0 lds
    buffer_load_dwordx4 v12, s[20:23], s78 offen offset:1024 lds
    s_add_u32 m0, s54, 2048
    s_add_u32 s78, s56, 294912
    buffer_load_dwordx4 v11, s[20:23], s78 offen offset:0 lds
    buffer_load_dwordx4 v12, s[20:23], s78 offen offset:1024 lds
    s_add_u32 m0, s54, 4096
    s_add_u32 s78, s56, 311296
    buffer_load_dwordx4 v11, s[20:23], s78 offen offset:0 lds
    buffer_load_dwordx4 v12, s[20:23], s78 offen offset:1024 lds
    s_add_u32 m0, s54, 32768
    s_add_u32 s78, s56, 327680
    buffer_load_dwordx4 v11, s[20:23], s78 offen offset:0 lds
    buffer_load_dwordx4 v12, s[20:23], s78 offen offset:1024 lds
    s_add_u32 m0, s54, 34816
    s_add_u32 s78, s56, 344064
    buffer_load_dwordx4 v11, s[20:23], s78 offen offset:0 lds
    buffer_load_dwordx4 v12, s[20:23], s78 offen offset:1024 lds
    s_add_u32 m0, s54, 36864
    s_add_u32 s78, s56, 360448
    buffer_load_dwordx4 v11, s[20:23], s78 offen offset:0 lds
    buffer_load_dwordx4 v12, s[20:23], s78 offen offset:1024 lds
    s_add_u32 m0, s54, 38912
    s_add_u32 s78, s56, 376832
    buffer_load_dwordx4 v11, s[20:23], s78 offen offset:0 lds
    buffer_load_dwordx4 v12, s[20:23], s78 offen offset:1024 lds
    s_add_u32 m0, s54, 65536
    s_add_u32 s78, s56, 393216
    buffer_load_dwordx4 v11, s[20:23], s78 offen offset:0 lds
    buffer_load_dwordx4 v12, s[20:23], s78 offen offset:1024 lds
    s_add_u32 m0, s54, 67584
    s_add_u32 s78, s56, 409600
    buffer_load_dwordx4 v11, s[20:23], s78 offen offset:0 lds
    buffer_load_dwordx4 v12, s[20:23], s78 offen offset:1024 lds
    s_add_u32 m0, s54, 69632
    s_add_u32 s78, s56, 425984
    buffer_load_dwordx4 v11, s[20:23], s78 offen offset:0 lds
    buffer_load_dwordx4 v12, s[20:23], s78 offen offset:1024 lds
    s_add_u32 m0, s54, 71680
    s_add_u32 s78, s56, 442368
    buffer_load_dwordx4 v11, s[20:23], s78 offen offset:0 lds
    buffer_load_dwordx4 v12, s[20:23], s78 offen offset:1024 lds
    s_waitcnt vmcnt(8)
    ds_read_b64_tr_b16 a[88:89], v15 offset:32768
    ds_read_b64_tr_b16 a[90:91], v15 offset:33792
    ds_read_b64_tr_b16 a[92:93], v16 offset:32768
    ds_read_b64_tr_b16 a[94:95], v16 offset:33792
    ds_read_b64_tr_b16 a[96:97], v15 offset:34816
    ds_read_b64_tr_b16 a[98:99], v15 offset:35840
    ds_read_b64_tr_b16 a[100:101], v16 offset:34816
    ds_read_b64_tr_b16 a[102:103], v16 offset:35840
    ds_read_b64_tr_b16 a[104:105], v15 offset:36864
    ds_read_b64_tr_b16 a[106:107], v15 offset:37888
    ds_read_b64_tr_b16 a[108:109], v16 offset:36864
    ds_read_b64_tr_b16 a[110:111], v16 offset:37888
    ds_read_b64_tr_b16 a[112:113], v15 offset:38912
    ds_read_b64_tr_b16 a[114:115], v15 offset:39936
    ds_read_b64_tr_b16 a[116:117], v16 offset:38912
    ds_read_b64_tr_b16 a[118:119], v16 offset:39936
    s_waitcnt lgkmcnt(15)
    s_add_u32 m0, s54, 98304
    s_add_u32 s78, s56, 0
    buffer_load_dwordx4 v11, s[20:23], s78 offen offset:0 lds
    buffer_load_dwordx4 v12, s[20:23], s78 offen offset:1024 lds
    s_add_u32 m0, s54, 100352
    s_add_u32 s78, s56, 16384
    buffer_load_dwordx4 v11, s[20:23], s78 offen offset:0 lds
    buffer_load_dwordx4 v12, s[20:23], s78 offen offset:1024 lds
    s_add_u32 m0, s54, 102400
    s_add_u32 s78, s56, 32768
    buffer_load_dwordx4 v11, s[20:23], s78 offen offset:0 lds
    buffer_load_dwordx4 v12, s[20:23], s78 offen offset:1024 lds
    s_add_u32 m0, s54, 104448
    s_add_u32 s78, s56, 49152
    buffer_load_dwordx4 v11, s[20:23], s78 offen offset:0 lds
    buffer_load_dwordx4 v12, s[20:23], s78 offen offset:1024 lds
    s_add_u32 m0, s54, 131072
    s_add_u32 s78, s56, 65536
    buffer_load_dwordx4 v11, s[20:23], s78 offen offset:0 lds
    buffer_load_dwordx4 v12, s[20:23], s78 offen offset:1024 lds
    s_add_u32 m0, s54, 133120
    s_add_u32 s78, s56, 81920
    buffer_load_dwordx4 v11, s[20:23], s78 offen offset:0 lds
    buffer_load_dwordx4 v12, s[20:23], s78 offen offset:1024 lds
    s_add_u32 m0, s54, 135168
    s_add_u32 s78, s56, 98304
    buffer_load_dwordx4 v11, s[20:23], s78 offen offset:0 lds
    buffer_load_dwordx4 v12, s[20:23], s78 offen offset:1024 lds
    s_add_u32 m0, s54, 137216
    s_add_u32 s78, s56, 114688
    buffer_load_dwordx4 v11, s[20:23], s78 offen offset:0 lds
    buffer_load_dwordx4 v12, s[20:23], s78 offen offset:1024 lds
    s_waitcnt lgkmcnt(0)
    s_add_u32 m0, s54, 32768
    s_add_u32 s78, s56, 131072
    buffer_load_dwordx4 v11, s[20:23], s78 offen offset:0 lds
    buffer_load_dwordx4 v12, s[20:23], s78 offen offset:1024 lds
    s_waitcnt vmcnt(0)
    ds_read_b64_tr_b16 a[184:185], v44 offset:32768
    ds_read_b64_tr_b16 a[186:187], v44 offset:33792
    ds_read_b64_tr_b16 a[188:189], v45 offset:32768
    ds_read_b64_tr_b16 a[190:191], v45 offset:33792
    ds_read_b64_tr_b16 a[192:193], v44 offset:34816
    ds_read_b64_tr_b16 a[194:195], v44 offset:35840
    ds_read_b64_tr_b16 a[196:197], v45 offset:34816
    ds_read_b64_tr_b16 a[198:199], v45 offset:35840
    ds_read_b64_tr_b16 a[200:201], v44 offset:36864
    ds_read_b64_tr_b16 a[202:203], v44 offset:37888
    ds_read_b64_tr_b16 a[204:205], v45 offset:36864
    ds_read_b64_tr_b16 a[206:207], v45 offset:37888
    ds_read_b64_tr_b16 a[208:209], v44 offset:38912
    ds_read_b64_tr_b16 a[210:211], v44 offset:39936
    ds_read_b64_tr_b16 a[212:213], v45 offset:38912
    ds_read_b64_tr_b16 a[214:215], v45 offset:39936
    ds_read_b64_tr_b16 a[216:217], v46 offset:0
    ds_read_b64_tr_b16 a[218:219], v46 offset:1024
    ds_read_b64_tr_b16 a[220:221], v47 offset:0
    ds_read_b64_tr_b16 a[222:223], v47 offset:1024
    ds_read_b64_tr_b16 a[224:225], v46 offset:2048
    ds_read_b64_tr_b16 a[226:227], v46 offset:3072
    ds_read_b64_tr_b16 a[228:229], v47 offset:2048
    ds_read_b64_tr_b16 a[230:231], v47 offset:3072
    ds_read_b64_tr_b16 a[232:233], v46 offset:4096
    ds_read_b64_tr_b16 a[234:235], v46 offset:5120
    ds_read_b64_tr_b16 a[236:237], v47 offset:4096
    ds_read_b64_tr_b16 a[238:239], v47 offset:5120
    ds_read_b64_tr_b16 a[240:241], v46 offset:6144
    ds_read_b64_tr_b16 a[242:243], v46 offset:7168
    ds_read_b64_tr_b16 a[244:245], v47 offset:6144
    ds_read_b64_tr_b16 a[246:247], v47 offset:7168
    ds_read_b64_tr_b16 a[248:249], v15 offset:32768
    ds_read_b64_tr_b16 a[250:251], v15 offset:33792
    ds_read_b64_tr_b16 a[252:253], v16 offset:32768
    ds_read_b64_tr_b16 a[254:255], v16 offset:33792
    s_lshl_b32 s74, s65, 8
    s_mul_i32 s75, s62, 56
    s_add_u32 s40, s74, 24576
    v_min_u32 v9, 13, v0
    v_lshl_add_u32 v9, v9, 2, s75
    s_mul_i32 s74, s65, 229376
    s_mul_i32 s75, s62, 28672
    s_add_u32 s74, s74, s75
    s_add_u32 s41, s74, 9437184
    v_and_b32 v5, -13, v9
    v_lshlrev_b32 v5, 5, v5
    s_lshl_b32 s84, s40, 5
    s_add_u32 s84, s84, 16777216
    buffer_load_dword v8, v5, s[28:31], s84 offen sc1
    s_waitcnt vmcnt(0)
    v_cmp_ne_u32 vcc, s70, v8
    s_nop 0
    s_cbranch_vccnz L_retry_36
L_back_37:
    s_add_u32 s81, s41, 0
    buffer_load_dwordx4 v[128:131], v1, s[28:31], s81 offen offset:0 sc1
    buffer_load_dwordx4 v[132:135], v1, s[28:31], s81 offen offset:1024 sc1
    buffer_load_dwordx4 v[136:139], v1, s[28:31], s81 offen offset:2048 sc1
    buffer_load_dwordx4 v[140:143], v1, s[28:31], s81 offen offset:3072 sc1
    s_add_u32 s81, s41, 4096
    buffer_load_dwordx4 v[144:147], v1, s[28:31], s81 offen offset:0 sc1
    buffer_load_dwordx4 v[148:151], v1, s[28:31], s81 offen offset:1024 sc1
    buffer_load_dwordx4 v[152:155], v1, s[28:31], s81 offen offset:2048 sc1
    buffer_load_dwordx4 v[156:159], v1, s[28:31], s81 offen offset:3072 sc1
    s_add_u32 s81, s41, 8192
    buffer_load_dwordx4 v[160:163], v1, s[28:31], s81 offen offset:0 sc1
    buffer_load_dwordx4 v[164:167], v1, s[28:31], s81 offen offset:1024 sc1
    s_waitcnt vmcnt(0) lgkmcnt(0)
    s_mov_b32 s49, 40960
    s_branch L_s5
L_retry_39:
    s_mov_b32 s71, 0
L_retry_39_l:
    buffer_load_dword v8, v5, s[28:31], s84 offen sc1
    s_add_u32 s71, s71, 1
    s_waitcnt vmcnt(0)
    v_cmp_ne_u32 vcc, s70, v8
    s_cmp_gt_u32 s71, 65536
    s_cbranch_scc1 L_back_40
    s_cbranch_vccnz L_retry_39_l
    s_branch L_back_40
L_codeend:
    s_endpgm
.section .rodata,"a"
.p2align 6
.amdhsa_kernel sequential_preLN__sliding_block__mixer_channel_mlp__prompt_kernel
  .amdhsa_next_free_vgpr 512
  .amdhsa_next_free_sgpr 102
  .amdhsa_accum_offset 256
  .amdhsa_group_segment_fixed_size 0
  .amdhsa_kernarg_size 88
  .amdhsa_user_sgpr_count 2
  .amdhsa_user_sgpr_kernarg_segment_ptr 1
  .amdhsa_system_sgpr_workgroup_id_x 1
  .amdhsa_float_denorm_mode_32 3
.end_amdhsa_kernel
```
